```python
import torch

def _softmax(x, axis=-1):
    return torch.softmax(x, dim=axis)
def _gelu(x):
    return torch.nn.functional.gelu(x, approximate="tanh")
def _silu(x):
    return torch.nn.functional.silu(x)
def _sigmoid(x):
    return torch.sigmoid(x)
def _layernorm(x, axis=-1, eps=1e-5):
    m = x.mean(dim=axis, keepdim=True)
    v = x.var(dim=axis, keepdim=True, unbiased=False)
    return (x - m) / torch.sqrt(v + eps)
def _scatter_add(tgt, idx, src, axis=0):
    return tgt.clone().index_add_(axis, idx, src)
def _segment_sum(src, seg, n):
    out = torch.zeros((n,) + src.shape[1:], dtype=src.dtype)
    return out.index_add_(0, seg, src)
def _pad(x, pw):
    flat = tuple(v for pair in reversed(pw) for v in pair)
    return torch.nn.functional.pad(x, flat)

kernel_name = 'sequential_preLN__mha_block__dense_activation_gelu__prompt'

def setup_inputs():

    _w = (lambda a: (lambda t: t.to(torch.bfloat16) if t.is_floating_point() else t)(torch.as_tensor(a)))
    def _A_setup():
        B, S, D, H = 1, 2048, 448, 16
        return {
            "x": _w((lambda *s: torch.randn(*s, dtype=torch.bfloat16) * 0.05)(B, S, D)),
            "wqkv": _w((lambda *s: torch.randn(*s, dtype=torch.bfloat16) * 0.05)(D, 3 * D)),
            "wo": _w((lambda *s: torch.randn(*s, dtype=torch.bfloat16) * 0.05)(D, D)),
        }
    _A_in = _A_setup()

    def _B_setup():
        B, S, D, F = 1, 2048, 448, 1792
        return {
            "x": _w((lambda *s: torch.randn(*s, dtype=torch.bfloat16) * 0.05)(B, S, D)),
            "w1": _w((lambda *s: torch.randn(*s, dtype=torch.bfloat16) * 0.8)(D, F) * (D ** -0.5)),
            "b1": _w((lambda *s: torch.randn(*s, dtype=torch.bfloat16) * 12.8)(F) * 0.01),
            "w2": _w((lambda *s: torch.randn(*s, dtype=torch.bfloat16) * 0.8)(F, D) * (F ** -0.5)),
            "b2": _w((lambda *s: torch.randn(*s, dtype=torch.bfloat16) * 12.8)(D) * 0.01),
        }
    _B_in = _B_setup()

    return {
        "A_x": _A_in["x"],
        "A_wqkv": _A_in["wqkv"],
        "A_wo": _A_in["wo"],
        "B_x": _B_in["x"],
        "B_w1": _B_in["w1"],
        "B_b1": _B_in["b1"],
        "B_w2": _B_in["w2"],
        "B_b2": _B_in["b2"],
    }

def reference(A_x, A_wqkv, A_wo, B_x, B_w1, B_b1, B_w2, B_b2):
    def _A_ref(x, wqkv, wo):
        B, S, D = x.shape
        H = 16
        Dh = D // H
        qkv = (lambda x, *d: x.permute(*d))((x @ wqkv).reshape(B, S, 3, H, Dh), 2, 0, 3, 1, 4)
        q, k, v = qkv[0], qkv[1], qkv[2]
        scores = torch.einsum("bhqd,bhkd->bhqk", q, k) * (Dh ** -0.5)
        p = _softmax(scores, axis=-1)
        o = torch.einsum("bhqk,bhkd->bhqd", p, v)
        return (lambda x, *d: x.permute(*d))(o, 0, 2, 1, 3).reshape(B, S, D) @ wo

    def _B_ref(x, w1, b1, w2, b2):
        h = torch.einsum("bsd,df->bsf", x, w1) + b1
        h = _gelu(h)
        return torch.einsum("bsf,fd->bsd", h, w2) + b2

    x = A_x
    h = x + _A_ref(_layernorm(x, axis=-1), A_wqkv, A_wo)
    h2 = h + _B_ref(_layernorm(h, axis=-1), B_w1, B_b1, B_w2, B_b2)
    return h2
```

```asm
; @launch kernel=sequential_preLN__mha_block__dense_activation_gelu__prompt_kernel grid=(220,1,1) block=(512,1,1) lds=163840
; @launch kernel=attn_kernel grid=(256,1,1) block=(512,1,1) lds=143616
.amdgcn_target "amdgcn-amd-amdhsa--gfx950"
.text
.globl sequential_preLN__mha_block__dense_activation_gelu__prompt_kernel
.p2align 8
.type sequential_preLN__mha_block__dense_activation_gelu__prompt_kernel,@function
sequential_preLN__mha_block__dense_activation_gelu__prompt_kernel:
    s_cmp_ge_u32 s2, 192
    s_cbranch_scc1 sequential_preLN__mha_block__dense_activation_gelu__prompt_kernel_side
    s_load_dwordx2 s[32:33], s[0:1], 8
    s_load_dwordx2 s[34:35], s[0:1], 80
    s_load_dwordx2 s[36:37], s[0:1], 0
    s_load_dwordx2 s[40:41], s[0:1], 64
    s_load_dwordx2 s[38:39], s[0:1], 56
    v_lshrrev_b32 v1, 6, v0
    v_and_b32 v0, 63, v0
    s_and_b32 s27, s2, 7
    v_readfirstlane_b32 s24, v1
    s_lshr_b32 s28, s2, 3
    s_and_b32 s25, s27, 3
    s_lshl_b32 s25, s25, 2
    s_and_b32 s29, s28, 3
    s_add_u32 s25, s25, s29
    s_lshr_b32 s26, s27, 2
    s_mul_i32 s26, s26, 6
    s_lshr_b32 s29, s28, 2
    s_add_u32 s26, s26, s29
    s_mov_b32 s45, 0x3f803f80
    s_mov_b32 s46, 0
    s_mov_b32 s47, -1
    s_waitcnt lgkmcnt(0)
    s_mov_b32 s4, s32
    s_mov_b32 s5, s33
    s_mov_b32 s6, 1204224
    s_mov_b32 s7, 0x00020000
    s_mov_b32 s8, s36
    s_mov_b32 s9, s37
    s_mov_b32 s10, 1835008
    s_mov_b32 s11, 0x00020000
    s_mov_b32 s12, s34
    s_mov_b32 s13, s35
    s_mov_b32 s14, 6291456
    s_mov_b32 s15, 0x00020000
    s_cmp_lt_u32 s24, 4
    s_cbranch_scc1 sequential_preLN__mha_block__dense_activation_gelu__prompt_kernel_compute
    s_sub_u32 s24, s24, 4
    s_lshl_b32 s44, s24, 12
    v_lshrrev_b32 v2, 4, v0
    v_and_b32 v3, 15, v0
    v_lshlrev_b32 v4, 2, v2
    v_xor_b32 v3, v3, v4
    s_mov_b32 s30, 2688
    v_mul_lo_u32 v2, v2, s30
    v_lshl_add_u32 v10, v3, 4, v2
    s_mul_i32 s42, s24, 43008
    s_mul_i32 s30, s26, 224
    s_add_u32 s42, s42, s30
    v_lshrrev_b32 v2, 3, v0
    v_and_b32 v3, 7, v0
    v_lshrrev_b32 v4, 4, v0
    v_xor_b32 v3, v3, v4
    s_mov_b32 s30, 896
    v_mul_lo_u32 v2, v2, s30
    v_lshl_add_u32 v11, v3, 4, v2
    v_xor_b32 v3, 4, v3
    v_lshl_add_u32 v12, v3, 4, v2
    s_lshl_b32 s43, s25, 7
    s_lshl_b32 s30, s24, 5
    s_add_u32 s43, s43, s30
    s_mul_i32 s43, s43, 896
    s_add_u32 m0, s44, 0
    s_add_u32 s30, s42, 0
    buffer_load_dwordx4 v10, s[4:7], s30 offen lds
    s_add_u32 m0, s44, 16384
    s_add_u32 s30, s43, 0
    buffer_load_dwordx4 v11, s[8:11], s30 offen lds
    s_add_u32 m0, s44, 1024
    s_add_u32 s30, s42, 10752
    buffer_load_dwordx4 v10, s[4:7], s30 offen lds
    s_add_u32 m0, s44, 17408
    s_add_u32 s30, s43, 7168
    buffer_load_dwordx4 v12, s[8:11], s30 offen lds
    s_add_u32 m0, s44, 2048
    s_add_u32 s30, s42, 21504
    buffer_load_dwordx4 v10, s[4:7], s30 offen lds
    s_add_u32 m0, s44, 18432
    s_add_u32 s30, s43, 14336
    buffer_load_dwordx4 v11, s[8:11], s30 offen lds
    s_add_u32 m0, s44, 3072
    s_add_u32 s30, s42, 32256
    buffer_load_dwordx4 v10, s[4:7], s30 offen lds
    s_add_u32 m0, s44, 19456
    s_add_u32 s30, s43, 21504
    buffer_load_dwordx4 v12, s[8:11], s30 offen lds
    s_add_u32 m0, s44, 32768
    s_add_u32 s30, s42, 172032
    buffer_load_dwordx4 v10, s[4:7], s30 offen lds
    s_add_u32 m0, s44, 49152
    s_add_u32 s30, s43, 128
    buffer_load_dwordx4 v11, s[8:11], s30 offen lds
    s_add_u32 m0, s44, 33792
    s_add_u32 s30, s42, 182784
    buffer_load_dwordx4 v10, s[4:7], s30 offen lds
    s_add_u32 m0, s44, 50176
    s_add_u32 s30, s43, 7296
    buffer_load_dwordx4 v12, s[8:11], s30 offen lds
    s_add_u32 m0, s44, 34816
    s_add_u32 s30, s42, 193536
    buffer_load_dwordx4 v10, s[4:7], s30 offen lds
    s_add_u32 m0, s44, 51200
    s_add_u32 s30, s43, 14464
    buffer_load_dwordx4 v11, s[8:11], s30 offen lds
    s_add_u32 m0, s44, 35840
    s_add_u32 s30, s42, 204288
    buffer_load_dwordx4 v10, s[4:7], s30 offen lds
    s_add_u32 m0, s44, 52224
    s_add_u32 s30, s43, 21632
    buffer_load_dwordx4 v12, s[8:11], s30 offen lds
    s_waitcnt vmcnt(8)
    s_barrier
    s_add_u32 m0, s44, 65536
    s_add_u32 s30, s42, 344064
    buffer_load_dwordx4 v10, s[4:7], s30 offen lds
    s_add_u32 m0, s44, 81920
    s_add_u32 s30, s43, 256
    buffer_load_dwordx4 v11, s[8:11], s30 offen lds
    s_add_u32 m0, s44, 66560
    s_add_u32 s30, s42, 354816
    buffer_load_dwordx4 v10, s[4:7], s30 offen lds
    s_add_u32 m0, s44, 82944
    s_add_u32 s30, s43, 7424
    buffer_load_dwordx4 v12, s[8:11], s30 offen lds
    s_add_u32 m0, s44, 67584
    s_add_u32 s30, s42, 365568
    buffer_load_dwordx4 v10, s[4:7], s30 offen lds
    s_add_u32 m0, s44, 83968
    s_add_u32 s30, s43, 14592
    buffer_load_dwordx4 v11, s[8:11], s30 offen lds
    s_add_u32 m0, s44, 68608
    s_add_u32 s30, s42, 376320
    buffer_load_dwordx4 v10, s[4:7], s30 offen lds
    s_add_u32 m0, s44, 84992
    s_add_u32 s30, s43, 21760
    buffer_load_dwordx4 v12, s[8:11], s30 offen lds
    s_add_u32 m0, s44, 98304
    s_add_u32 s30, s42, 516096
    buffer_load_dwordx4 v10, s[4:7], s30 offen lds
    s_add_u32 m0, s44, 114688
    s_add_u32 s30, s43, 384
    buffer_load_dwordx4 v11, s[8:11], s30 offen lds
    s_add_u32 m0, s44, 99328
    s_add_u32 s30, s42, 526848
    buffer_load_dwordx4 v10, s[4:7], s30 offen lds
    s_add_u32 m0, s44, 115712
    s_add_u32 s30, s43, 7552
    buffer_load_dwordx4 v12, s[8:11], s30 offen lds
    s_add_u32 m0, s44, 100352
    s_add_u32 s30, s42, 537600
    buffer_load_dwordx4 v10, s[4:7], s30 offen lds
    s_add_u32 m0, s44, 116736
    s_add_u32 s30, s43, 14720
    buffer_load_dwordx4 v11, s[8:11], s30 offen lds
    s_add_u32 m0, s44, 101376
    s_add_u32 s30, s42, 548352
    buffer_load_dwordx4 v10, s[4:7], s30 offen lds
    s_add_u32 m0, s44, 117760
    s_add_u32 s30, s43, 21888
    buffer_load_dwordx4 v12, s[8:11], s30 offen lds
    s_waitcnt vmcnt(16)
    s_barrier
    s_add_u32 m0, s44, 131072
    s_add_u32 s30, s42, 688128
    buffer_load_dwordx4 v10, s[4:7], s30 offen lds
    s_add_u32 m0, s44, 147456
    s_add_u32 s30, s43, 512
    buffer_load_dwordx4 v11, s[8:11], s30 offen lds
    s_add_u32 m0, s44, 132096
    s_add_u32 s30, s42, 698880
    buffer_load_dwordx4 v10, s[4:7], s30 offen lds
    s_add_u32 m0, s44, 148480
    s_add_u32 s30, s43, 7680
    buffer_load_dwordx4 v12, s[8:11], s30 offen lds
    s_add_u32 m0, s44, 133120
    s_add_u32 s30, s42, 709632
    buffer_load_dwordx4 v10, s[4:7], s30 offen lds
    s_add_u32 m0, s44, 149504
    s_add_u32 s30, s43, 14848
    buffer_load_dwordx4 v11, s[8:11], s30 offen lds
    s_add_u32 m0, s44, 134144
    s_add_u32 s30, s42, 720384
    buffer_load_dwordx4 v10, s[4:7], s30 offen lds
    s_add_u32 m0, s44, 150528
    s_add_u32 s30, s43, 22016
    buffer_load_dwordx4 v12, s[8:11], s30 offen lds
    s_add_u32 m0, s44, 0
    s_add_u32 s30, s42, 860160
    buffer_load_dwordx4 v10, s[4:7], s30 offen lds
    s_add_u32 m0, s44, 16384
    s_add_u32 s30, s43, 640
    buffer_load_dwordx4 v11, s[8:11], s30 offen lds
    s_add_u32 m0, s44, 1024
    s_add_u32 s30, s42, 870912
    buffer_load_dwordx4 v10, s[4:7], s30 offen lds
    s_add_u32 m0, s44, 17408
    s_add_u32 s30, s43, 7808
    buffer_load_dwordx4 v12, s[8:11], s30 offen lds
    s_add_u32 m0, s44, 2048
    s_add_u32 s30, s42, 881664
    buffer_load_dwordx4 v10, s[4:7], s30 offen lds
    s_add_u32 m0, s44, 18432
    s_add_u32 s30, s43, 14976
    buffer_load_dwordx4 v11, s[8:11], s30 offen lds
    s_add_u32 m0, s44, 3072
    s_add_u32 s30, s42, 892416
    buffer_load_dwordx4 v10, s[4:7], s30 offen lds
    s_add_u32 m0, s44, 19456
    s_add_u32 s30, s43, 22144
    buffer_load_dwordx4 v12, s[8:11], s30 offen lds
    s_waitcnt vmcnt(24)
    s_barrier
    s_add_u32 m0, s44, 32768
    s_add_u32 s30, s42, 1032192
    buffer_load_dwordx4 v10, s[4:7], s30 offen lds
    s_add_u32 m0, s44, 49152
    s_add_u32 s30, s43, 768
    buffer_load_dwordx4 v11, s[8:11], s30 offen lds
    s_add_u32 m0, s44, 33792
    s_add_u32 s30, s42, 1042944
    buffer_load_dwordx4 v10, s[4:7], s30 offen lds
    s_add_u32 m0, s44, 50176
    s_add_u32 s30, s43, 7936
    buffer_load_dwordx4 v12, s[8:11], s30 offen lds
    s_add_u32 m0, s44, 34816
    s_add_u32 s30, s42, 1053696
    buffer_load_dwordx4 v10, s[4:7], s30 offen lds
    s_add_u32 m0, s44, 51200
    s_add_u32 s30, s43, 15104
    buffer_load_dwordx4 v11, s[8:11], s30 offen lds
    s_add_u32 m0, s44, 35840
    s_add_u32 s30, s42, 1064448
    buffer_load_dwordx4 v10, s[4:7], s30 offen lds
    s_add_u32 m0, s44, 52224
    s_add_u32 s30, s43, 22272
    buffer_load_dwordx4 v12, s[8:11], s30 offen lds
    s_waitcnt vmcnt(24)
    s_barrier
    s_waitcnt vmcnt(16)
    s_barrier
    s_waitcnt vmcnt(8)
    s_barrier
    s_waitcnt vmcnt(0)
    s_barrier
    s_endpgm
sequential_preLN__mha_block__dense_activation_gelu__prompt_kernel_compute:
    v_lshrrev_b32 v10, 4, v0
    v_and_b32 v11, 1, v10
    v_lshrrev_b32 v12, 5, v0
    v_bfe_u32 v13, v0, 2, 2
    v_and_b32 v14, 3, v0
    v_and_b32 v15, 31, v0
    s_and_b32 s30, s24, 1
    s_lshr_b32 s31, s24, 1
    s_lshl_b32 s29, s31, 1
    s_add_u32 s48, s29, s30
    s_add_u32 s49, s29, 1
    s_sub_u32 s49, s49, s30
    s_lshl_b32 s29, s30, 1
    s_add_u32 s50, s29, s31
    s_add_u32 s51, s29, 1
    s_sub_u32 s51, s51, s31
    v_mul_u32_u24 v16, 8, v12
    v_add_u32 v16, v16, v13
    v_lshlrev_b32 v16, 8, v16
    v_lshlrev_b32 v17, 5, v11
    v_lshl_add_u32 v17, v14, 3, v17
    v_lshlrev_b32 v18, 2, v13
    s_mul_i32 s29, s48, 56
    v_add_u32 v19, s29, v17
    v_lshrrev_b32 v20, 4, v19
    v_xor_b32 v20, v20, v18
    v_and_b32 v19, 8, v19
    v_lshl_add_u32 v19, v20, 4, v19
    v_add_u32 v2, v19, v16
    v_add_u32 v3, 0x10000, v2
    s_mul_i32 s29, s49, 56
    v_add_u32 v19, s29, v17
    v_lshrrev_b32 v20, 4, v19
    v_xor_b32 v20, v20, v18
    v_and_b32 v19, 8, v19
    v_lshl_add_u32 v19, v20, 4, v19
    v_add_u32 v4, v19, v16
    v_add_u32 v5, 0x10000, v4
    v_bfe_u32 v19, v15, 1, 3
    v_xor_b32 v19, v19, v12
    v_lshlrev_b32 v19, 4, v19
    v_lshl_add_u32 v19, v15, 7, v19
    s_lshl_b32 s29, s50, 12
    v_add_u32 v6, s29, v19
    v_add_u32 v7, 0x10000, v6
    s_lshl_b32 s29, s51, 12
    v_add_u32 v8, s29, v19
    v_add_u32 v9, 0x10000, v8
    v_mov_b32 v128, 0
    v_mov_b32 v129, 0
    v_mov_b32 v130, 0
    s_cmp_ge_u32 s26, 8
    s_cbranch_scc1 sequential_preLN__mha_block__dense_activation_gelu__prompt_kernel_v
    s_cmp_lt_u32 s26, 4
    s_cselect_b32 s54, 0x3e8b97f6, 1.0
    v_add_u32 v26, 0x20000, v2
    v_add_u32 v27, 0x20000, v4
    v_add_u32 v28, 0x20000, v6
    v_add_u32 v29, 0x20000, v8
    s_barrier
    ds_read_b64_tr_b16 v[32:33], v2 offset:0
    ds_read_b64_tr_b16 v[34:35], v2 offset:1024
    ds_read_b64_tr_b16 v[36:37], v4 offset:0
    ds_read_b64_tr_b16 v[38:39], v4 offset:1024
    v_xor_b32 v22, 0, v6
    ds_read_b128 v[40:43], v22 offset:16384
    v_xor_b32 v23, 0, v8
    ds_read_b128 v[44:47], v23 offset:16384
    s_waitcnt lgkmcnt(0)
    v_mfma_f32_32x32x16_bf16 v[64:79], v[32:35], v[40:43], 0
    ds_read_b64_tr_b16 v[48:49], v2 offset:4096
    ds_read_b64_tr_b16 v[50:51], v2 offset:5120
    ds_read_b64_tr_b16 v[52:53], v4 offset:4096
    v_mfma_f32_32x32x16_bf16 v[80:95], v[32:35], v[44:47], 0
    ds_read_b64_tr_b16 v[54:55], v4 offset:5120
    v_xor_b32 v22, 32, v6
    ds_read_b128 v[56:59], v22 offset:16384
    v_xor_b32 v23, 32, v8
    ds_read_b128 v[60:63], v23 offset:16384
    v_dot2c_f32_bf16 v128, s45, v40
    v_dot2c_f32_bf16 v128, s45, v41
    v_dot2c_f32_bf16 v128, s45, v42
    v_dot2c_f32_bf16 v128, s45, v43
    v_mfma_f32_32x32x16_bf16 v[96:111], v[36:39], v[40:43], 0
    v_dot2c_f32_bf16 v129, v40, v40
    v_dot2c_f32_bf16 v129, v41, v41
    v_dot2c_f32_bf16 v129, v42, v42
    v_dot2c_f32_bf16 v129, v43, v43
    v_mfma_f32_32x32x16_bf16 v[112:127], v[36:39], v[44:47], 0
    v_dot2c_f32_bf16 v130, s45, v32
    v_dot2c_f32_bf16 v130, s45, v33
    v_dot2c_f32_bf16 v130, s45, v34
    v_dot2c_f32_bf16 v130, s45, v35
    s_waitcnt lgkmcnt(0)
    v_mfma_f32_32x32x16_bf16 v[64:79], v[48:51], v[56:59], v[64:79]
    ds_read_b64_tr_b16 v[32:33], v2 offset:8192
    ds_read_b64_tr_b16 v[34:35], v2 offset:9216
    ds_read_b64_tr_b16 v[36:37], v4 offset:8192
    v_mfma_f32_32x32x16_bf16 v[80:95], v[48:51], v[60:63], v[80:95]
    ds_read_b64_tr_b16 v[38:39], v4 offset:9216
    v_xor_b32 v22, 64, v6
    ds_read_b128 v[40:43], v22 offset:16384
    v_xor_b32 v23, 64, v8
    ds_read_b128 v[44:47], v23 offset:16384
    v_dot2c_f32_bf16 v128, s45, v56
    v_dot2c_f32_bf16 v128, s45, v57
    v_dot2c_f32_bf16 v128, s45, v58
    v_dot2c_f32_bf16 v128, s45, v59
    v_mfma_f32_32x32x16_bf16 v[96:111], v[52:55], v[56:59], v[96:111]
    v_dot2c_f32_bf16 v129, v56, v56
    v_dot2c_f32_bf16 v129, v57, v57
    v_dot2c_f32_bf16 v129, v58, v58
    v_dot2c_f32_bf16 v129, v59, v59
    v_mfma_f32_32x32x16_bf16 v[112:127], v[52:55], v[60:63], v[112:127]
    v_dot2c_f32_bf16 v130, s45, v48
    v_dot2c_f32_bf16 v130, s45, v49
    v_dot2c_f32_bf16 v130, s45, v50
    v_dot2c_f32_bf16 v130, s45, v51
    s_waitcnt lgkmcnt(0)
    v_mfma_f32_32x32x16_bf16 v[64:79], v[32:35], v[40:43], v[64:79]
    ds_read_b64_tr_b16 v[48:49], v2 offset:12288
    ds_read_b64_tr_b16 v[50:51], v2 offset:13312
    ds_read_b64_tr_b16 v[52:53], v4 offset:12288
    v_mfma_f32_32x32x16_bf16 v[80:95], v[32:35], v[44:47], v[80:95]
    ds_read_b64_tr_b16 v[54:55], v4 offset:13312
    v_xor_b32 v22, 96, v6
    ds_read_b128 v[56:59], v22 offset:16384
    v_xor_b32 v23, 96, v8
    ds_read_b128 v[60:63], v23 offset:16384
    v_dot2c_f32_bf16 v128, s45, v40
    v_dot2c_f32_bf16 v128, s45, v41
    v_dot2c_f32_bf16 v128, s45, v42
    v_dot2c_f32_bf16 v128, s45, v43
    v_mfma_f32_32x32x16_bf16 v[96:111], v[36:39], v[40:43], v[96:111]
    v_dot2c_f32_bf16 v129, v40, v40
    v_dot2c_f32_bf16 v129, v41, v41
    v_dot2c_f32_bf16 v129, v42, v42
    v_dot2c_f32_bf16 v129, v43, v43
    v_mfma_f32_32x32x16_bf16 v[112:127], v[36:39], v[44:47], v[112:127]
    v_dot2c_f32_bf16 v130, s45, v32
    v_dot2c_f32_bf16 v130, s45, v33
    v_dot2c_f32_bf16 v130, s45, v34
    v_dot2c_f32_bf16 v130, s45, v35
    s_waitcnt lgkmcnt(0)
    s_barrier
    v_mfma_f32_32x32x16_bf16 v[64:79], v[48:51], v[56:59], v[64:79]
    ds_read_b64_tr_b16 v[32:33], v2 offset:32768
    ds_read_b64_tr_b16 v[34:35], v2 offset:33792
    ds_read_b64_tr_b16 v[36:37], v4 offset:32768
    v_mfma_f32_32x32x16_bf16 v[80:95], v[48:51], v[60:63], v[80:95]
    ds_read_b64_tr_b16 v[38:39], v4 offset:33792
    v_xor_b32 v22, 0, v6
    ds_read_b128 v[40:43], v22 offset:49152
    v_xor_b32 v23, 0, v8
    ds_read_b128 v[44:47], v23 offset:49152
    v_dot2c_f32_bf16 v128, s45, v56
    v_dot2c_f32_bf16 v128, s45, v57
    v_dot2c_f32_bf16 v128, s45, v58
    v_dot2c_f32_bf16 v128, s45, v59
    v_mfma_f32_32x32x16_bf16 v[96:111], v[52:55], v[56:59], v[96:111]
    v_dot2c_f32_bf16 v129, v56, v56
    v_dot2c_f32_bf16 v129, v57, v57
    v_dot2c_f32_bf16 v129, v58, v58
    v_dot2c_f32_bf16 v129, v59, v59
    v_mfma_f32_32x32x16_bf16 v[112:127], v[52:55], v[60:63], v[112:127]
    v_dot2c_f32_bf16 v130, s45, v48
    v_dot2c_f32_bf16 v130, s45, v49
    v_dot2c_f32_bf16 v130, s45, v50
    v_dot2c_f32_bf16 v130, s45, v51
    s_waitcnt lgkmcnt(0)
    v_mfma_f32_32x32x16_bf16 v[64:79], v[32:35], v[40:43], v[64:79]
    ds_read_b64_tr_b16 v[48:49], v2 offset:36864
    ds_read_b64_tr_b16 v[50:51], v2 offset:37888
    ds_read_b64_tr_b16 v[52:53], v4 offset:36864
    v_mfma_f32_32x32x16_bf16 v[80:95], v[32:35], v[44:47], v[80:95]
    ds_read_b64_tr_b16 v[54:55], v4 offset:37888
    v_xor_b32 v22, 32, v6
    ds_read_b128 v[56:59], v22 offset:49152
    v_xor_b32 v23, 32, v8
    ds_read_b128 v[60:63], v23 offset:49152
    v_dot2c_f32_bf16 v128, s45, v40
    v_dot2c_f32_bf16 v128, s45, v41
    v_dot2c_f32_bf16 v128, s45, v42
    v_dot2c_f32_bf16 v128, s45, v43
    v_mfma_f32_32x32x16_bf16 v[96:111], v[36:39], v[40:43], v[96:111]
    v_dot2c_f32_bf16 v129, v40, v40
    v_dot2c_f32_bf16 v129, v41, v41
    v_dot2c_f32_bf16 v129, v42, v42
    v_dot2c_f32_bf16 v129, v43, v43
    v_mfma_f32_32x32x16_bf16 v[112:127], v[36:39], v[44:47], v[112:127]
    v_dot2c_f32_bf16 v130, s45, v32
    v_dot2c_f32_bf16 v130, s45, v33
    v_dot2c_f32_bf16 v130, s45, v34
    v_dot2c_f32_bf16 v130, s45, v35
    s_waitcnt lgkmcnt(0)
    v_mfma_f32_32x32x16_bf16 v[64:79], v[48:51], v[56:59], v[64:79]
    ds_read_b64_tr_b16 v[32:33], v2 offset:40960
    ds_read_b64_tr_b16 v[34:35], v2 offset:41984
    ds_read_b64_tr_b16 v[36:37], v4 offset:40960
    v_mfma_f32_32x32x16_bf16 v[80:95], v[48:51], v[60:63], v[80:95]
    ds_read_b64_tr_b16 v[38:39], v4 offset:41984
    v_xor_b32 v22, 64, v6
    ds_read_b128 v[40:43], v22 offset:49152
    v_xor_b32 v23, 64, v8
    ds_read_b128 v[44:47], v23 offset:49152
    v_dot2c_f32_bf16 v128, s45, v56
    v_dot2c_f32_bf16 v128, s45, v57
    v_dot2c_f32_bf16 v128, s45, v58
    v_dot2c_f32_bf16 v128, s45, v59
    v_mfma_f32_32x32x16_bf16 v[96:111], v[52:55], v[56:59], v[96:111]
    v_dot2c_f32_bf16 v129, v56, v56
    v_dot2c_f32_bf16 v129, v57, v57
    v_dot2c_f32_bf16 v129, v58, v58
    v_dot2c_f32_bf16 v129, v59, v59
    v_mfma_f32_32x32x16_bf16 v[112:127], v[52:55], v[60:63], v[112:127]
    v_dot2c_f32_bf16 v130, s45, v48
    v_dot2c_f32_bf16 v130, s45, v49
    v_dot2c_f32_bf16 v130, s45, v50
    v_dot2c_f32_bf16 v130, s45, v51
    s_waitcnt lgkmcnt(0)
    v_mfma_f32_32x32x16_bf16 v[64:79], v[32:35], v[40:43], v[64:79]
    ds_read_b64_tr_b16 v[48:49], v2 offset:45056
    ds_read_b64_tr_b16 v[50:51], v2 offset:46080
    ds_read_b64_tr_b16 v[52:53], v4 offset:45056
    v_mfma_f32_32x32x16_bf16 v[80:95], v[32:35], v[44:47], v[80:95]
    ds_read_b64_tr_b16 v[54:55], v4 offset:46080
    v_xor_b32 v22, 96, v6
    ds_read_b128 v[56:59], v22 offset:49152
    v_xor_b32 v23, 96, v8
    ds_read_b128 v[60:63], v23 offset:49152
    v_dot2c_f32_bf16 v128, s45, v40
    v_dot2c_f32_bf16 v128, s45, v41
    v_dot2c_f32_bf16 v128, s45, v42
    v_dot2c_f32_bf16 v128, s45, v43
    v_mfma_f32_32x32x16_bf16 v[96:111], v[36:39], v[40:43], v[96:111]
    v_dot2c_f32_bf16 v129, v40, v40
    v_dot2c_f32_bf16 v129, v41, v41
    v_dot2c_f32_bf16 v129, v42, v42
    v_dot2c_f32_bf16 v129, v43, v43
    v_mfma_f32_32x32x16_bf16 v[112:127], v[36:39], v[44:47], v[112:127]
    v_dot2c_f32_bf16 v130, s45, v32
    v_dot2c_f32_bf16 v130, s45, v33
    v_dot2c_f32_bf16 v130, s45, v34
    v_dot2c_f32_bf16 v130, s45, v35
    s_waitcnt lgkmcnt(0)
    s_barrier
    v_mfma_f32_32x32x16_bf16 v[64:79], v[48:51], v[56:59], v[64:79]
    ds_read_b64_tr_b16 v[32:33], v3 offset:0
    ds_read_b64_tr_b16 v[34:35], v3 offset:1024
    ds_read_b64_tr_b16 v[36:37], v5 offset:0
    v_mfma_f32_32x32x16_bf16 v[80:95], v[48:51], v[60:63], v[80:95]
    ds_read_b64_tr_b16 v[38:39], v5 offset:1024
    v_xor_b32 v22, 0, v7
    ds_read_b128 v[40:43], v22 offset:16384
    v_xor_b32 v23, 0, v9
    ds_read_b128 v[44:47], v23 offset:16384
    v_dot2c_f32_bf16 v128, s45, v56
    v_dot2c_f32_bf16 v128, s45, v57
    v_dot2c_f32_bf16 v128, s45, v58
    v_dot2c_f32_bf16 v128, s45, v59
    v_mfma_f32_32x32x16_bf16 v[96:111], v[52:55], v[56:59], v[96:111]
    v_dot2c_f32_bf16 v129, v56, v56
    v_dot2c_f32_bf16 v129, v57, v57
    v_dot2c_f32_bf16 v129, v58, v58
    v_dot2c_f32_bf16 v129, v59, v59
    v_mfma_f32_32x32x16_bf16 v[112:127], v[52:55], v[60:63], v[112:127]
    v_dot2c_f32_bf16 v130, s45, v48
    v_dot2c_f32_bf16 v130, s45, v49
    v_dot2c_f32_bf16 v130, s45, v50
    v_dot2c_f32_bf16 v130, s45, v51
    s_waitcnt lgkmcnt(0)
    v_mfma_f32_32x32x16_bf16 v[64:79], v[32:35], v[40:43], v[64:79]
    ds_read_b64_tr_b16 v[48:49], v3 offset:4096
    ds_read_b64_tr_b16 v[50:51], v3 offset:5120
    ds_read_b64_tr_b16 v[52:53], v5 offset:4096
    v_mfma_f32_32x32x16_bf16 v[80:95], v[32:35], v[44:47], v[80:95]
    ds_read_b64_tr_b16 v[54:55], v5 offset:5120
    v_xor_b32 v22, 32, v7
    ds_read_b128 v[56:59], v22 offset:16384
    v_xor_b32 v23, 32, v9
    ds_read_b128 v[60:63], v23 offset:16384
    v_dot2c_f32_bf16 v128, s45, v40
    v_dot2c_f32_bf16 v128, s45, v41
    v_dot2c_f32_bf16 v128, s45, v42
    v_dot2c_f32_bf16 v128, s45, v43
    v_mfma_f32_32x32x16_bf16 v[96:111], v[36:39], v[40:43], v[96:111]
    v_dot2c_f32_bf16 v129, v40, v40
    v_dot2c_f32_bf16 v129, v41, v41
    v_dot2c_f32_bf16 v129, v42, v42
    v_dot2c_f32_bf16 v129, v43, v43
    v_mfma_f32_32x32x16_bf16 v[112:127], v[36:39], v[44:47], v[112:127]
    v_dot2c_f32_bf16 v130, s45, v32
    v_dot2c_f32_bf16 v130, s45, v33
    v_dot2c_f32_bf16 v130, s45, v34
    v_dot2c_f32_bf16 v130, s45, v35
    s_waitcnt lgkmcnt(0)
    v_mfma_f32_32x32x16_bf16 v[64:79], v[48:51], v[56:59], v[64:79]
    ds_read_b64_tr_b16 v[32:33], v3 offset:8192
    ds_read_b64_tr_b16 v[34:35], v3 offset:9216
    ds_read_b64_tr_b16 v[36:37], v5 offset:8192
    v_mfma_f32_32x32x16_bf16 v[80:95], v[48:51], v[60:63], v[80:95]
    ds_read_b64_tr_b16 v[38:39], v5 offset:9216
    v_xor_b32 v22, 64, v7
    ds_read_b128 v[40:43], v22 offset:16384
    v_xor_b32 v23, 64, v9
    ds_read_b128 v[44:47], v23 offset:16384
    v_dot2c_f32_bf16 v128, s45, v56
    v_dot2c_f32_bf16 v128, s45, v57
    v_dot2c_f32_bf16 v128, s45, v58
    v_dot2c_f32_bf16 v128, s45, v59
    v_mfma_f32_32x32x16_bf16 v[96:111], v[52:55], v[56:59], v[96:111]
    v_dot2c_f32_bf16 v129, v56, v56
    v_dot2c_f32_bf16 v129, v57, v57
    v_dot2c_f32_bf16 v129, v58, v58
    v_dot2c_f32_bf16 v129, v59, v59
    v_mfma_f32_32x32x16_bf16 v[112:127], v[52:55], v[60:63], v[112:127]
    v_dot2c_f32_bf16 v130, s45, v48
    v_dot2c_f32_bf16 v130, s45, v49
    v_dot2c_f32_bf16 v130, s45, v50
    v_dot2c_f32_bf16 v130, s45, v51
    s_waitcnt lgkmcnt(0)
    v_mfma_f32_32x32x16_bf16 v[64:79], v[32:35], v[40:43], v[64:79]
    ds_read_b64_tr_b16 v[48:49], v3 offset:12288
    ds_read_b64_tr_b16 v[50:51], v3 offset:13312
    ds_read_b64_tr_b16 v[52:53], v5 offset:12288
    v_mfma_f32_32x32x16_bf16 v[80:95], v[32:35], v[44:47], v[80:95]
    ds_read_b64_tr_b16 v[54:55], v5 offset:13312
    v_xor_b32 v22, 96, v7
    ds_read_b128 v[56:59], v22 offset:16384
    v_xor_b32 v23, 96, v9
    ds_read_b128 v[60:63], v23 offset:16384
    v_dot2c_f32_bf16 v128, s45, v40
    v_dot2c_f32_bf16 v128, s45, v41
    v_dot2c_f32_bf16 v128, s45, v42
    v_dot2c_f32_bf16 v128, s45, v43
    v_mfma_f32_32x32x16_bf16 v[96:111], v[36:39], v[40:43], v[96:111]
    v_dot2c_f32_bf16 v129, v40, v40
    v_dot2c_f32_bf16 v129, v41, v41
    v_dot2c_f32_bf16 v129, v42, v42
    v_dot2c_f32_bf16 v129, v43, v43
    v_mfma_f32_32x32x16_bf16 v[112:127], v[36:39], v[44:47], v[112:127]
    v_dot2c_f32_bf16 v130, s45, v32
    v_dot2c_f32_bf16 v130, s45, v33
    v_dot2c_f32_bf16 v130, s45, v34
    v_dot2c_f32_bf16 v130, s45, v35
    s_waitcnt lgkmcnt(0)
    s_barrier
    v_mfma_f32_32x32x16_bf16 v[64:79], v[48:51], v[56:59], v[64:79]
    ds_read_b64_tr_b16 v[32:33], v3 offset:32768
    ds_read_b64_tr_b16 v[34:35], v3 offset:33792
    ds_read_b64_tr_b16 v[36:37], v5 offset:32768
    v_mfma_f32_32x32x16_bf16 v[80:95], v[48:51], v[60:63], v[80:95]
    ds_read_b64_tr_b16 v[38:39], v5 offset:33792
    v_xor_b32 v22, 0, v7
    ds_read_b128 v[40:43], v22 offset:49152
    v_xor_b32 v23, 0, v9
    ds_read_b128 v[44:47], v23 offset:49152
    v_dot2c_f32_bf16 v128, s45, v56
    v_dot2c_f32_bf16 v128, s45, v57
    v_dot2c_f32_bf16 v128, s45, v58
    v_dot2c_f32_bf16 v128, s45, v59
    v_mfma_f32_32x32x16_bf16 v[96:111], v[52:55], v[56:59], v[96:111]
    v_dot2c_f32_bf16 v129, v56, v56
    v_dot2c_f32_bf16 v129, v57, v57
    v_dot2c_f32_bf16 v129, v58, v58
    v_dot2c_f32_bf16 v129, v59, v59
    v_mfma_f32_32x32x16_bf16 v[112:127], v[52:55], v[60:63], v[112:127]
    v_dot2c_f32_bf16 v130, s45, v48
    v_dot2c_f32_bf16 v130, s45, v49
    v_dot2c_f32_bf16 v130, s45, v50
    v_dot2c_f32_bf16 v130, s45, v51
    s_waitcnt lgkmcnt(0)
    v_mfma_f32_32x32x16_bf16 v[64:79], v[32:35], v[40:43], v[64:79]
    ds_read_b64_tr_b16 v[48:49], v3 offset:36864
    ds_read_b64_tr_b16 v[50:51], v3 offset:37888
    ds_read_b64_tr_b16 v[52:53], v5 offset:36864
    v_mfma_f32_32x32x16_bf16 v[80:95], v[32:35], v[44:47], v[80:95]
    ds_read_b64_tr_b16 v[54:55], v5 offset:37888
    v_xor_b32 v22, 32, v7
    ds_read_b128 v[56:59], v22 offset:49152
    v_xor_b32 v23, 32, v9
    ds_read_b128 v[60:63], v23 offset:49152
    v_dot2c_f32_bf16 v128, s45, v40
    v_dot2c_f32_bf16 v128, s45, v41
    v_dot2c_f32_bf16 v128, s45, v42
    v_dot2c_f32_bf16 v128, s45, v43
    v_mfma_f32_32x32x16_bf16 v[96:111], v[36:39], v[40:43], v[96:111]
    v_dot2c_f32_bf16 v129, v40, v40
    v_dot2c_f32_bf16 v129, v41, v41
    v_dot2c_f32_bf16 v129, v42, v42
    v_dot2c_f32_bf16 v129, v43, v43
    v_mfma_f32_32x32x16_bf16 v[112:127], v[36:39], v[44:47], v[112:127]
    v_dot2c_f32_bf16 v130, s45, v32
    v_dot2c_f32_bf16 v130, s45, v33
    v_dot2c_f32_bf16 v130, s45, v34
    v_dot2c_f32_bf16 v130, s45, v35
    s_waitcnt lgkmcnt(0)
    v_mfma_f32_32x32x16_bf16 v[64:79], v[48:51], v[56:59], v[64:79]
    ds_read_b64_tr_b16 v[32:33], v3 offset:40960
    ds_read_b64_tr_b16 v[34:35], v3 offset:41984
    ds_read_b64_tr_b16 v[36:37], v5 offset:40960
    v_mfma_f32_32x32x16_bf16 v[80:95], v[48:51], v[60:63], v[80:95]
    ds_read_b64_tr_b16 v[38:39], v5 offset:41984
    v_xor_b32 v22, 64, v7
    ds_read_b128 v[40:43], v22 offset:49152
    v_xor_b32 v23, 64, v9
    ds_read_b128 v[44:47], v23 offset:49152
    v_dot2c_f32_bf16 v128, s45, v56
    v_dot2c_f32_bf16 v128, s45, v57
    v_dot2c_f32_bf16 v128, s45, v58
    v_dot2c_f32_bf16 v128, s45, v59
    v_mfma_f32_32x32x16_bf16 v[96:111], v[52:55], v[56:59], v[96:111]
    v_dot2c_f32_bf16 v129, v56, v56
    v_dot2c_f32_bf16 v129, v57, v57
    v_dot2c_f32_bf16 v129, v58, v58
    v_dot2c_f32_bf16 v129, v59, v59
    v_mfma_f32_32x32x16_bf16 v[112:127], v[52:55], v[60:63], v[112:127]
    v_dot2c_f32_bf16 v130, s45, v48
    v_dot2c_f32_bf16 v130, s45, v49
    v_dot2c_f32_bf16 v130, s45, v50
    v_dot2c_f32_bf16 v130, s45, v51
    s_waitcnt lgkmcnt(0)
    v_mfma_f32_32x32x16_bf16 v[64:79], v[32:35], v[40:43], v[64:79]
    ds_read_b64_tr_b16 v[48:49], v3 offset:45056
    ds_read_b64_tr_b16 v[50:51], v3 offset:46080
    ds_read_b64_tr_b16 v[52:53], v5 offset:45056
    v_mfma_f32_32x32x16_bf16 v[80:95], v[32:35], v[44:47], v[80:95]
    ds_read_b64_tr_b16 v[54:55], v5 offset:46080
    v_xor_b32 v22, 96, v7
    ds_read_b128 v[56:59], v22 offset:49152
    v_xor_b32 v23, 96, v9
    ds_read_b128 v[60:63], v23 offset:49152
    v_dot2c_f32_bf16 v128, s45, v40
    v_dot2c_f32_bf16 v128, s45, v41
    v_dot2c_f32_bf16 v128, s45, v42
    v_dot2c_f32_bf16 v128, s45, v43
    v_mfma_f32_32x32x16_bf16 v[96:111], v[36:39], v[40:43], v[96:111]
    v_dot2c_f32_bf16 v129, v40, v40
    v_dot2c_f32_bf16 v129, v41, v41
    v_dot2c_f32_bf16 v129, v42, v42
    v_dot2c_f32_bf16 v129, v43, v43
    v_mfma_f32_32x32x16_bf16 v[112:127], v[36:39], v[44:47], v[112:127]
    v_dot2c_f32_bf16 v130, s45, v32
    v_dot2c_f32_bf16 v130, s45, v33
    v_dot2c_f32_bf16 v130, s45, v34
    v_dot2c_f32_bf16 v130, s45, v35
    s_waitcnt lgkmcnt(0)
    s_barrier
    v_mfma_f32_32x32x16_bf16 v[64:79], v[48:51], v[56:59], v[64:79]
    ds_read_b64_tr_b16 v[32:33], v26 offset:0
    ds_read_b64_tr_b16 v[34:35], v26 offset:1024
    ds_read_b64_tr_b16 v[36:37], v27 offset:0
    v_mfma_f32_32x32x16_bf16 v[80:95], v[48:51], v[60:63], v[80:95]
    ds_read_b64_tr_b16 v[38:39], v27 offset:1024
    v_xor_b32 v22, 0, v28
    ds_read_b128 v[40:43], v22 offset:16384
    v_xor_b32 v23, 0, v29
    ds_read_b128 v[44:47], v23 offset:16384
    v_dot2c_f32_bf16 v128, s45, v56
    v_dot2c_f32_bf16 v128, s45, v57
    v_dot2c_f32_bf16 v128, s45, v58
    v_dot2c_f32_bf16 v128, s45, v59
    v_mfma_f32_32x32x16_bf16 v[96:111], v[52:55], v[56:59], v[96:111]
    v_dot2c_f32_bf16 v129, v56, v56
    v_dot2c_f32_bf16 v129, v57, v57
    v_dot2c_f32_bf16 v129, v58, v58
    v_dot2c_f32_bf16 v129, v59, v59
    v_mfma_f32_32x32x16_bf16 v[112:127], v[52:55], v[60:63], v[112:127]
    v_dot2c_f32_bf16 v130, s45, v48
    v_dot2c_f32_bf16 v130, s45, v49
    v_dot2c_f32_bf16 v130, s45, v50
    v_dot2c_f32_bf16 v130, s45, v51
    s_waitcnt lgkmcnt(0)
    v_mfma_f32_32x32x16_bf16 v[64:79], v[32:35], v[40:43], v[64:79]
    ds_read_b64_tr_b16 v[48:49], v26 offset:4096
    ds_read_b64_tr_b16 v[50:51], v26 offset:5120
    ds_read_b64_tr_b16 v[52:53], v27 offset:4096
    v_mfma_f32_32x32x16_bf16 v[80:95], v[32:35], v[44:47], v[80:95]
    ds_read_b64_tr_b16 v[54:55], v27 offset:5120
    v_xor_b32 v22, 32, v28
    ds_read_b128 v[56:59], v22 offset:16384
    v_xor_b32 v23, 32, v29
    ds_read_b128 v[60:63], v23 offset:16384
    v_dot2c_f32_bf16 v128, s45, v40
    v_dot2c_f32_bf16 v128, s45, v41
    v_dot2c_f32_bf16 v128, s45, v42
    v_dot2c_f32_bf16 v128, s45, v43
    v_mfma_f32_32x32x16_bf16 v[96:111], v[36:39], v[40:43], v[96:111]
    v_dot2c_f32_bf16 v129, v40, v40
    v_dot2c_f32_bf16 v129, v41, v41
    v_dot2c_f32_bf16 v129, v42, v42
    v_dot2c_f32_bf16 v129, v43, v43
    v_mfma_f32_32x32x16_bf16 v[112:127], v[36:39], v[44:47], v[112:127]
    v_dot2c_f32_bf16 v130, s45, v32
    v_dot2c_f32_bf16 v130, s45, v33
    v_dot2c_f32_bf16 v130, s45, v34
    v_dot2c_f32_bf16 v130, s45, v35
    s_waitcnt lgkmcnt(0)
    v_mfma_f32_32x32x16_bf16 v[64:79], v[48:51], v[56:59], v[64:79]
    ds_read_b64_tr_b16 v[32:33], v26 offset:8192
    ds_read_b64_tr_b16 v[34:35], v26 offset:9216
    ds_read_b64_tr_b16 v[36:37], v27 offset:8192
    v_mfma_f32_32x32x16_bf16 v[80:95], v[48:51], v[60:63], v[80:95]
    ds_read_b64_tr_b16 v[38:39], v27 offset:9216
    v_xor_b32 v22, 64, v28
    ds_read_b128 v[40:43], v22 offset:16384
    v_xor_b32 v23, 64, v29
    ds_read_b128 v[44:47], v23 offset:16384
    v_dot2c_f32_bf16 v128, s45, v56
    v_dot2c_f32_bf16 v128, s45, v57
    v_dot2c_f32_bf16 v128, s45, v58
    v_dot2c_f32_bf16 v128, s45, v59
    v_mfma_f32_32x32x16_bf16 v[96:111], v[52:55], v[56:59], v[96:111]
    v_dot2c_f32_bf16 v129, v56, v56
    v_dot2c_f32_bf16 v129, v57, v57
    v_dot2c_f32_bf16 v129, v58, v58
    v_dot2c_f32_bf16 v129, v59, v59
    v_mfma_f32_32x32x16_bf16 v[112:127], v[52:55], v[60:63], v[112:127]
    v_dot2c_f32_bf16 v130, s45, v48
    v_dot2c_f32_bf16 v130, s45, v49
    v_dot2c_f32_bf16 v130, s45, v50
    v_dot2c_f32_bf16 v130, s45, v51
    s_waitcnt lgkmcnt(0)
    v_mfma_f32_32x32x16_bf16 v[64:79], v[32:35], v[40:43], v[64:79]
    ds_read_b64_tr_b16 v[48:49], v26 offset:12288
    ds_read_b64_tr_b16 v[50:51], v26 offset:13312
    ds_read_b64_tr_b16 v[52:53], v27 offset:12288
    v_mfma_f32_32x32x16_bf16 v[80:95], v[32:35], v[44:47], v[80:95]
    ds_read_b64_tr_b16 v[54:55], v27 offset:13312
    v_xor_b32 v22, 96, v28
    ds_read_b128 v[56:59], v22 offset:16384
    v_xor_b32 v23, 96, v29
    ds_read_b128 v[60:63], v23 offset:16384
    v_dot2c_f32_bf16 v128, s45, v40
    v_dot2c_f32_bf16 v128, s45, v41
    v_dot2c_f32_bf16 v128, s45, v42
    v_dot2c_f32_bf16 v128, s45, v43
    v_mfma_f32_32x32x16_bf16 v[96:111], v[36:39], v[40:43], v[96:111]
    v_dot2c_f32_bf16 v129, v40, v40
    v_dot2c_f32_bf16 v129, v41, v41
    v_dot2c_f32_bf16 v129, v42, v42
    v_dot2c_f32_bf16 v129, v43, v43
    v_mfma_f32_32x32x16_bf16 v[112:127], v[36:39], v[44:47], v[112:127]
    v_dot2c_f32_bf16 v130, s45, v32
    v_dot2c_f32_bf16 v130, s45, v33
    v_dot2c_f32_bf16 v130, s45, v34
    v_dot2c_f32_bf16 v130, s45, v35
    s_waitcnt lgkmcnt(0)
    s_barrier
    v_mfma_f32_32x32x16_bf16 v[64:79], v[48:51], v[56:59], v[64:79]
    ds_read_b64_tr_b16 v[32:33], v2 offset:0
    ds_read_b64_tr_b16 v[34:35], v2 offset:1024
    ds_read_b64_tr_b16 v[36:37], v4 offset:0
    v_mfma_f32_32x32x16_bf16 v[80:95], v[48:51], v[60:63], v[80:95]
    ds_read_b64_tr_b16 v[38:39], v4 offset:1024
    v_xor_b32 v22, 0, v6
    ds_read_b128 v[40:43], v22 offset:16384
    v_xor_b32 v23, 0, v8
    ds_read_b128 v[44:47], v23 offset:16384
    v_dot2c_f32_bf16 v128, s45, v56
    v_dot2c_f32_bf16 v128, s45, v57
    v_dot2c_f32_bf16 v128, s45, v58
    v_dot2c_f32_bf16 v128, s45, v59
    v_mfma_f32_32x32x16_bf16 v[96:111], v[52:55], v[56:59], v[96:111]
    v_dot2c_f32_bf16 v129, v56, v56
    v_dot2c_f32_bf16 v129, v57, v57
    v_dot2c_f32_bf16 v129, v58, v58
    v_dot2c_f32_bf16 v129, v59, v59
    v_mfma_f32_32x32x16_bf16 v[112:127], v[52:55], v[60:63], v[112:127]
    v_dot2c_f32_bf16 v130, s45, v48
    v_dot2c_f32_bf16 v130, s45, v49
    v_dot2c_f32_bf16 v130, s45, v50
    v_dot2c_f32_bf16 v130, s45, v51
    s_waitcnt lgkmcnt(0)
    v_mfma_f32_32x32x16_bf16 v[64:79], v[32:35], v[40:43], v[64:79]
    ds_read_b64_tr_b16 v[48:49], v2 offset:4096
    ds_read_b64_tr_b16 v[50:51], v2 offset:5120
    ds_read_b64_tr_b16 v[52:53], v4 offset:4096
    v_mfma_f32_32x32x16_bf16 v[80:95], v[32:35], v[44:47], v[80:95]
    ds_read_b64_tr_b16 v[54:55], v4 offset:5120
    v_xor_b32 v22, 32, v6
    ds_read_b128 v[56:59], v22 offset:16384
    v_xor_b32 v23, 32, v8
    ds_read_b128 v[60:63], v23 offset:16384
    v_dot2c_f32_bf16 v128, s45, v40
    v_dot2c_f32_bf16 v128, s45, v41
    v_dot2c_f32_bf16 v128, s45, v42
    v_dot2c_f32_bf16 v128, s45, v43
    v_mfma_f32_32x32x16_bf16 v[96:111], v[36:39], v[40:43], v[96:111]
    v_dot2c_f32_bf16 v129, v40, v40
    v_dot2c_f32_bf16 v129, v41, v41
    v_dot2c_f32_bf16 v129, v42, v42
    v_dot2c_f32_bf16 v129, v43, v43
    v_mfma_f32_32x32x16_bf16 v[112:127], v[36:39], v[44:47], v[112:127]
    v_dot2c_f32_bf16 v130, s45, v32
    v_dot2c_f32_bf16 v130, s45, v33
    v_dot2c_f32_bf16 v130, s45, v34
    v_dot2c_f32_bf16 v130, s45, v35
    s_waitcnt lgkmcnt(0)
    v_mfma_f32_32x32x16_bf16 v[64:79], v[48:51], v[56:59], v[64:79]
    ds_read_b64_tr_b16 v[32:33], v2 offset:8192
    ds_read_b64_tr_b16 v[34:35], v2 offset:9216
    ds_read_b64_tr_b16 v[36:37], v4 offset:8192
    v_mfma_f32_32x32x16_bf16 v[80:95], v[48:51], v[60:63], v[80:95]
    ds_read_b64_tr_b16 v[38:39], v4 offset:9216
    v_xor_b32 v22, 64, v6
    ds_read_b128 v[40:43], v22 offset:16384
    v_xor_b32 v23, 64, v8
    ds_read_b128 v[44:47], v23 offset:16384
    v_dot2c_f32_bf16 v128, s45, v56
    v_dot2c_f32_bf16 v128, s45, v57
    v_dot2c_f32_bf16 v128, s45, v58
    v_dot2c_f32_bf16 v128, s45, v59
    v_mfma_f32_32x32x16_bf16 v[96:111], v[52:55], v[56:59], v[96:111]
    v_dot2c_f32_bf16 v129, v56, v56
    v_dot2c_f32_bf16 v129, v57, v57
    v_dot2c_f32_bf16 v129, v58, v58
    v_dot2c_f32_bf16 v129, v59, v59
    v_mfma_f32_32x32x16_bf16 v[112:127], v[52:55], v[60:63], v[112:127]
    v_dot2c_f32_bf16 v130, s45, v48
    v_dot2c_f32_bf16 v130, s45, v49
    v_dot2c_f32_bf16 v130, s45, v50
    v_dot2c_f32_bf16 v130, s45, v51
    s_waitcnt lgkmcnt(0)
    v_mfma_f32_32x32x16_bf16 v[64:79], v[32:35], v[40:43], v[64:79]
    ds_read_b64_tr_b16 v[48:49], v2 offset:12288
    ds_read_b64_tr_b16 v[50:51], v2 offset:13312
    ds_read_b64_tr_b16 v[52:53], v4 offset:12288
    v_mfma_f32_32x32x16_bf16 v[80:95], v[32:35], v[44:47], v[80:95]
    ds_read_b64_tr_b16 v[54:55], v4 offset:13312
    v_xor_b32 v22, 96, v6
    ds_read_b128 v[56:59], v22 offset:16384
    v_xor_b32 v23, 96, v8
    ds_read_b128 v[60:63], v23 offset:16384
    v_dot2c_f32_bf16 v128, s45, v40
    v_dot2c_f32_bf16 v128, s45, v41
    v_dot2c_f32_bf16 v128, s45, v42
    v_dot2c_f32_bf16 v128, s45, v43
    v_mfma_f32_32x32x16_bf16 v[96:111], v[36:39], v[40:43], v[96:111]
    v_dot2c_f32_bf16 v129, v40, v40
    v_dot2c_f32_bf16 v129, v41, v41
    v_dot2c_f32_bf16 v129, v42, v42
    v_dot2c_f32_bf16 v129, v43, v43
    v_mfma_f32_32x32x16_bf16 v[112:127], v[36:39], v[44:47], v[112:127]
    v_dot2c_f32_bf16 v130, s45, v32
    v_dot2c_f32_bf16 v130, s45, v33
    v_dot2c_f32_bf16 v130, s45, v34
    v_dot2c_f32_bf16 v130, s45, v35
    s_waitcnt lgkmcnt(0)
    s_barrier
    v_mfma_f32_32x32x16_bf16 v[64:79], v[48:51], v[56:59], v[64:79]
    ds_read_b64_tr_b16 v[32:33], v2 offset:32768
    ds_read_b64_tr_b16 v[34:35], v2 offset:33792
    ds_read_b64_tr_b16 v[36:37], v4 offset:32768
    v_mfma_f32_32x32x16_bf16 v[80:95], v[48:51], v[60:63], v[80:95]
    ds_read_b64_tr_b16 v[38:39], v4 offset:33792
    v_xor_b32 v22, 0, v6
    ds_read_b128 v[40:43], v22 offset:49152
    v_xor_b32 v23, 0, v8
    ds_read_b128 v[44:47], v23 offset:49152
    v_dot2c_f32_bf16 v128, s45, v56
    v_dot2c_f32_bf16 v128, s45, v57
    v_dot2c_f32_bf16 v128, s45, v58
    v_dot2c_f32_bf16 v128, s45, v59
    v_mfma_f32_32x32x16_bf16 v[96:111], v[52:55], v[56:59], v[96:111]
    v_dot2c_f32_bf16 v129, v56, v56
    v_dot2c_f32_bf16 v129, v57, v57
    v_dot2c_f32_bf16 v129, v58, v58
    v_dot2c_f32_bf16 v129, v59, v59
    v_mfma_f32_32x32x16_bf16 v[112:127], v[52:55], v[60:63], v[112:127]
    v_dot2c_f32_bf16 v130, s45, v48
    v_dot2c_f32_bf16 v130, s45, v49
    v_dot2c_f32_bf16 v130, s45, v50
    v_dot2c_f32_bf16 v130, s45, v51
    s_waitcnt lgkmcnt(0)
    v_mfma_f32_32x32x16_bf16 v[64:79], v[32:35], v[40:43], v[64:79]
    ds_read_b64_tr_b16 v[48:49], v2 offset:36864
    ds_read_b64_tr_b16 v[50:51], v2 offset:37888
    ds_read_b64_tr_b16 v[52:53], v4 offset:36864
    v_mfma_f32_32x32x16_bf16 v[80:95], v[32:35], v[44:47], v[80:95]
    ds_read_b64_tr_b16 v[54:55], v4 offset:37888
    v_xor_b32 v22, 32, v6
    ds_read_b128 v[56:59], v22 offset:49152
    v_xor_b32 v23, 32, v8
    ds_read_b128 v[60:63], v23 offset:49152
    v_dot2c_f32_bf16 v128, s45, v40
    v_dot2c_f32_bf16 v128, s45, v41
    v_dot2c_f32_bf16 v128, s45, v42
    v_dot2c_f32_bf16 v128, s45, v43
    v_mfma_f32_32x32x16_bf16 v[96:111], v[36:39], v[40:43], v[96:111]
    v_dot2c_f32_bf16 v129, v40, v40
    v_dot2c_f32_bf16 v129, v41, v41
    v_dot2c_f32_bf16 v129, v42, v42
    v_dot2c_f32_bf16 v129, v43, v43
    v_mfma_f32_32x32x16_bf16 v[112:127], v[36:39], v[44:47], v[112:127]
    v_dot2c_f32_bf16 v130, s45, v32
    v_dot2c_f32_bf16 v130, s45, v33
    v_dot2c_f32_bf16 v130, s45, v34
    v_dot2c_f32_bf16 v130, s45, v35
    s_waitcnt lgkmcnt(0)
    v_mfma_f32_32x32x16_bf16 v[64:79], v[48:51], v[56:59], v[64:79]
    ds_read_b64_tr_b16 v[32:33], v2 offset:40960
    ds_read_b64_tr_b16 v[34:35], v2 offset:41984
    ds_read_b64_tr_b16 v[36:37], v4 offset:40960
    v_mfma_f32_32x32x16_bf16 v[80:95], v[48:51], v[60:63], v[80:95]
    ds_read_b64_tr_b16 v[38:39], v4 offset:41984
    v_xor_b32 v22, 64, v6
    ds_read_b128 v[40:43], v22 offset:49152
    v_xor_b32 v23, 64, v8
    ds_read_b128 v[44:47], v23 offset:49152
    v_dot2c_f32_bf16 v128, s45, v56
    v_dot2c_f32_bf16 v128, s45, v57
    v_dot2c_f32_bf16 v128, s45, v58
    v_dot2c_f32_bf16 v128, s45, v59
    v_mfma_f32_32x32x16_bf16 v[96:111], v[52:55], v[56:59], v[96:111]
    v_dot2c_f32_bf16 v129, v56, v56
    v_dot2c_f32_bf16 v129, v57, v57
    v_dot2c_f32_bf16 v129, v58, v58
    v_dot2c_f32_bf16 v129, v59, v59
    v_mfma_f32_32x32x16_bf16 v[112:127], v[52:55], v[60:63], v[112:127]
    v_dot2c_f32_bf16 v130, s45, v48
    v_dot2c_f32_bf16 v130, s45, v49
    v_dot2c_f32_bf16 v130, s45, v50
    v_dot2c_f32_bf16 v130, s45, v51
    s_waitcnt lgkmcnt(0)
    v_mfma_f32_32x32x16_bf16 v[64:79], v[32:35], v[40:43], v[64:79]
    ds_read_b64_tr_b16 v[48:49], v2 offset:45056
    ds_read_b64_tr_b16 v[50:51], v2 offset:46080
    ds_read_b64_tr_b16 v[52:53], v4 offset:45056
    v_mfma_f32_32x32x16_bf16 v[80:95], v[32:35], v[44:47], v[80:95]
    ds_read_b64_tr_b16 v[54:55], v4 offset:46080
    v_xor_b32 v22, 96, v6
    ds_read_b128 v[56:59], v22 offset:49152
    v_xor_b32 v23, 96, v8
    ds_read_b128 v[60:63], v23 offset:49152
    v_dot2c_f32_bf16 v128, s45, v40
    v_dot2c_f32_bf16 v128, s45, v41
    v_dot2c_f32_bf16 v128, s45, v42
    v_dot2c_f32_bf16 v128, s45, v43
    v_mfma_f32_32x32x16_bf16 v[96:111], v[36:39], v[40:43], v[96:111]
    v_dot2c_f32_bf16 v129, v40, v40
    v_dot2c_f32_bf16 v129, v41, v41
    v_dot2c_f32_bf16 v129, v42, v42
    v_dot2c_f32_bf16 v129, v43, v43
    v_mfma_f32_32x32x16_bf16 v[112:127], v[36:39], v[44:47], v[112:127]
    v_dot2c_f32_bf16 v130, s45, v32
    v_dot2c_f32_bf16 v130, s45, v33
    v_dot2c_f32_bf16 v130, s45, v34
    v_dot2c_f32_bf16 v130, s45, v35
    s_waitcnt lgkmcnt(0)
    v_mfma_f32_32x32x16_bf16 v[64:79], v[48:51], v[56:59], v[64:79]
    v_mfma_f32_32x32x16_bf16 v[80:95], v[48:51], v[60:63], v[80:95]
    v_dot2c_f32_bf16 v128, s45, v56
    v_dot2c_f32_bf16 v128, s45, v57
    v_dot2c_f32_bf16 v128, s45, v58
    v_dot2c_f32_bf16 v128, s45, v59
    v_mfma_f32_32x32x16_bf16 v[96:111], v[52:55], v[56:59], v[96:111]
    v_dot2c_f32_bf16 v129, v56, v56
    v_dot2c_f32_bf16 v129, v57, v57
    v_dot2c_f32_bf16 v129, v58, v58
    v_dot2c_f32_bf16 v129, v59, v59
    v_mfma_f32_32x32x16_bf16 v[112:127], v[52:55], v[60:63], v[112:127]
    v_dot2c_f32_bf16 v130, s45, v48
    v_dot2c_f32_bf16 v130, s45, v49
    v_dot2c_f32_bf16 v130, s45, v50
    v_dot2c_f32_bf16 v130, s45, v51
    s_nop 3
    v_mov_b32 v148, v128
    s_nop 1
    v_permlane32_swap_b32 v128, v148
    s_nop 1
    v_add_f32 v128, v128, v148
    v_mov_b32 v148, v129
    s_nop 1
    v_permlane32_swap_b32 v129, v148
    s_nop 1
    v_add_f32 v129, v129, v148
    v_mov_b32 v148, v130
    s_nop 1
    v_permlane32_swap_b32 v130, v148
    s_nop 1
    v_add_f32 v130, v130, v148
    s_mov_b32 s29, 0x3b124925
    v_mul_f32 v128, s29, v128
    v_mul_f32 v129, s29, v129
    v_fma_f32 v129, -v128, v128, v129
    v_max_f32 v129, 0, v129
    v_add_f32 v129, 0x3727c5ac, v129
    v_rsq_f32 v129, v129
    s_nop 0
    v_mul_f32 v128, v128, v129
    s_lshl_b32 s29, s50, 7
    s_add_u32 s29, s29, 0
    v_lshlrev_b32 v16, 2, v15
    v_add_u32 v17, s29, v16
    ds_write_b32 v17, v129
    ds_write_b32 v17, v128 offset:512
    s_lshl_b32 s29, s48, 7
    s_add_u32 s29, s29, 0
    v_add_u32 v17, s29, v16
    ds_write_b32 v17, v130 offset:1024
    s_waitcnt lgkmcnt(0)
    s_barrier
    v_lshlrev_b32 v18, 4, v12
    v_lshlrev_b32 v24, 4, v0
    s_lshl_b32 s29, s50, 7
    s_add_u32 s29, s29, 0
    v_add_u32 v17, s29, v16
    s_lshl_b32 s29, s48, 7
    s_add_u32 s29, s29, 0
    v_add_u32 v19, s29, v18
    ds_read_b32 v148, v17
    ds_read_b32 v149, v17 offset:512
    ds_read_b128 v[152:155], v19 offset:1024
    ds_read_b128 v[156:159], v19 offset:1056
    ds_read_b128 v[160:163], v19 offset:1088
    ds_read_b128 v[164:167], v19 offset:1120
    s_waitcnt lgkmcnt(0)
    v_mul_f32 v148, s54, v148
    v_mul_f32 v149, s54, v149
    v_mul_f32 v152, v149, v152
    v_fma_f32 v64, v64, v148, -v152
    v_mul_f32 v153, v149, v153
    v_fma_f32 v65, v65, v148, -v153
    v_mul_f32 v154, v149, v154
    v_fma_f32 v66, v66, v148, -v154
    v_mul_f32 v155, v149, v155
    v_fma_f32 v67, v67, v148, -v155
    v_mul_f32 v156, v149, v156
    v_fma_f32 v68, v68, v148, -v156
    v_mul_f32 v157, v149, v157
    v_fma_f32 v69, v69, v148, -v157
    v_mul_f32 v158, v149, v158
    v_fma_f32 v70, v70, v148, -v158
    v_mul_f32 v159, v149, v159
    v_fma_f32 v71, v71, v148, -v159
    v_mul_f32 v160, v149, v160
    v_fma_f32 v72, v72, v148, -v160
    v_mul_f32 v161, v149, v161
    v_fma_f32 v73, v73, v148, -v161
    v_mul_f32 v162, v149, v162
    v_fma_f32 v74, v74, v148, -v162
    v_mul_f32 v163, v149, v163
    v_fma_f32 v75, v75, v148, -v163
    v_mul_f32 v164, v149, v164
    v_fma_f32 v76, v76, v148, -v164
    v_mul_f32 v165, v149, v165
    v_fma_f32 v77, v77, v148, -v165
    v_mul_f32 v166, v149, v166
    v_fma_f32 v78, v78, v148, -v166
    v_mul_f32 v167, v149, v167
    v_fma_f32 v79, v79, v148, -v167
    v_cndmask_b32 v76, v76, 0, s[46:47]
    v_cndmask_b32 v77, v77, 0, s[46:47]
    v_cndmask_b32 v78, v78, 0, s[46:47]
    v_cndmask_b32 v79, v79, 0, s[46:47]
    s_lshl_b32 s29, s26, 2
    s_add_u32 s29, s29, s48
    s_lshl_b32 s29, s29, 6
    s_lshl_b32 s30, s25, 2
    s_add_u32 s29, s29, s30
    s_add_u32 s29, s29, s50
    s_lshl_b32 s55, s29, 11
    v_cvt_pk_bf16_f32 v188, v64, v65
    v_cvt_pk_bf16_f32 v189, v66, v67
    v_cvt_pk_bf16_f32 v190, v68, v69
    v_cvt_pk_bf16_f32 v191, v70, v71
    v_cvt_pk_bf16_f32 v192, v72, v73
    v_cvt_pk_bf16_f32 v193, v74, v75
    v_cvt_pk_bf16_f32 v194, v76, v77
    v_cvt_pk_bf16_f32 v195, v78, v79
    buffer_store_dwordx4 v[188:191], v24, s[12:15], s55 offen
    buffer_store_dwordx4 v[192:195], v24, s[12:15], s55 offen offset:1024
    s_lshl_b32 s29, s51, 7
    s_add_u32 s29, s29, 0
    v_add_u32 v17, s29, v16
    s_lshl_b32 s29, s48, 7
    s_add_u32 s29, s29, 0
    v_add_u32 v19, s29, v18
    ds_read_b32 v148, v17
    ds_read_b32 v149, v17 offset:512
    ds_read_b128 v[152:155], v19 offset:1024
    ds_read_b128 v[156:159], v19 offset:1056
    ds_read_b128 v[160:163], v19 offset:1088
    ds_read_b128 v[164:167], v19 offset:1120
    s_waitcnt lgkmcnt(0)
    v_mul_f32 v148, s54, v148
    v_mul_f32 v149, s54, v149
    v_mul_f32 v152, v149, v152
    v_fma_f32 v80, v80, v148, -v152
    v_mul_f32 v153, v149, v153
    v_fma_f32 v81, v81, v148, -v153
    v_mul_f32 v154, v149, v154
    v_fma_f32 v82, v82, v148, -v154
    v_mul_f32 v155, v149, v155
    v_fma_f32 v83, v83, v148, -v155
    v_mul_f32 v156, v149, v156
    v_fma_f32 v84, v84, v148, -v156
    v_mul_f32 v157, v149, v157
    v_fma_f32 v85, v85, v148, -v157
    v_mul_f32 v158, v149, v158
    v_fma_f32 v86, v86, v148, -v158
    v_mul_f32 v159, v149, v159
    v_fma_f32 v87, v87, v148, -v159
    v_mul_f32 v160, v149, v160
    v_fma_f32 v88, v88, v148, -v160
    v_mul_f32 v161, v149, v161
    v_fma_f32 v89, v89, v148, -v161
    v_mul_f32 v162, v149, v162
    v_fma_f32 v90, v90, v148, -v162
    v_mul_f32 v163, v149, v163
    v_fma_f32 v91, v91, v148, -v163
    v_mul_f32 v164, v149, v164
    v_fma_f32 v92, v92, v148, -v164
    v_mul_f32 v165, v149, v165
    v_fma_f32 v93, v93, v148, -v165
    v_mul_f32 v166, v149, v166
    v_fma_f32 v94, v94, v148, -v166
    v_mul_f32 v167, v149, v167
    v_fma_f32 v95, v95, v148, -v167
    v_cndmask_b32 v92, v92, 0, s[46:47]
    v_cndmask_b32 v93, v93, 0, s[46:47]
    v_cndmask_b32 v94, v94, 0, s[46:47]
    v_cndmask_b32 v95, v95, 0, s[46:47]
    s_lshl_b32 s29, s26, 2
    s_add_u32 s29, s29, s48
    s_lshl_b32 s29, s29, 6
    s_lshl_b32 s30, s25, 2
    s_add_u32 s29, s29, s30
    s_add_u32 s29, s29, s51
    s_lshl_b32 s55, s29, 11
    v_cvt_pk_bf16_f32 v188, v80, v81
    v_cvt_pk_bf16_f32 v189, v82, v83
    v_cvt_pk_bf16_f32 v190, v84, v85
    v_cvt_pk_bf16_f32 v191, v86, v87
    v_cvt_pk_bf16_f32 v192, v88, v89
    v_cvt_pk_bf16_f32 v193, v90, v91
    v_cvt_pk_bf16_f32 v194, v92, v93
    v_cvt_pk_bf16_f32 v195, v94, v95
    buffer_store_dwordx4 v[188:191], v24, s[12:15], s55 offen
    buffer_store_dwordx4 v[192:195], v24, s[12:15], s55 offen offset:1024
    s_lshl_b32 s29, s50, 7
    s_add_u32 s29, s29, 0
    v_add_u32 v17, s29, v16
    s_lshl_b32 s29, s49, 7
    s_add_u32 s29, s29, 0
    v_add_u32 v19, s29, v18
    ds_read_b32 v148, v17
    ds_read_b32 v149, v17 offset:512
    ds_read_b128 v[152:155], v19 offset:1024
    ds_read_b128 v[156:159], v19 offset:1056
    ds_read_b128 v[160:163], v19 offset:1088
    ds_read_b128 v[164:167], v19 offset:1120
    s_waitcnt lgkmcnt(0)
    v_mul_f32 v148, s54, v148
    v_mul_f32 v149, s54, v149
    v_mul_f32 v152, v149, v152
    v_fma_f32 v96, v96, v148, -v152
    v_mul_f32 v153, v149, v153
    v_fma_f32 v97, v97, v148, -v153
    v_mul_f32 v154, v149, v154
    v_fma_f32 v98, v98, v148, -v154
    v_mul_f32 v155, v149, v155
    v_fma_f32 v99, v99, v148, -v155
    v_mul_f32 v156, v149, v156
    v_fma_f32 v100, v100, v148, -v156
    v_mul_f32 v157, v149, v157
    v_fma_f32 v101, v101, v148, -v157
    v_mul_f32 v158, v149, v158
    v_fma_f32 v102, v102, v148, -v158
    v_mul_f32 v159, v149, v159
    v_fma_f32 v103, v103, v148, -v159
    v_mul_f32 v160, v149, v160
    v_fma_f32 v104, v104, v148, -v160
    v_mul_f32 v161, v149, v161
    v_fma_f32 v105, v105, v148, -v161
    v_mul_f32 v162, v149, v162
    v_fma_f32 v106, v106, v148, -v162
    v_mul_f32 v163, v149, v163
    v_fma_f32 v107, v107, v148, -v163
    v_mul_f32 v164, v149, v164
    v_fma_f32 v108, v108, v148, -v164
    v_mul_f32 v165, v149, v165
    v_fma_f32 v109, v109, v148, -v165
    v_mul_f32 v166, v149, v166
    v_fma_f32 v110, v110, v148, -v166
    v_mul_f32 v167, v149, v167
    v_fma_f32 v111, v111, v148, -v167
    v_cndmask_b32 v108, v108, 0, s[46:47]
    v_cndmask_b32 v109, v109, 0, s[46:47]
    v_cndmask_b32 v110, v110, 0, s[46:47]
    v_cndmask_b32 v111, v111, 0, s[46:47]
    s_lshl_b32 s29, s26, 2
    s_add_u32 s29, s29, s49
    s_lshl_b32 s29, s29, 6
    s_lshl_b32 s30, s25, 2
    s_add_u32 s29, s29, s30
    s_add_u32 s29, s29, s50
    s_lshl_b32 s55, s29, 11
    v_cvt_pk_bf16_f32 v188, v96, v97
    v_cvt_pk_bf16_f32 v189, v98, v99
    v_cvt_pk_bf16_f32 v190, v100, v101
    v_cvt_pk_bf16_f32 v191, v102, v103
    v_cvt_pk_bf16_f32 v192, v104, v105
    v_cvt_pk_bf16_f32 v193, v106, v107
    v_cvt_pk_bf16_f32 v194, v108, v109
    v_cvt_pk_bf16_f32 v195, v110, v111
    buffer_store_dwordx4 v[188:191], v24, s[12:15], s55 offen
    buffer_store_dwordx4 v[192:195], v24, s[12:15], s55 offen offset:1024
    s_lshl_b32 s29, s51, 7
    s_add_u32 s29, s29, 0
    v_add_u32 v17, s29, v16
    s_lshl_b32 s29, s49, 7
    s_add_u32 s29, s29, 0
    v_add_u32 v19, s29, v18
    ds_read_b32 v148, v17
    ds_read_b32 v149, v17 offset:512
    ds_read_b128 v[152:155], v19 offset:1024
    ds_read_b128 v[156:159], v19 offset:1056
    ds_read_b128 v[160:163], v19 offset:1088
    ds_read_b128 v[164:167], v19 offset:1120
    s_waitcnt lgkmcnt(0)
    v_mul_f32 v148, s54, v148
    v_mul_f32 v149, s54, v149
    v_mul_f32 v152, v149, v152
    v_fma_f32 v112, v112, v148, -v152
    v_mul_f32 v153, v149, v153
    v_fma_f32 v113, v113, v148, -v153
    v_mul_f32 v154, v149, v154
    v_fma_f32 v114, v114, v148, -v154
    v_mul_f32 v155, v149, v155
    v_fma_f32 v115, v115, v148, -v155
    v_mul_f32 v156, v149, v156
    v_fma_f32 v116, v116, v148, -v156
    v_mul_f32 v157, v149, v157
    v_fma_f32 v117, v117, v148, -v157
    v_mul_f32 v158, v149, v158
    v_fma_f32 v118, v118, v148, -v158
    v_mul_f32 v159, v149, v159
    v_fma_f32 v119, v119, v148, -v159
    v_mul_f32 v160, v149, v160
    v_fma_f32 v120, v120, v148, -v160
    v_mul_f32 v161, v149, v161
    v_fma_f32 v121, v121, v148, -v161
    v_mul_f32 v162, v149, v162
    v_fma_f32 v122, v122, v148, -v162
    v_mul_f32 v163, v149, v163
    v_fma_f32 v123, v123, v148, -v163
    v_mul_f32 v164, v149, v164
    v_fma_f32 v124, v124, v148, -v164
    v_mul_f32 v165, v149, v165
    v_fma_f32 v125, v125, v148, -v165
    v_mul_f32 v166, v149, v166
    v_fma_f32 v126, v126, v148, -v166
    v_mul_f32 v167, v149, v167
    v_fma_f32 v127, v127, v148, -v167
    v_cndmask_b32 v124, v124, 0, s[46:47]
    v_cndmask_b32 v125, v125, 0, s[46:47]
    v_cndmask_b32 v126, v126, 0, s[46:47]
    v_cndmask_b32 v127, v127, 0, s[46:47]
    s_lshl_b32 s29, s26, 2
    s_add_u32 s29, s29, s49
    s_lshl_b32 s29, s29, 6
    s_lshl_b32 s30, s25, 2
    s_add_u32 s29, s29, s30
    s_add_u32 s29, s29, s51
    s_lshl_b32 s55, s29, 11
    v_cvt_pk_bf16_f32 v188, v112, v113
    v_cvt_pk_bf16_f32 v189, v114, v115
    v_cvt_pk_bf16_f32 v190, v116, v117
    v_cvt_pk_bf16_f32 v191, v118, v119
    v_cvt_pk_bf16_f32 v192, v120, v121
    v_cvt_pk_bf16_f32 v193, v122, v123
    v_cvt_pk_bf16_f32 v194, v124, v125
    v_cvt_pk_bf16_f32 v195, v126, v127
    buffer_store_dwordx4 v[188:191], v24, s[12:15], s55 offen
    buffer_store_dwordx4 v[192:195], v24, s[12:15], s55 offen offset:1024
    s_endpgm
sequential_preLN__mha_block__dense_activation_gelu__prompt_kernel_v:
    v_add_u32 v26, 0x20000, v2
    v_add_u32 v27, 0x20000, v4
    v_add_u32 v28, 0x20000, v6
    v_add_u32 v29, 0x20000, v8
    s_barrier
    ds_read_b64_tr_b16 v[32:33], v2 offset:0
    ds_read_b64_tr_b16 v[34:35], v2 offset:1024
    ds_read_b64_tr_b16 v[36:37], v4 offset:0
    ds_read_b64_tr_b16 v[38:39], v4 offset:1024
    v_xor_b32 v22, 0, v6
    ds_read_b128 v[40:43], v22 offset:16384
    v_xor_b32 v23, 0, v8
    ds_read_b128 v[44:47], v23 offset:16384
    s_waitcnt lgkmcnt(0)
    v_mfma_f32_32x32x16_bf16 v[64:79], v[40:43], v[32:35], 0
    ds_read_b64_tr_b16 v[48:49], v2 offset:4096
    ds_read_b64_tr_b16 v[50:51], v2 offset:5120
    ds_read_b64_tr_b16 v[52:53], v4 offset:4096
    v_mfma_f32_32x32x16_bf16 v[80:95], v[44:47], v[32:35], 0
    ds_read_b64_tr_b16 v[54:55], v4 offset:5120
    v_xor_b32 v22, 32, v6
    ds_read_b128 v[56:59], v22 offset:16384
    v_xor_b32 v23, 32, v8
    ds_read_b128 v[60:63], v23 offset:16384
    v_dot2c_f32_bf16 v128, s45, v40
    v_dot2c_f32_bf16 v128, s45, v41
    v_dot2c_f32_bf16 v128, s45, v42
    v_dot2c_f32_bf16 v128, s45, v43
    v_mfma_f32_32x32x16_bf16 v[96:111], v[40:43], v[36:39], 0
    v_dot2c_f32_bf16 v129, v40, v40
    v_dot2c_f32_bf16 v129, v41, v41
    v_dot2c_f32_bf16 v129, v42, v42
    v_dot2c_f32_bf16 v129, v43, v43
    v_mfma_f32_32x32x16_bf16 v[112:127], v[44:47], v[36:39], 0
    v_dot2c_f32_bf16 v130, s45, v32
    v_dot2c_f32_bf16 v130, s45, v33
    v_dot2c_f32_bf16 v130, s45, v34
    v_dot2c_f32_bf16 v130, s45, v35
    s_waitcnt lgkmcnt(0)
    v_mfma_f32_32x32x16_bf16 v[64:79], v[56:59], v[48:51], v[64:79]
    ds_read_b64_tr_b16 v[32:33], v2 offset:8192
    ds_read_b64_tr_b16 v[34:35], v2 offset:9216
    ds_read_b64_tr_b16 v[36:37], v4 offset:8192
    v_mfma_f32_32x32x16_bf16 v[80:95], v[60:63], v[48:51], v[80:95]
    ds_read_b64_tr_b16 v[38:39], v4 offset:9216
    v_xor_b32 v22, 64, v6
    ds_read_b128 v[40:43], v22 offset:16384
    v_xor_b32 v23, 64, v8
    ds_read_b128 v[44:47], v23 offset:16384
    v_dot2c_f32_bf16 v128, s45, v56
    v_dot2c_f32_bf16 v128, s45, v57
    v_dot2c_f32_bf16 v128, s45, v58
    v_dot2c_f32_bf16 v128, s45, v59
    v_mfma_f32_32x32x16_bf16 v[96:111], v[56:59], v[52:55], v[96:111]
    v_dot2c_f32_bf16 v129, v56, v56
    v_dot2c_f32_bf16 v129, v57, v57
    v_dot2c_f32_bf16 v129, v58, v58
    v_dot2c_f32_bf16 v129, v59, v59
    v_mfma_f32_32x32x16_bf16 v[112:127], v[60:63], v[52:55], v[112:127]
    v_dot2c_f32_bf16 v130, s45, v48
    v_dot2c_f32_bf16 v130, s45, v49
    v_dot2c_f32_bf16 v130, s45, v50
    v_dot2c_f32_bf16 v130, s45, v51
    s_waitcnt lgkmcnt(0)
    v_mfma_f32_32x32x16_bf16 v[64:79], v[40:43], v[32:35], v[64:79]
    ds_read_b64_tr_b16 v[48:49], v2 offset:12288
    ds_read_b64_tr_b16 v[50:51], v2 offset:13312
    ds_read_b64_tr_b16 v[52:53], v4 offset:12288
    v_mfma_f32_32x32x16_bf16 v[80:95], v[44:47], v[32:35], v[80:95]
    ds_read_b64_tr_b16 v[54:55], v4 offset:13312
    v_xor_b32 v22, 96, v6
    ds_read_b128 v[56:59], v22 offset:16384
    v_xor_b32 v23, 96, v8
    ds_read_b128 v[60:63], v23 offset:16384
    v_dot2c_f32_bf16 v128, s45, v40
    v_dot2c_f32_bf16 v128, s45, v41
    v_dot2c_f32_bf16 v128, s45, v42
    v_dot2c_f32_bf16 v128, s45, v43
    v_mfma_f32_32x32x16_bf16 v[96:111], v[40:43], v[36:39], v[96:111]
    v_dot2c_f32_bf16 v129, v40, v40
    v_dot2c_f32_bf16 v129, v41, v41
    v_dot2c_f32_bf16 v129, v42, v42
    v_dot2c_f32_bf16 v129, v43, v43
    v_mfma_f32_32x32x16_bf16 v[112:127], v[44:47], v[36:39], v[112:127]
    v_dot2c_f32_bf16 v130, s45, v32
    v_dot2c_f32_bf16 v130, s45, v33
    v_dot2c_f32_bf16 v130, s45, v34
    v_dot2c_f32_bf16 v130, s45, v35
    s_waitcnt lgkmcnt(0)
    s_barrier
    v_mfma_f32_32x32x16_bf16 v[64:79], v[56:59], v[48:51], v[64:79]
    ds_read_b64_tr_b16 v[32:33], v2 offset:32768
    ds_read_b64_tr_b16 v[34:35], v2 offset:33792
    ds_read_b64_tr_b16 v[36:37], v4 offset:32768
    v_mfma_f32_32x32x16_bf16 v[80:95], v[60:63], v[48:51], v[80:95]
    ds_read_b64_tr_b16 v[38:39], v4 offset:33792
    v_xor_b32 v22, 0, v6
    ds_read_b128 v[40:43], v22 offset:49152
    v_xor_b32 v23, 0, v8
    ds_read_b128 v[44:47], v23 offset:49152
    v_dot2c_f32_bf16 v128, s45, v56
    v_dot2c_f32_bf16 v128, s45, v57
    v_dot2c_f32_bf16 v128, s45, v58
    v_dot2c_f32_bf16 v128, s45, v59
    v_mfma_f32_32x32x16_bf16 v[96:111], v[56:59], v[52:55], v[96:111]
    v_dot2c_f32_bf16 v129, v56, v56
    v_dot2c_f32_bf16 v129, v57, v57
    v_dot2c_f32_bf16 v129, v58, v58
    v_dot2c_f32_bf16 v129, v59, v59
    v_mfma_f32_32x32x16_bf16 v[112:127], v[60:63], v[52:55], v[112:127]
    v_dot2c_f32_bf16 v130, s45, v48
    v_dot2c_f32_bf16 v130, s45, v49
    v_dot2c_f32_bf16 v130, s45, v50
    v_dot2c_f32_bf16 v130, s45, v51
    s_waitcnt lgkmcnt(0)
    v_mfma_f32_32x32x16_bf16 v[64:79], v[40:43], v[32:35], v[64:79]
    ds_read_b64_tr_b16 v[48:49], v2 offset:36864
    ds_read_b64_tr_b16 v[50:51], v2 offset:37888
    ds_read_b64_tr_b16 v[52:53], v4 offset:36864
    v_mfma_f32_32x32x16_bf16 v[80:95], v[44:47], v[32:35], v[80:95]
    ds_read_b64_tr_b16 v[54:55], v4 offset:37888
    v_xor_b32 v22, 32, v6
    ds_read_b128 v[56:59], v22 offset:49152
    v_xor_b32 v23, 32, v8
    ds_read_b128 v[60:63], v23 offset:49152
    v_dot2c_f32_bf16 v128, s45, v40
    v_dot2c_f32_bf16 v128, s45, v41
    v_dot2c_f32_bf16 v128, s45, v42
    v_dot2c_f32_bf16 v128, s45, v43
    v_mfma_f32_32x32x16_bf16 v[96:111], v[40:43], v[36:39], v[96:111]
    v_dot2c_f32_bf16 v129, v40, v40
    v_dot2c_f32_bf16 v129, v41, v41
    v_dot2c_f32_bf16 v129, v42, v42
    v_dot2c_f32_bf16 v129, v43, v43
    v_mfma_f32_32x32x16_bf16 v[112:127], v[44:47], v[36:39], v[112:127]
    v_dot2c_f32_bf16 v130, s45, v32
    v_dot2c_f32_bf16 v130, s45, v33
    v_dot2c_f32_bf16 v130, s45, v34
    v_dot2c_f32_bf16 v130, s45, v35
    s_waitcnt lgkmcnt(0)
    v_mfma_f32_32x32x16_bf16 v[64:79], v[56:59], v[48:51], v[64:79]
    ds_read_b64_tr_b16 v[32:33], v2 offset:40960
    ds_read_b64_tr_b16 v[34:35], v2 offset:41984
    ds_read_b64_tr_b16 v[36:37], v4 offset:40960
    v_mfma_f32_32x32x16_bf16 v[80:95], v[60:63], v[48:51], v[80:95]
    ds_read_b64_tr_b16 v[38:39], v4 offset:41984
    v_xor_b32 v22, 64, v6
    ds_read_b128 v[40:43], v22 offset:49152
    v_xor_b32 v23, 64, v8
    ds_read_b128 v[44:47], v23 offset:49152
    v_dot2c_f32_bf16 v128, s45, v56
    v_dot2c_f32_bf16 v128, s45, v57
    v_dot2c_f32_bf16 v128, s45, v58
    v_dot2c_f32_bf16 v128, s45, v59
    v_mfma_f32_32x32x16_bf16 v[96:111], v[56:59], v[52:55], v[96:111]
    v_dot2c_f32_bf16 v129, v56, v56
    v_dot2c_f32_bf16 v129, v57, v57
    v_dot2c_f32_bf16 v129, v58, v58
    v_dot2c_f32_bf16 v129, v59, v59
    v_mfma_f32_32x32x16_bf16 v[112:127], v[60:63], v[52:55], v[112:127]
    v_dot2c_f32_bf16 v130, s45, v48
    v_dot2c_f32_bf16 v130, s45, v49
    v_dot2c_f32_bf16 v130, s45, v50
    v_dot2c_f32_bf16 v130, s45, v51
    s_waitcnt lgkmcnt(0)
    v_mfma_f32_32x32x16_bf16 v[64:79], v[40:43], v[32:35], v[64:79]
    ds_read_b64_tr_b16 v[48:49], v2 offset:45056
    ds_read_b64_tr_b16 v[50:51], v2 offset:46080
    ds_read_b64_tr_b16 v[52:53], v4 offset:45056
    v_mfma_f32_32x32x16_bf16 v[80:95], v[44:47], v[32:35], v[80:95]
    ds_read_b64_tr_b16 v[54:55], v4 offset:46080
    v_xor_b32 v22, 96, v6
    ds_read_b128 v[56:59], v22 offset:49152
    v_xor_b32 v23, 96, v8
    ds_read_b128 v[60:63], v23 offset:49152
    v_dot2c_f32_bf16 v128, s45, v40
    v_dot2c_f32_bf16 v128, s45, v41
    v_dot2c_f32_bf16 v128, s45, v42
    v_dot2c_f32_bf16 v128, s45, v43
    v_mfma_f32_32x32x16_bf16 v[96:111], v[40:43], v[36:39], v[96:111]
    v_dot2c_f32_bf16 v129, v40, v40
    v_dot2c_f32_bf16 v129, v41, v41
    v_dot2c_f32_bf16 v129, v42, v42
    v_dot2c_f32_bf16 v129, v43, v43
    v_mfma_f32_32x32x16_bf16 v[112:127], v[44:47], v[36:39], v[112:127]
    v_dot2c_f32_bf16 v130, s45, v32
    v_dot2c_f32_bf16 v130, s45, v33
    v_dot2c_f32_bf16 v130, s45, v34
    v_dot2c_f32_bf16 v130, s45, v35
    s_waitcnt lgkmcnt(0)
    s_barrier
    v_mfma_f32_32x32x16_bf16 v[64:79], v[56:59], v[48:51], v[64:79]
    ds_read_b64_tr_b16 v[32:33], v3 offset:0
    ds_read_b64_tr_b16 v[34:35], v3 offset:1024
    ds_read_b64_tr_b16 v[36:37], v5 offset:0
    v_mfma_f32_32x32x16_bf16 v[80:95], v[60:63], v[48:51], v[80:95]
    ds_read_b64_tr_b16 v[38:39], v5 offset:1024
    v_xor_b32 v22, 0, v7
    ds_read_b128 v[40:43], v22 offset:16384
    v_xor_b32 v23, 0, v9
    ds_read_b128 v[44:47], v23 offset:16384
    v_dot2c_f32_bf16 v128, s45, v56
    v_dot2c_f32_bf16 v128, s45, v57
    v_dot2c_f32_bf16 v128, s45, v58
    v_dot2c_f32_bf16 v128, s45, v59
    v_mfma_f32_32x32x16_bf16 v[96:111], v[56:59], v[52:55], v[96:111]
    v_dot2c_f32_bf16 v129, v56, v56
    v_dot2c_f32_bf16 v129, v57, v57
    v_dot2c_f32_bf16 v129, v58, v58
    v_dot2c_f32_bf16 v129, v59, v59
    v_mfma_f32_32x32x16_bf16 v[112:127], v[60:63], v[52:55], v[112:127]
    v_dot2c_f32_bf16 v130, s45, v48
    v_dot2c_f32_bf16 v130, s45, v49
    v_dot2c_f32_bf16 v130, s45, v50
    v_dot2c_f32_bf16 v130, s45, v51
    s_waitcnt lgkmcnt(0)
    v_mfma_f32_32x32x16_bf16 v[64:79], v[40:43], v[32:35], v[64:79]
    ds_read_b64_tr_b16 v[48:49], v3 offset:4096
    ds_read_b64_tr_b16 v[50:51], v3 offset:5120
    ds_read_b64_tr_b16 v[52:53], v5 offset:4096
    v_mfma_f32_32x32x16_bf16 v[80:95], v[44:47], v[32:35], v[80:95]
    ds_read_b64_tr_b16 v[54:55], v5 offset:5120
    v_xor_b32 v22, 32, v7
    ds_read_b128 v[56:59], v22 offset:16384
    v_xor_b32 v23, 32, v9
    ds_read_b128 v[60:63], v23 offset:16384
    v_dot2c_f32_bf16 v128, s45, v40
    v_dot2c_f32_bf16 v128, s45, v41
    v_dot2c_f32_bf16 v128, s45, v42
    v_dot2c_f32_bf16 v128, s45, v43
    v_mfma_f32_32x32x16_bf16 v[96:111], v[40:43], v[36:39], v[96:111]
    v_dot2c_f32_bf16 v129, v40, v40
    v_dot2c_f32_bf16 v129, v41, v41
    v_dot2c_f32_bf16 v129, v42, v42
    v_dot2c_f32_bf16 v129, v43, v43
    v_mfma_f32_32x32x16_bf16 v[112:127], v[44:47], v[36:39], v[112:127]
    v_dot2c_f32_bf16 v130, s45, v32
    v_dot2c_f32_bf16 v130, s45, v33
    v_dot2c_f32_bf16 v130, s45, v34
    v_dot2c_f32_bf16 v130, s45, v35
    s_waitcnt lgkmcnt(0)
    v_mfma_f32_32x32x16_bf16 v[64:79], v[56:59], v[48:51], v[64:79]
    ds_read_b64_tr_b16 v[32:33], v3 offset:8192
    ds_read_b64_tr_b16 v[34:35], v3 offset:9216
    ds_read_b64_tr_b16 v[36:37], v5 offset:8192
    v_mfma_f32_32x32x16_bf16 v[80:95], v[60:63], v[48:51], v[80:95]
    ds_read_b64_tr_b16 v[38:39], v5 offset:9216
    v_xor_b32 v22, 64, v7
    ds_read_b128 v[40:43], v22 offset:16384
    v_xor_b32 v23, 64, v9
    ds_read_b128 v[44:47], v23 offset:16384
    v_dot2c_f32_bf16 v128, s45, v56
    v_dot2c_f32_bf16 v128, s45, v57
    v_dot2c_f32_bf16 v128, s45, v58
    v_dot2c_f32_bf16 v128, s45, v59
    v_mfma_f32_32x32x16_bf16 v[96:111], v[56:59], v[52:55], v[96:111]
    v_dot2c_f32_bf16 v129, v56, v56
    v_dot2c_f32_bf16 v129, v57, v57
    v_dot2c_f32_bf16 v129, v58, v58
    v_dot2c_f32_bf16 v129, v59, v59
    v_mfma_f32_32x32x16_bf16 v[112:127], v[60:63], v[52:55], v[112:127]
    v_dot2c_f32_bf16 v130, s45, v48
    v_dot2c_f32_bf16 v130, s45, v49
    v_dot2c_f32_bf16 v130, s45, v50
    v_dot2c_f32_bf16 v130, s45, v51
    s_waitcnt lgkmcnt(0)
    v_mfma_f32_32x32x16_bf16 v[64:79], v[40:43], v[32:35], v[64:79]
    ds_read_b64_tr_b16 v[48:49], v3 offset:12288
    ds_read_b64_tr_b16 v[50:51], v3 offset:13312
    ds_read_b64_tr_b16 v[52:53], v5 offset:12288
    v_mfma_f32_32x32x16_bf16 v[80:95], v[44:47], v[32:35], v[80:95]
    ds_read_b64_tr_b16 v[54:55], v5 offset:13312
    v_xor_b32 v22, 96, v7
    ds_read_b128 v[56:59], v22 offset:16384
    v_xor_b32 v23, 96, v9
    ds_read_b128 v[60:63], v23 offset:16384
    v_dot2c_f32_bf16 v128, s45, v40
    v_dot2c_f32_bf16 v128, s45, v41
    v_dot2c_f32_bf16 v128, s45, v42
    v_dot2c_f32_bf16 v128, s45, v43
    v_mfma_f32_32x32x16_bf16 v[96:111], v[40:43], v[36:39], v[96:111]
    v_dot2c_f32_bf16 v129, v40, v40
    v_dot2c_f32_bf16 v129, v41, v41
    v_dot2c_f32_bf16 v129, v42, v42
    v_dot2c_f32_bf16 v129, v43, v43
    v_mfma_f32_32x32x16_bf16 v[112:127], v[44:47], v[36:39], v[112:127]
    v_dot2c_f32_bf16 v130, s45, v32
    v_dot2c_f32_bf16 v130, s45, v33
    v_dot2c_f32_bf16 v130, s45, v34
    v_dot2c_f32_bf16 v130, s45, v35
    s_waitcnt lgkmcnt(0)
    s_barrier
    v_mfma_f32_32x32x16_bf16 v[64:79], v[56:59], v[48:51], v[64:79]
    ds_read_b64_tr_b16 v[32:33], v3 offset:32768
    ds_read_b64_tr_b16 v[34:35], v3 offset:33792
    ds_read_b64_tr_b16 v[36:37], v5 offset:32768
    v_mfma_f32_32x32x16_bf16 v[80:95], v[60:63], v[48:51], v[80:95]
    ds_read_b64_tr_b16 v[38:39], v5 offset:33792
    v_xor_b32 v22, 0, v7
    ds_read_b128 v[40:43], v22 offset:49152
    v_xor_b32 v23, 0, v9
    ds_read_b128 v[44:47], v23 offset:49152
    v_dot2c_f32_bf16 v128, s45, v56
    v_dot2c_f32_bf16 v128, s45, v57
    v_dot2c_f32_bf16 v128, s45, v58
    v_dot2c_f32_bf16 v128, s45, v59
    v_mfma_f32_32x32x16_bf16 v[96:111], v[56:59], v[52:55], v[96:111]
    v_dot2c_f32_bf16 v129, v56, v56
    v_dot2c_f32_bf16 v129, v57, v57
    v_dot2c_f32_bf16 v129, v58, v58
    v_dot2c_f32_bf16 v129, v59, v59
    v_mfma_f32_32x32x16_bf16 v[112:127], v[60:63], v[52:55], v[112:127]
    v_dot2c_f32_bf16 v130, s45, v48
    v_dot2c_f32_bf16 v130, s45, v49
    v_dot2c_f32_bf16 v130, s45, v50
    v_dot2c_f32_bf16 v130, s45, v51
    s_waitcnt lgkmcnt(0)
    v_mfma_f32_32x32x16_bf16 v[64:79], v[40:43], v[32:35], v[64:79]
    ds_read_b64_tr_b16 v[48:49], v3 offset:36864
    ds_read_b64_tr_b16 v[50:51], v3 offset:37888
    ds_read_b64_tr_b16 v[52:53], v5 offset:36864
    v_mfma_f32_32x32x16_bf16 v[80:95], v[44:47], v[32:35], v[80:95]
    ds_read_b64_tr_b16 v[54:55], v5 offset:37888
    v_xor_b32 v22, 32, v7
    ds_read_b128 v[56:59], v22 offset:49152
    v_xor_b32 v23, 32, v9
    ds_read_b128 v[60:63], v23 offset:49152
    v_dot2c_f32_bf16 v128, s45, v40
    v_dot2c_f32_bf16 v128, s45, v41
    v_dot2c_f32_bf16 v128, s45, v42
    v_dot2c_f32_bf16 v128, s45, v43
    v_mfma_f32_32x32x16_bf16 v[96:111], v[40:43], v[36:39], v[96:111]
    v_dot2c_f32_bf16 v129, v40, v40
    v_dot2c_f32_bf16 v129, v41, v41
    v_dot2c_f32_bf16 v129, v42, v42
    v_dot2c_f32_bf16 v129, v43, v43
    v_mfma_f32_32x32x16_bf16 v[112:127], v[44:47], v[36:39], v[112:127]
    v_dot2c_f32_bf16 v130, s45, v32
    v_dot2c_f32_bf16 v130, s45, v33
    v_dot2c_f32_bf16 v130, s45, v34
    v_dot2c_f32_bf16 v130, s45, v35
    s_waitcnt lgkmcnt(0)
    v_mfma_f32_32x32x16_bf16 v[64:79], v[56:59], v[48:51], v[64:79]
    ds_read_b64_tr_b16 v[32:33], v3 offset:40960
    ds_read_b64_tr_b16 v[34:35], v3 offset:41984
    ds_read_b64_tr_b16 v[36:37], v5 offset:40960
    v_mfma_f32_32x32x16_bf16 v[80:95], v[60:63], v[48:51], v[80:95]
    ds_read_b64_tr_b16 v[38:39], v5 offset:41984
    v_xor_b32 v22, 64, v7
    ds_read_b128 v[40:43], v22 offset:49152
    v_xor_b32 v23, 64, v9
    ds_read_b128 v[44:47], v23 offset:49152
    v_dot2c_f32_bf16 v128, s45, v56
    v_dot2c_f32_bf16 v128, s45, v57
    v_dot2c_f32_bf16 v128, s45, v58
    v_dot2c_f32_bf16 v128, s45, v59
    v_mfma_f32_32x32x16_bf16 v[96:111], v[56:59], v[52:55], v[96:111]
    v_dot2c_f32_bf16 v129, v56, v56
    v_dot2c_f32_bf16 v129, v57, v57
    v_dot2c_f32_bf16 v129, v58, v58
    v_dot2c_f32_bf16 v129, v59, v59
    v_mfma_f32_32x32x16_bf16 v[112:127], v[60:63], v[52:55], v[112:127]
    v_dot2c_f32_bf16 v130, s45, v48
    v_dot2c_f32_bf16 v130, s45, v49
    v_dot2c_f32_bf16 v130, s45, v50
    v_dot2c_f32_bf16 v130, s45, v51
    s_waitcnt lgkmcnt(0)
    v_mfma_f32_32x32x16_bf16 v[64:79], v[40:43], v[32:35], v[64:79]
    ds_read_b64_tr_b16 v[48:49], v3 offset:45056
    ds_read_b64_tr_b16 v[50:51], v3 offset:46080
    ds_read_b64_tr_b16 v[52:53], v5 offset:45056
    v_mfma_f32_32x32x16_bf16 v[80:95], v[44:47], v[32:35], v[80:95]
    ds_read_b64_tr_b16 v[54:55], v5 offset:46080
    v_xor_b32 v22, 96, v7
    ds_read_b128 v[56:59], v22 offset:49152
    v_xor_b32 v23, 96, v9
    ds_read_b128 v[60:63], v23 offset:49152
    v_dot2c_f32_bf16 v128, s45, v40
    v_dot2c_f32_bf16 v128, s45, v41
    v_dot2c_f32_bf16 v128, s45, v42
    v_dot2c_f32_bf16 v128, s45, v43
    v_mfma_f32_32x32x16_bf16 v[96:111], v[40:43], v[36:39], v[96:111]
    v_dot2c_f32_bf16 v129, v40, v40
    v_dot2c_f32_bf16 v129, v41, v41
    v_dot2c_f32_bf16 v129, v42, v42
    v_dot2c_f32_bf16 v129, v43, v43
    v_mfma_f32_32x32x16_bf16 v[112:127], v[44:47], v[36:39], v[112:127]
    v_dot2c_f32_bf16 v130, s45, v32
    v_dot2c_f32_bf16 v130, s45, v33
    v_dot2c_f32_bf16 v130, s45, v34
    v_dot2c_f32_bf16 v130, s45, v35
    s_waitcnt lgkmcnt(0)
    s_barrier
    v_mfma_f32_32x32x16_bf16 v[64:79], v[56:59], v[48:51], v[64:79]
    ds_read_b64_tr_b16 v[32:33], v26 offset:0
    ds_read_b64_tr_b16 v[34:35], v26 offset:1024
    ds_read_b64_tr_b16 v[36:37], v27 offset:0
    v_mfma_f32_32x32x16_bf16 v[80:95], v[60:63], v[48:51], v[80:95]
    ds_read_b64_tr_b16 v[38:39], v27 offset:1024
    v_xor_b32 v22, 0, v28
    ds_read_b128 v[40:43], v22 offset:16384
    v_xor_b32 v23, 0, v29
    ds_read_b128 v[44:47], v23 offset:16384
    v_dot2c_f32_bf16 v128, s45, v56
    v_dot2c_f32_bf16 v128, s45, v57
    v_dot2c_f32_bf16 v128, s45, v58
    v_dot2c_f32_bf16 v128, s45, v59
    v_mfma_f32_32x32x16_bf16 v[96:111], v[56:59], v[52:55], v[96:111]
    v_dot2c_f32_bf16 v129, v56, v56
    v_dot2c_f32_bf16 v129, v57, v57
    v_dot2c_f32_bf16 v129, v58, v58
    v_dot2c_f32_bf16 v129, v59, v59
    v_mfma_f32_32x32x16_bf16 v[112:127], v[60:63], v[52:55], v[112:127]
    v_dot2c_f32_bf16 v130, s45, v48
    v_dot2c_f32_bf16 v130, s45, v49
    v_dot2c_f32_bf16 v130, s45, v50
    v_dot2c_f32_bf16 v130, s45, v51
    s_waitcnt lgkmcnt(0)
    v_mfma_f32_32x32x16_bf16 v[64:79], v[40:43], v[32:35], v[64:79]
    ds_read_b64_tr_b16 v[48:49], v26 offset:4096
    ds_read_b64_tr_b16 v[50:51], v26 offset:5120
    ds_read_b64_tr_b16 v[52:53], v27 offset:4096
    v_mfma_f32_32x32x16_bf16 v[80:95], v[44:47], v[32:35], v[80:95]
    ds_read_b64_tr_b16 v[54:55], v27 offset:5120
    v_xor_b32 v22, 32, v28
    ds_read_b128 v[56:59], v22 offset:16384
    v_xor_b32 v23, 32, v29
    ds_read_b128 v[60:63], v23 offset:16384
    v_dot2c_f32_bf16 v128, s45, v40
    v_dot2c_f32_bf16 v128, s45, v41
    v_dot2c_f32_bf16 v128, s45, v42
    v_dot2c_f32_bf16 v128, s45, v43
    v_mfma_f32_32x32x16_bf16 v[96:111], v[40:43], v[36:39], v[96:111]
    v_dot2c_f32_bf16 v129, v40, v40
    v_dot2c_f32_bf16 v129, v41, v41
    v_dot2c_f32_bf16 v129, v42, v42
    v_dot2c_f32_bf16 v129, v43, v43
    v_mfma_f32_32x32x16_bf16 v[112:127], v[44:47], v[36:39], v[112:127]
    v_dot2c_f32_bf16 v130, s45, v32
    v_dot2c_f32_bf16 v130, s45, v33
    v_dot2c_f32_bf16 v130, s45, v34
    v_dot2c_f32_bf16 v130, s45, v35
    s_waitcnt lgkmcnt(0)
    v_mfma_f32_32x32x16_bf16 v[64:79], v[56:59], v[48:51], v[64:79]
    ds_read_b64_tr_b16 v[32:33], v26 offset:8192
    ds_read_b64_tr_b16 v[34:35], v26 offset:9216
    ds_read_b64_tr_b16 v[36:37], v27 offset:8192
    v_mfma_f32_32x32x16_bf16 v[80:95], v[60:63], v[48:51], v[80:95]
    ds_read_b64_tr_b16 v[38:39], v27 offset:9216
    v_xor_b32 v22, 64, v28
    ds_read_b128 v[40:43], v22 offset:16384
    v_xor_b32 v23, 64, v29
    ds_read_b128 v[44:47], v23 offset:16384
    v_dot2c_f32_bf16 v128, s45, v56
    v_dot2c_f32_bf16 v128, s45, v57
    v_dot2c_f32_bf16 v128, s45, v58
    v_dot2c_f32_bf16 v128, s45, v59
    v_mfma_f32_32x32x16_bf16 v[96:111], v[56:59], v[52:55], v[96:111]
    v_dot2c_f32_bf16 v129, v56, v56
    v_dot2c_f32_bf16 v129, v57, v57
    v_dot2c_f32_bf16 v129, v58, v58
    v_dot2c_f32_bf16 v129, v59, v59
    v_mfma_f32_32x32x16_bf16 v[112:127], v[60:63], v[52:55], v[112:127]
    v_dot2c_f32_bf16 v130, s45, v48
    v_dot2c_f32_bf16 v130, s45, v49
    v_dot2c_f32_bf16 v130, s45, v50
    v_dot2c_f32_bf16 v130, s45, v51
    s_waitcnt lgkmcnt(0)
    v_mfma_f32_32x32x16_bf16 v[64:79], v[40:43], v[32:35], v[64:79]
    ds_read_b64_tr_b16 v[48:49], v26 offset:12288
    ds_read_b64_tr_b16 v[50:51], v26 offset:13312
    ds_read_b64_tr_b16 v[52:53], v27 offset:12288
    v_mfma_f32_32x32x16_bf16 v[80:95], v[44:47], v[32:35], v[80:95]
    ds_read_b64_tr_b16 v[54:55], v27 offset:13312
    v_xor_b32 v22, 96, v28
    ds_read_b128 v[56:59], v22 offset:16384
    v_xor_b32 v23, 96, v29
    ds_read_b128 v[60:63], v23 offset:16384
    v_dot2c_f32_bf16 v128, s45, v40
    v_dot2c_f32_bf16 v128, s45, v41
    v_dot2c_f32_bf16 v128, s45, v42
    v_dot2c_f32_bf16 v128, s45, v43
    v_mfma_f32_32x32x16_bf16 v[96:111], v[40:43], v[36:39], v[96:111]
    v_dot2c_f32_bf16 v129, v40, v40
    v_dot2c_f32_bf16 v129, v41, v41
    v_dot2c_f32_bf16 v129, v42, v42
    v_dot2c_f32_bf16 v129, v43, v43
    v_mfma_f32_32x32x16_bf16 v[112:127], v[44:47], v[36:39], v[112:127]
    v_dot2c_f32_bf16 v130, s45, v32
    v_dot2c_f32_bf16 v130, s45, v33
    v_dot2c_f32_bf16 v130, s45, v34
    v_dot2c_f32_bf16 v130, s45, v35
    s_waitcnt lgkmcnt(0)
    s_barrier
    v_mfma_f32_32x32x16_bf16 v[64:79], v[56:59], v[48:51], v[64:79]
    ds_read_b64_tr_b16 v[32:33], v2 offset:0
    ds_read_b64_tr_b16 v[34:35], v2 offset:1024
    ds_read_b64_tr_b16 v[36:37], v4 offset:0
    v_mfma_f32_32x32x16_bf16 v[80:95], v[60:63], v[48:51], v[80:95]
    ds_read_b64_tr_b16 v[38:39], v4 offset:1024
    v_xor_b32 v22, 0, v6
    ds_read_b128 v[40:43], v22 offset:16384
    v_xor_b32 v23, 0, v8
    ds_read_b128 v[44:47], v23 offset:16384
    v_dot2c_f32_bf16 v128, s45, v56
    v_dot2c_f32_bf16 v128, s45, v57
    v_dot2c_f32_bf16 v128, s45, v58
    v_dot2c_f32_bf16 v128, s45, v59
    v_mfma_f32_32x32x16_bf16 v[96:111], v[56:59], v[52:55], v[96:111]
    v_dot2c_f32_bf16 v129, v56, v56
    v_dot2c_f32_bf16 v129, v57, v57
    v_dot2c_f32_bf16 v129, v58, v58
    v_dot2c_f32_bf16 v129, v59, v59
    v_mfma_f32_32x32x16_bf16 v[112:127], v[60:63], v[52:55], v[112:127]
    v_dot2c_f32_bf16 v130, s45, v48
    v_dot2c_f32_bf16 v130, s45, v49
    v_dot2c_f32_bf16 v130, s45, v50
    v_dot2c_f32_bf16 v130, s45, v51
    s_waitcnt lgkmcnt(0)
    v_mfma_f32_32x32x16_bf16 v[64:79], v[40:43], v[32:35], v[64:79]
    ds_read_b64_tr_b16 v[48:49], v2 offset:4096
    ds_read_b64_tr_b16 v[50:51], v2 offset:5120
    ds_read_b64_tr_b16 v[52:53], v4 offset:4096
    v_mfma_f32_32x32x16_bf16 v[80:95], v[44:47], v[32:35], v[80:95]
    ds_read_b64_tr_b16 v[54:55], v4 offset:5120
    v_xor_b32 v22, 32, v6
    ds_read_b128 v[56:59], v22 offset:16384
    v_xor_b32 v23, 32, v8
    ds_read_b128 v[60:63], v23 offset:16384
    v_dot2c_f32_bf16 v128, s45, v40
    v_dot2c_f32_bf16 v128, s45, v41
    v_dot2c_f32_bf16 v128, s45, v42
    v_dot2c_f32_bf16 v128, s45, v43
    v_mfma_f32_32x32x16_bf16 v[96:111], v[40:43], v[36:39], v[96:111]
    v_dot2c_f32_bf16 v129, v40, v40
    v_dot2c_f32_bf16 v129, v41, v41
    v_dot2c_f32_bf16 v129, v42, v42
    v_dot2c_f32_bf16 v129, v43, v43
    v_mfma_f32_32x32x16_bf16 v[112:127], v[44:47], v[36:39], v[112:127]
    v_dot2c_f32_bf16 v130, s45, v32
    v_dot2c_f32_bf16 v130, s45, v33
    v_dot2c_f32_bf16 v130, s45, v34
    v_dot2c_f32_bf16 v130, s45, v35
    s_waitcnt lgkmcnt(0)
    v_mfma_f32_32x32x16_bf16 v[64:79], v[56:59], v[48:51], v[64:79]
    ds_read_b64_tr_b16 v[32:33], v2 offset:8192
    ds_read_b64_tr_b16 v[34:35], v2 offset:9216
    ds_read_b64_tr_b16 v[36:37], v4 offset:8192
    v_mfma_f32_32x32x16_bf16 v[80:95], v[60:63], v[48:51], v[80:95]
    ds_read_b64_tr_b16 v[38:39], v4 offset:9216
    v_xor_b32 v22, 64, v6
    ds_read_b128 v[40:43], v22 offset:16384
    v_xor_b32 v23, 64, v8
    ds_read_b128 v[44:47], v23 offset:16384
    v_dot2c_f32_bf16 v128, s45, v56
    v_dot2c_f32_bf16 v128, s45, v57
    v_dot2c_f32_bf16 v128, s45, v58
    v_dot2c_f32_bf16 v128, s45, v59
    v_mfma_f32_32x32x16_bf16 v[96:111], v[56:59], v[52:55], v[96:111]
    v_dot2c_f32_bf16 v129, v56, v56
    v_dot2c_f32_bf16 v129, v57, v57
    v_dot2c_f32_bf16 v129, v58, v58
    v_dot2c_f32_bf16 v129, v59, v59
    v_mfma_f32_32x32x16_bf16 v[112:127], v[60:63], v[52:55], v[112:127]
    v_dot2c_f32_bf16 v130, s45, v48
    v_dot2c_f32_bf16 v130, s45, v49
    v_dot2c_f32_bf16 v130, s45, v50
    v_dot2c_f32_bf16 v130, s45, v51
    s_waitcnt lgkmcnt(0)
    v_mfma_f32_32x32x16_bf16 v[64:79], v[40:43], v[32:35], v[64:79]
    ds_read_b64_tr_b16 v[48:49], v2 offset:12288
    ds_read_b64_tr_b16 v[50:51], v2 offset:13312
    ds_read_b64_tr_b16 v[52:53], v4 offset:12288
    v_mfma_f32_32x32x16_bf16 v[80:95], v[44:47], v[32:35], v[80:95]
    ds_read_b64_tr_b16 v[54:55], v4 offset:13312
    v_xor_b32 v22, 96, v6
    ds_read_b128 v[56:59], v22 offset:16384
    v_xor_b32 v23, 96, v8
    ds_read_b128 v[60:63], v23 offset:16384
    v_dot2c_f32_bf16 v128, s45, v40
    v_dot2c_f32_bf16 v128, s45, v41
    v_dot2c_f32_bf16 v128, s45, v42
    v_dot2c_f32_bf16 v128, s45, v43
    v_mfma_f32_32x32x16_bf16 v[96:111], v[40:43], v[36:39], v[96:111]
    v_dot2c_f32_bf16 v129, v40, v40
    v_dot2c_f32_bf16 v129, v41, v41
    v_dot2c_f32_bf16 v129, v42, v42
    v_dot2c_f32_bf16 v129, v43, v43
    v_mfma_f32_32x32x16_bf16 v[112:127], v[44:47], v[36:39], v[112:127]
    v_dot2c_f32_bf16 v130, s45, v32
    v_dot2c_f32_bf16 v130, s45, v33
    v_dot2c_f32_bf16 v130, s45, v34
    v_dot2c_f32_bf16 v130, s45, v35
    s_waitcnt lgkmcnt(0)
    s_barrier
    v_mfma_f32_32x32x16_bf16 v[64:79], v[56:59], v[48:51], v[64:79]
    ds_read_b64_tr_b16 v[32:33], v2 offset:32768
    ds_read_b64_tr_b16 v[34:35], v2 offset:33792
    ds_read_b64_tr_b16 v[36:37], v4 offset:32768
    v_mfma_f32_32x32x16_bf16 v[80:95], v[60:63], v[48:51], v[80:95]
    ds_read_b64_tr_b16 v[38:39], v4 offset:33792
    v_xor_b32 v22, 0, v6
    ds_read_b128 v[40:43], v22 offset:49152
    v_xor_b32 v23, 0, v8
    ds_read_b128 v[44:47], v23 offset:49152
    v_dot2c_f32_bf16 v128, s45, v56
    v_dot2c_f32_bf16 v128, s45, v57
    v_dot2c_f32_bf16 v128, s45, v58
    v_dot2c_f32_bf16 v128, s45, v59
    v_mfma_f32_32x32x16_bf16 v[96:111], v[56:59], v[52:55], v[96:111]
    v_dot2c_f32_bf16 v129, v56, v56
    v_dot2c_f32_bf16 v129, v57, v57
    v_dot2c_f32_bf16 v129, v58, v58
    v_dot2c_f32_bf16 v129, v59, v59
    v_mfma_f32_32x32x16_bf16 v[112:127], v[60:63], v[52:55], v[112:127]
    v_dot2c_f32_bf16 v130, s45, v48
    v_dot2c_f32_bf16 v130, s45, v49
    v_dot2c_f32_bf16 v130, s45, v50
    v_dot2c_f32_bf16 v130, s45, v51
    s_waitcnt lgkmcnt(0)
    v_mfma_f32_32x32x16_bf16 v[64:79], v[40:43], v[32:35], v[64:79]
    ds_read_b64_tr_b16 v[48:49], v2 offset:36864
    ds_read_b64_tr_b16 v[50:51], v2 offset:37888
    ds_read_b64_tr_b16 v[52:53], v4 offset:36864
    v_mfma_f32_32x32x16_bf16 v[80:95], v[44:47], v[32:35], v[80:95]
    ds_read_b64_tr_b16 v[54:55], v4 offset:37888
    v_xor_b32 v22, 32, v6
    ds_read_b128 v[56:59], v22 offset:49152
    v_xor_b32 v23, 32, v8
    ds_read_b128 v[60:63], v23 offset:49152
    v_dot2c_f32_bf16 v128, s45, v40
    v_dot2c_f32_bf16 v128, s45, v41
    v_dot2c_f32_bf16 v128, s45, v42
    v_dot2c_f32_bf16 v128, s45, v43
    v_mfma_f32_32x32x16_bf16 v[96:111], v[40:43], v[36:39], v[96:111]
    v_dot2c_f32_bf16 v129, v40, v40
    v_dot2c_f32_bf16 v129, v41, v41
    v_dot2c_f32_bf16 v129, v42, v42
    v_dot2c_f32_bf16 v129, v43, v43
    v_mfma_f32_32x32x16_bf16 v[112:127], v[44:47], v[36:39], v[112:127]
    v_dot2c_f32_bf16 v130, s45, v32
    v_dot2c_f32_bf16 v130, s45, v33
    v_dot2c_f32_bf16 v130, s45, v34
    v_dot2c_f32_bf16 v130, s45, v35
    s_waitcnt lgkmcnt(0)
    v_mfma_f32_32x32x16_bf16 v[64:79], v[56:59], v[48:51], v[64:79]
    ds_read_b64_tr_b16 v[32:33], v2 offset:40960
    ds_read_b64_tr_b16 v[34:35], v2 offset:41984
    ds_read_b64_tr_b16 v[36:37], v4 offset:40960
    v_mfma_f32_32x32x16_bf16 v[80:95], v[60:63], v[48:51], v[80:95]
    ds_read_b64_tr_b16 v[38:39], v4 offset:41984
    v_xor_b32 v22, 64, v6
    ds_read_b128 v[40:43], v22 offset:49152
    v_xor_b32 v23, 64, v8
    ds_read_b128 v[44:47], v23 offset:49152
    v_dot2c_f32_bf16 v128, s45, v56
    v_dot2c_f32_bf16 v128, s45, v57
    v_dot2c_f32_bf16 v128, s45, v58
    v_dot2c_f32_bf16 v128, s45, v59
    v_mfma_f32_32x32x16_bf16 v[96:111], v[56:59], v[52:55], v[96:111]
    v_dot2c_f32_bf16 v129, v56, v56
    v_dot2c_f32_bf16 v129, v57, v57
    v_dot2c_f32_bf16 v129, v58, v58
    v_dot2c_f32_bf16 v129, v59, v59
    v_mfma_f32_32x32x16_bf16 v[112:127], v[60:63], v[52:55], v[112:127]
    v_dot2c_f32_bf16 v130, s45, v48
    v_dot2c_f32_bf16 v130, s45, v49
    v_dot2c_f32_bf16 v130, s45, v50
    v_dot2c_f32_bf16 v130, s45, v51
    s_waitcnt lgkmcnt(0)
    v_mfma_f32_32x32x16_bf16 v[64:79], v[40:43], v[32:35], v[64:79]
    ds_read_b64_tr_b16 v[48:49], v2 offset:45056
    ds_read_b64_tr_b16 v[50:51], v2 offset:46080
    ds_read_b64_tr_b16 v[52:53], v4 offset:45056
    v_mfma_f32_32x32x16_bf16 v[80:95], v[44:47], v[32:35], v[80:95]
    ds_read_b64_tr_b16 v[54:55], v4 offset:46080
    v_xor_b32 v22, 96, v6
    ds_read_b128 v[56:59], v22 offset:49152
    v_xor_b32 v23, 96, v8
    ds_read_b128 v[60:63], v23 offset:49152
    v_dot2c_f32_bf16 v128, s45, v40
    v_dot2c_f32_bf16 v128, s45, v41
    v_dot2c_f32_bf16 v128, s45, v42
    v_dot2c_f32_bf16 v128, s45, v43
    v_mfma_f32_32x32x16_bf16 v[96:111], v[40:43], v[36:39], v[96:111]
    v_dot2c_f32_bf16 v129, v40, v40
    v_dot2c_f32_bf16 v129, v41, v41
    v_dot2c_f32_bf16 v129, v42, v42
    v_dot2c_f32_bf16 v129, v43, v43
    v_mfma_f32_32x32x16_bf16 v[112:127], v[44:47], v[36:39], v[112:127]
    v_dot2c_f32_bf16 v130, s45, v32
    v_dot2c_f32_bf16 v130, s45, v33
    v_dot2c_f32_bf16 v130, s45, v34
    v_dot2c_f32_bf16 v130, s45, v35
    s_waitcnt lgkmcnt(0)
    v_mfma_f32_32x32x16_bf16 v[64:79], v[56:59], v[48:51], v[64:79]
    v_mfma_f32_32x32x16_bf16 v[80:95], v[60:63], v[48:51], v[80:95]
    v_dot2c_f32_bf16 v128, s45, v56
    v_dot2c_f32_bf16 v128, s45, v57
    v_dot2c_f32_bf16 v128, s45, v58
    v_dot2c_f32_bf16 v128, s45, v59
    v_mfma_f32_32x32x16_bf16 v[96:111], v[56:59], v[52:55], v[96:111]
    v_dot2c_f32_bf16 v129, v56, v56
    v_dot2c_f32_bf16 v129, v57, v57
    v_dot2c_f32_bf16 v129, v58, v58
    v_dot2c_f32_bf16 v129, v59, v59
    v_mfma_f32_32x32x16_bf16 v[112:127], v[60:63], v[52:55], v[112:127]
    v_dot2c_f32_bf16 v130, s45, v48
    v_dot2c_f32_bf16 v130, s45, v49
    v_dot2c_f32_bf16 v130, s45, v50
    v_dot2c_f32_bf16 v130, s45, v51
    s_nop 3
    v_mov_b32 v148, v128
    s_nop 1
    v_permlane32_swap_b32 v128, v148
    s_nop 1
    v_add_f32 v128, v128, v148
    v_mov_b32 v148, v129
    s_nop 1
    v_permlane32_swap_b32 v129, v148
    s_nop 1
    v_add_f32 v129, v129, v148
    v_mov_b32 v148, v130
    s_nop 1
    v_permlane32_swap_b32 v130, v148
    s_nop 1
    v_add_f32 v130, v130, v148
    s_mov_b32 s29, 0x3b124925
    v_mul_f32 v128, s29, v128
    v_mul_f32 v129, s29, v129
    v_fma_f32 v129, -v128, v128, v129
    v_max_f32 v129, 0, v129
    v_add_f32 v129, 0x3727c5ac, v129
    v_rsq_f32 v129, v129
    s_nop 0
    v_mul_f32 v128, v128, v129
    s_lshl_b32 s29, s50, 7
    s_add_u32 s29, s29, 0
    v_lshlrev_b32 v16, 2, v15
    v_add_u32 v17, s29, v16
    ds_write_b32 v17, v129
    ds_write_b32 v17, v128 offset:512
    s_lshl_b32 s29, s48, 7
    s_add_u32 s29, s29, 0
    v_add_u32 v17, s29, v16
    ds_write_b32 v17, v130 offset:1024
    s_waitcnt lgkmcnt(0)
    s_barrier
    v_lshlrev_b32 v18, 4, v12
    v_lshlrev_b32 v24, 4, v0
    s_lshl_b32 s29, s48, 7
    s_add_u32 s29, s29, 0
    v_add_u32 v17, s29, v16
    s_lshl_b32 s29, s50, 7
    s_add_u32 s29, s29, 0
    v_add_u32 v19, s29, v18
    ds_read_b32 v148, v17 offset:1024
    ds_read_b128 v[152:155], v19 offset:0
    ds_read_b128 v[168:171], v19 offset:512
    ds_read_b128 v[156:159], v19 offset:32
    ds_read_b128 v[172:175], v19 offset:544
    ds_read_b128 v[160:163], v19 offset:64
    ds_read_b128 v[176:179], v19 offset:576
    ds_read_b128 v[164:167], v19 offset:96
    ds_read_b128 v[180:183], v19 offset:608
    s_waitcnt lgkmcnt(0)
    v_mul_f32 v168, v148, v168
    v_fma_f32 v64, v64, v152, -v168
    v_mul_f32 v169, v148, v169
    v_fma_f32 v65, v65, v153, -v169
    v_mul_f32 v170, v148, v170
    v_fma_f32 v66, v66, v154, -v170
    v_mul_f32 v171, v148, v171
    v_fma_f32 v67, v67, v155, -v171
    v_mul_f32 v172, v148, v172
    v_fma_f32 v68, v68, v156, -v172
    v_mul_f32 v173, v148, v173
    v_fma_f32 v69, v69, v157, -v173
    v_mul_f32 v174, v148, v174
    v_fma_f32 v70, v70, v158, -v174
    v_mul_f32 v175, v148, v175
    v_fma_f32 v71, v71, v159, -v175
    v_mul_f32 v176, v148, v176
    v_fma_f32 v72, v72, v160, -v176
    v_mul_f32 v177, v148, v177
    v_fma_f32 v73, v73, v161, -v177
    v_mul_f32 v178, v148, v178
    v_fma_f32 v74, v74, v162, -v178
    v_mul_f32 v179, v148, v179
    v_fma_f32 v75, v75, v163, -v179
    v_mul_f32 v180, v148, v180
    v_fma_f32 v76, v76, v164, -v180
    v_mul_f32 v181, v148, v181
    v_fma_f32 v77, v77, v165, -v181
    v_mul_f32 v182, v148, v182
    v_fma_f32 v78, v78, v166, -v182
    v_mul_f32 v183, v148, v183
    v_fma_f32 v79, v79, v167, -v183
    v_cmp_gt_u32 vcc, 28, v15
    v_cmp_eq_u32 s[52:53], 28, v15
    s_nop 1
    v_cndmask_b32 v149, 0, 1.0, s[52:53]
    v_cndmask_b32 v64, v149, v64, vcc
    v_cndmask_b32 v65, v149, v65, vcc
    v_cndmask_b32 v66, v149, v66, vcc
    v_cndmask_b32 v67, v149, v67, vcc
    v_cndmask_b32 v68, v149, v68, vcc
    v_cndmask_b32 v69, v149, v69, vcc
    v_cndmask_b32 v70, v149, v70, vcc
    v_cndmask_b32 v71, v149, v71, vcc
    v_cndmask_b32 v72, v149, v72, vcc
    v_cndmask_b32 v73, v149, v73, vcc
    v_cndmask_b32 v74, v149, v74, vcc
    v_cndmask_b32 v75, v149, v75, vcc
    v_cndmask_b32 v76, v149, v76, vcc
    v_cndmask_b32 v77, v149, v77, vcc
    v_cndmask_b32 v78, v149, v78, vcc
    v_cndmask_b32 v79, v149, v79, vcc
    s_lshl_b32 s29, s26, 2
    s_add_u32 s29, s29, s48
    s_lshl_b32 s29, s29, 6
    s_lshl_b32 s30, s25, 2
    s_add_u32 s29, s29, s30
    s_add_u32 s29, s29, s50
    s_lshl_b32 s55, s29, 11
    v_cvt_pk_bf16_f32 v188, v64, v65
    v_cvt_pk_bf16_f32 v189, v66, v67
    v_cvt_pk_bf16_f32 v190, v68, v69
    v_cvt_pk_bf16_f32 v191, v70, v71
    v_cvt_pk_bf16_f32 v192, v72, v73
    v_cvt_pk_bf16_f32 v193, v74, v75
    v_cvt_pk_bf16_f32 v194, v76, v77
    v_cvt_pk_bf16_f32 v195, v78, v79
    buffer_store_dwordx4 v[188:191], v24, s[12:15], s55 offen
    buffer_store_dwordx4 v[192:195], v24, s[12:15], s55 offen offset:1024
    s_lshl_b32 s29, s48, 7
    s_add_u32 s29, s29, 0
    v_add_u32 v17, s29, v16
    s_lshl_b32 s29, s51, 7
    s_add_u32 s29, s29, 0
    v_add_u32 v19, s29, v18
    ds_read_b32 v148, v17 offset:1024
    ds_read_b128 v[152:155], v19 offset:0
    ds_read_b128 v[168:171], v19 offset:512
    ds_read_b128 v[156:159], v19 offset:32
    ds_read_b128 v[172:175], v19 offset:544
    ds_read_b128 v[160:163], v19 offset:64
    ds_read_b128 v[176:179], v19 offset:576
    ds_read_b128 v[164:167], v19 offset:96
    ds_read_b128 v[180:183], v19 offset:608
    s_waitcnt lgkmcnt(0)
    v_mul_f32 v168, v148, v168
    v_fma_f32 v80, v80, v152, -v168
    v_mul_f32 v169, v148, v169
    v_fma_f32 v81, v81, v153, -v169
    v_mul_f32 v170, v148, v170
    v_fma_f32 v82, v82, v154, -v170
    v_mul_f32 v171, v148, v171
    v_fma_f32 v83, v83, v155, -v171
    v_mul_f32 v172, v148, v172
    v_fma_f32 v84, v84, v156, -v172
    v_mul_f32 v173, v148, v173
    v_fma_f32 v85, v85, v157, -v173
    v_mul_f32 v174, v148, v174
    v_fma_f32 v86, v86, v158, -v174
    v_mul_f32 v175, v148, v175
    v_fma_f32 v87, v87, v159, -v175
    v_mul_f32 v176, v148, v176
    v_fma_f32 v88, v88, v160, -v176
    v_mul_f32 v177, v148, v177
    v_fma_f32 v89, v89, v161, -v177
    v_mul_f32 v178, v148, v178
    v_fma_f32 v90, v90, v162, -v178
    v_mul_f32 v179, v148, v179
    v_fma_f32 v91, v91, v163, -v179
    v_mul_f32 v180, v148, v180
    v_fma_f32 v92, v92, v164, -v180
    v_mul_f32 v181, v148, v181
    v_fma_f32 v93, v93, v165, -v181
    v_mul_f32 v182, v148, v182
    v_fma_f32 v94, v94, v166, -v182
    v_mul_f32 v183, v148, v183
    v_fma_f32 v95, v95, v167, -v183
    v_cmp_gt_u32 vcc, 28, v15
    v_cmp_eq_u32 s[52:53], 28, v15
    s_nop 1
    v_cndmask_b32 v149, 0, 1.0, s[52:53]
    v_cndmask_b32 v80, v149, v80, vcc
    v_cndmask_b32 v81, v149, v81, vcc
    v_cndmask_b32 v82, v149, v82, vcc
    v_cndmask_b32 v83, v149, v83, vcc
    v_cndmask_b32 v84, v149, v84, vcc
    v_cndmask_b32 v85, v149, v85, vcc
    v_cndmask_b32 v86, v149, v86, vcc
    v_cndmask_b32 v87, v149, v87, vcc
    v_cndmask_b32 v88, v149, v88, vcc
    v_cndmask_b32 v89, v149, v89, vcc
    v_cndmask_b32 v90, v149, v90, vcc
    v_cndmask_b32 v91, v149, v91, vcc
    v_cndmask_b32 v92, v149, v92, vcc
    v_cndmask_b32 v93, v149, v93, vcc
    v_cndmask_b32 v94, v149, v94, vcc
    v_cndmask_b32 v95, v149, v95, vcc
    s_lshl_b32 s29, s26, 2
    s_add_u32 s29, s29, s48
    s_lshl_b32 s29, s29, 6
    s_lshl_b32 s30, s25, 2
    s_add_u32 s29, s29, s30
    s_add_u32 s29, s29, s51
    s_lshl_b32 s55, s29, 11
    v_cvt_pk_bf16_f32 v188, v80, v81
    v_cvt_pk_bf16_f32 v189, v82, v83
    v_cvt_pk_bf16_f32 v190, v84, v85
    v_cvt_pk_bf16_f32 v191, v86, v87
    v_cvt_pk_bf16_f32 v192, v88, v89
    v_cvt_pk_bf16_f32 v193, v90, v91
    v_cvt_pk_bf16_f32 v194, v92, v93
    v_cvt_pk_bf16_f32 v195, v94, v95
    buffer_store_dwordx4 v[188:191], v24, s[12:15], s55 offen
    buffer_store_dwordx4 v[192:195], v24, s[12:15], s55 offen offset:1024
    s_lshl_b32 s29, s49, 7
    s_add_u32 s29, s29, 0
    v_add_u32 v17, s29, v16
    s_lshl_b32 s29, s50, 7
    s_add_u32 s29, s29, 0
    v_add_u32 v19, s29, v18
    ds_read_b32 v148, v17 offset:1024
    ds_read_b128 v[152:155], v19 offset:0
    ds_read_b128 v[168:171], v19 offset:512
    ds_read_b128 v[156:159], v19 offset:32
    ds_read_b128 v[172:175], v19 offset:544
    ds_read_b128 v[160:163], v19 offset:64
    ds_read_b128 v[176:179], v19 offset:576
    ds_read_b128 v[164:167], v19 offset:96
    ds_read_b128 v[180:183], v19 offset:608
    s_waitcnt lgkmcnt(0)
    v_mul_f32 v168, v148, v168
    v_fma_f32 v96, v96, v152, -v168
    v_mul_f32 v169, v148, v169
    v_fma_f32 v97, v97, v153, -v169
    v_mul_f32 v170, v148, v170
    v_fma_f32 v98, v98, v154, -v170
    v_mul_f32 v171, v148, v171
    v_fma_f32 v99, v99, v155, -v171
    v_mul_f32 v172, v148, v172
    v_fma_f32 v100, v100, v156, -v172
    v_mul_f32 v173, v148, v173
    v_fma_f32 v101, v101, v157, -v173
    v_mul_f32 v174, v148, v174
    v_fma_f32 v102, v102, v158, -v174
    v_mul_f32 v175, v148, v175
    v_fma_f32 v103, v103, v159, -v175
    v_mul_f32 v176, v148, v176
    v_fma_f32 v104, v104, v160, -v176
    v_mul_f32 v177, v148, v177
    v_fma_f32 v105, v105, v161, -v177
    v_mul_f32 v178, v148, v178
    v_fma_f32 v106, v106, v162, -v178
    v_mul_f32 v179, v148, v179
    v_fma_f32 v107, v107, v163, -v179
    v_mul_f32 v180, v148, v180
    v_fma_f32 v108, v108, v164, -v180
    v_mul_f32 v181, v148, v181
    v_fma_f32 v109, v109, v165, -v181
    v_mul_f32 v182, v148, v182
    v_fma_f32 v110, v110, v166, -v182
    v_mul_f32 v183, v148, v183
    v_fma_f32 v111, v111, v167, -v183
    v_cmp_gt_u32 vcc, 28, v15
    v_cmp_eq_u32 s[52:53], 28, v15
    s_nop 1
    v_cndmask_b32 v149, 0, 1.0, s[52:53]
    v_cndmask_b32 v96, v149, v96, vcc
    v_cndmask_b32 v97, v149, v97, vcc
    v_cndmask_b32 v98, v149, v98, vcc
    v_cndmask_b32 v99, v149, v99, vcc
    v_cndmask_b32 v100, v149, v100, vcc
    v_cndmask_b32 v101, v149, v101, vcc
    v_cndmask_b32 v102, v149, v102, vcc
    v_cndmask_b32 v103, v149, v103, vcc
    v_cndmask_b32 v104, v149, v104, vcc
    v_cndmask_b32 v105, v149, v105, vcc
    v_cndmask_b32 v106, v149, v106, vcc
    v_cndmask_b32 v107, v149, v107, vcc
    v_cndmask_b32 v108, v149, v108, vcc
    v_cndmask_b32 v109, v149, v109, vcc
    v_cndmask_b32 v110, v149, v110, vcc
    v_cndmask_b32 v111, v149, v111, vcc
    s_lshl_b32 s29, s26, 2
    s_add_u32 s29, s29, s49
    s_lshl_b32 s29, s29, 6
    s_lshl_b32 s30, s25, 2
    s_add_u32 s29, s29, s30
    s_add_u32 s29, s29, s50
    s_lshl_b32 s55, s29, 11
    v_cvt_pk_bf16_f32 v188, v96, v97
    v_cvt_pk_bf16_f32 v189, v98, v99
    v_cvt_pk_bf16_f32 v190, v100, v101
    v_cvt_pk_bf16_f32 v191, v102, v103
    v_cvt_pk_bf16_f32 v192, v104, v105
    v_cvt_pk_bf16_f32 v193, v106, v107
    v_cvt_pk_bf16_f32 v194, v108, v109
    v_cvt_pk_bf16_f32 v195, v110, v111
    buffer_store_dwordx4 v[188:191], v24, s[12:15], s55 offen
    buffer_store_dwordx4 v[192:195], v24, s[12:15], s55 offen offset:1024
    s_lshl_b32 s29, s49, 7
    s_add_u32 s29, s29, 0
    v_add_u32 v17, s29, v16
    s_lshl_b32 s29, s51, 7
    s_add_u32 s29, s29, 0
    v_add_u32 v19, s29, v18
    ds_read_b32 v148, v17 offset:1024
    ds_read_b128 v[152:155], v19 offset:0
    ds_read_b128 v[168:171], v19 offset:512
    ds_read_b128 v[156:159], v19 offset:32
    ds_read_b128 v[172:175], v19 offset:544
    ds_read_b128 v[160:163], v19 offset:64
    ds_read_b128 v[176:179], v19 offset:576
    ds_read_b128 v[164:167], v19 offset:96
    ds_read_b128 v[180:183], v19 offset:608
    s_waitcnt lgkmcnt(0)
    v_mul_f32 v168, v148, v168
    v_fma_f32 v112, v112, v152, -v168
    v_mul_f32 v169, v148, v169
    v_fma_f32 v113, v113, v153, -v169
    v_mul_f32 v170, v148, v170
    v_fma_f32 v114, v114, v154, -v170
    v_mul_f32 v171, v148, v171
    v_fma_f32 v115, v115, v155, -v171
    v_mul_f32 v172, v148, v172
    v_fma_f32 v116, v116, v156, -v172
    v_mul_f32 v173, v148, v173
    v_fma_f32 v117, v117, v157, -v173
    v_mul_f32 v174, v148, v174
    v_fma_f32 v118, v118, v158, -v174
    v_mul_f32 v175, v148, v175
    v_fma_f32 v119, v119, v159, -v175
    v_mul_f32 v176, v148, v176
    v_fma_f32 v120, v120, v160, -v176
    v_mul_f32 v177, v148, v177
    v_fma_f32 v121, v121, v161, -v177
    v_mul_f32 v178, v148, v178
    v_fma_f32 v122, v122, v162, -v178
    v_mul_f32 v179, v148, v179
    v_fma_f32 v123, v123, v163, -v179
    v_mul_f32 v180, v148, v180
    v_fma_f32 v124, v124, v164, -v180
    v_mul_f32 v181, v148, v181
    v_fma_f32 v125, v125, v165, -v181
    v_mul_f32 v182, v148, v182
    v_fma_f32 v126, v126, v166, -v182
    v_mul_f32 v183, v148, v183
    v_fma_f32 v127, v127, v167, -v183
    v_cmp_gt_u32 vcc, 28, v15
    v_cmp_eq_u32 s[52:53], 28, v15
    s_nop 1
    v_cndmask_b32 v149, 0, 1.0, s[52:53]
    v_cndmask_b32 v112, v149, v112, vcc
    v_cndmask_b32 v113, v149, v113, vcc
    v_cndmask_b32 v114, v149, v114, vcc
    v_cndmask_b32 v115, v149, v115, vcc
    v_cndmask_b32 v116, v149, v116, vcc
    v_cndmask_b32 v117, v149, v117, vcc
    v_cndmask_b32 v118, v149, v118, vcc
    v_cndmask_b32 v119, v149, v119, vcc
    v_cndmask_b32 v120, v149, v120, vcc
    v_cndmask_b32 v121, v149, v121, vcc
    v_cndmask_b32 v122, v149, v122, vcc
    v_cndmask_b32 v123, v149, v123, vcc
    v_cndmask_b32 v124, v149, v124, vcc
    v_cndmask_b32 v125, v149, v125, vcc
    v_cndmask_b32 v126, v149, v126, vcc
    v_cndmask_b32 v127, v149, v127, vcc
    s_lshl_b32 s29, s26, 2
    s_add_u32 s29, s29, s49
    s_lshl_b32 s29, s29, 6
    s_lshl_b32 s30, s25, 2
    s_add_u32 s29, s29, s30
    s_add_u32 s29, s29, s51
    s_lshl_b32 s55, s29, 11
    v_cvt_pk_bf16_f32 v188, v112, v113
    v_cvt_pk_bf16_f32 v189, v114, v115
    v_cvt_pk_bf16_f32 v190, v116, v117
    v_cvt_pk_bf16_f32 v191, v118, v119
    v_cvt_pk_bf16_f32 v192, v120, v121
    v_cvt_pk_bf16_f32 v193, v122, v123
    v_cvt_pk_bf16_f32 v194, v124, v125
    v_cvt_pk_bf16_f32 v195, v126, v127
    buffer_store_dwordx4 v[188:191], v24, s[12:15], s55 offen
    buffer_store_dwordx4 v[192:195], v24, s[12:15], s55 offen offset:1024
    s_endpgm
sequential_preLN__mha_block__dense_activation_gelu__prompt_kernel_side:
    s_cmp_ge_u32 s2, 220
    s_cbranch_scc1 sequential_preLN__mha_block__dense_activation_gelu__prompt_kernel_end
    s_load_dwordx2 s[32:33], s[0:1], 32
    s_load_dwordx2 s[34:35], s[0:1], 80
    s_load_dwordx2 s[36:37], s[0:1], 40
    s_cmp_lg_u32 s2, 192
    s_cbranch_scc1 sequential_preLN__mha_block__dense_activation_gelu__prompt_kernel_nz
    s_waitcnt lgkmcnt(0)
    s_add_u32 s12, s34, 19922944
    s_addc_u32 s13, s35, 0
    s_mov_b32 s14, 6144
    s_mov_b32 s15, 0x00020000
    v_lshlrev_b32 v2, 7, v0
    v_mov_b32 v3, 0
    buffer_store_dword v3, v2, s[12:15], 0 offen
sequential_preLN__mha_block__dense_activation_gelu__prompt_kernel_nz:
    s_sub_u32 s25, s2, 192
    v_lshrrev_b32 v2, 3, v0
    v_and_b32 v3, 7, v0
    s_waitcnt lgkmcnt(0)
    s_mov_b32 s4, s32
    s_mov_b32 s5, s33
    s_mov_b32 s6, 1605632
    s_mov_b32 s7, 0x00020000
    s_add_u32 s8, s34, 18874368
    s_addc_u32 s9, s35, 0
    s_mov_b32 s10, 14336
    s_mov_b32 s11, 0x00020000
    s_mov_b32 s12, s36
    s_mov_b32 s13, s37
    s_mov_b32 s14, 3584
    s_mov_b32 s15, 0x00020000
    v_mul_u32_u24 v4, 3584, v2
    v_lshl_add_u32 v4, v3, 4, v4
    s_lshl_b32 s26, s25, 7
    s_add_u32 s30, s26, 0
    buffer_load_dwordx4 v[32:35], v4, s[4:7], s30 offen
    s_add_u32 s30, s26, 229376
    buffer_load_dwordx4 v[36:39], v4, s[4:7], s30 offen
    s_add_u32 s30, s26, 458752
    buffer_load_dwordx4 v[40:43], v4, s[4:7], s30 offen
    s_add_u32 s30, s26, 688128
    buffer_load_dwordx4 v[44:47], v4, s[4:7], s30 offen
    s_add_u32 s30, s26, 917504
    buffer_load_dwordx4 v[48:51], v4, s[4:7], s30 offen
    s_add_u32 s30, s26, 1146880
    buffer_load_dwordx4 v[52:55], v4, s[4:7], s30 offen
    s_add_u32 s30, s26, 1376256
    buffer_load_dwordx4 v[56:59], v4, s[4:7], s30 offen
    v_lshlrev_b32 v6, 1, v0
    buffer_load_ushort v7, v6, s[12:15], s26 offen
    v_mov_b32 v16, 0
    v_mov_b32 v17, 0
    v_mov_b32 v18, 0
    v_mov_b32 v19, 0
    v_mov_b32 v20, 0
    v_mov_b32 v21, 0
    v_mov_b32 v22, 0
    v_mov_b32 v23, 0
    s_waitcnt vmcnt(7)
    v_and_b32 v65, 0xffff0000, v32
    v_lshlrev_b32 v64, 16, v32
    v_and_b32 v67, 0xffff0000, v33
    v_lshlrev_b32 v66, 16, v33
    v_and_b32 v69, 0xffff0000, v34
    v_lshlrev_b32 v68, 16, v34
    v_and_b32 v71, 0xffff0000, v35
    v_lshlrev_b32 v70, 16, v35
    v_pk_add_f32 v[16:17], v[16:17], v[64:65]
    v_pk_add_f32 v[18:19], v[18:19], v[66:67]
    v_pk_add_f32 v[20:21], v[20:21], v[68:69]
    v_pk_add_f32 v[22:23], v[22:23], v[70:71]
    s_waitcnt vmcnt(6)
    v_and_b32 v65, 0xffff0000, v36
    v_lshlrev_b32 v64, 16, v36
    v_and_b32 v67, 0xffff0000, v37
    v_lshlrev_b32 v66, 16, v37
    v_and_b32 v69, 0xffff0000, v38
    v_lshlrev_b32 v68, 16, v38
    v_and_b32 v71, 0xffff0000, v39
    v_lshlrev_b32 v70, 16, v39
    v_pk_add_f32 v[16:17], v[16:17], v[64:65]
    v_pk_add_f32 v[18:19], v[18:19], v[66:67]
    v_pk_add_f32 v[20:21], v[20:21], v[68:69]
    v_pk_add_f32 v[22:23], v[22:23], v[70:71]
    s_waitcnt vmcnt(5)
    v_and_b32 v65, 0xffff0000, v40
    v_lshlrev_b32 v64, 16, v40
    v_and_b32 v67, 0xffff0000, v41
    v_lshlrev_b32 v66, 16, v41
    v_and_b32 v69, 0xffff0000, v42
    v_lshlrev_b32 v68, 16, v42
    v_and_b32 v71, 0xffff0000, v43
    v_lshlrev_b32 v70, 16, v43
    v_pk_add_f32 v[16:17], v[16:17], v[64:65]
    v_pk_add_f32 v[18:19], v[18:19], v[66:67]
    v_pk_add_f32 v[20:21], v[20:21], v[68:69]
    v_pk_add_f32 v[22:23], v[22:23], v[70:71]
    s_waitcnt vmcnt(4)
    v_and_b32 v65, 0xffff0000, v44
    v_lshlrev_b32 v64, 16, v44
    v_and_b32 v67, 0xffff0000, v45
    v_lshlrev_b32 v66, 16, v45
    v_and_b32 v69, 0xffff0000, v46
    v_lshlrev_b32 v68, 16, v46
    v_and_b32 v71, 0xffff0000, v47
    v_lshlrev_b32 v70, 16, v47
    v_pk_add_f32 v[16:17], v[16:17], v[64:65]
    v_pk_add_f32 v[18:19], v[18:19], v[66:67]
    v_pk_add_f32 v[20:21], v[20:21], v[68:69]
    v_pk_add_f32 v[22:23], v[22:23], v[70:71]
    s_waitcnt vmcnt(3)
    v_and_b32 v65, 0xffff0000, v48
    v_lshlrev_b32 v64, 16, v48
    v_and_b32 v67, 0xffff0000, v49
    v_lshlrev_b32 v66, 16, v49
    v_and_b32 v69, 0xffff0000, v50
    v_lshlrev_b32 v68, 16, v50
    v_and_b32 v71, 0xffff0000, v51
    v_lshlrev_b32 v70, 16, v51
    v_pk_add_f32 v[16:17], v[16:17], v[64:65]
    v_pk_add_f32 v[18:19], v[18:19], v[66:67]
    v_pk_add_f32 v[20:21], v[20:21], v[68:69]
    v_pk_add_f32 v[22:23], v[22:23], v[70:71]
    s_waitcnt vmcnt(2)
    v_and_b32 v65, 0xffff0000, v52
    v_lshlrev_b32 v64, 16, v52
    v_and_b32 v67, 0xffff0000, v53
    v_lshlrev_b32 v66, 16, v53
    v_and_b32 v69, 0xffff0000, v54
    v_lshlrev_b32 v68, 16, v54
    v_and_b32 v71, 0xffff0000, v55
    v_lshlrev_b32 v70, 16, v55
    v_pk_add_f32 v[16:17], v[16:17], v[64:65]
    v_pk_add_f32 v[18:19], v[18:19], v[66:67]
    v_pk_add_f32 v[20:21], v[20:21], v[68:69]
    v_pk_add_f32 v[22:23], v[22:23], v[70:71]
    s_waitcnt vmcnt(1)
    v_and_b32 v65, 0xffff0000, v56
    v_lshlrev_b32 v64, 16, v56
    v_and_b32 v67, 0xffff0000, v57
    v_lshlrev_b32 v66, 16, v57
    v_and_b32 v69, 0xffff0000, v58
    v_lshlrev_b32 v68, 16, v58
    v_and_b32 v71, 0xffff0000, v59
    v_lshlrev_b32 v70, 16, v59
    v_pk_add_f32 v[16:17], v[16:17], v[64:65]
    v_pk_add_f32 v[18:19], v[18:19], v[66:67]
    v_pk_add_f32 v[20:21], v[20:21], v[68:69]
    v_pk_add_f32 v[22:23], v[22:23], v[70:71]
    v_lshlrev_b32 v5, 5, v0
    ds_write_b128 v5, v[16:19]
    ds_write_b128 v5, v[20:23] offset:16
    s_waitcnt lgkmcnt(0)
    s_barrier
    v_and_b32 v8, 63, v0
    v_lshrrev_b32 v9, 6, v0
    v_lshlrev_b32 v5, 2, v8
    v_lshl_add_u32 v5, v9, 11, v5
    ds_read_b32 v16, v5 offset:0
    ds_read_b32 v17, v5 offset:256
    ds_read_b32 v18, v5 offset:512
    ds_read_b32 v19, v5 offset:768
    ds_read_b32 v20, v5 offset:1024
    ds_read_b32 v21, v5 offset:1280
    ds_read_b32 v22, v5 offset:1536
    ds_read_b32 v23, v5 offset:1792
    s_waitcnt lgkmcnt(0)
    v_add_f32 v16, v16, v17
    v_add_f32 v16, v16, v18
    v_add_f32 v16, v16, v19
    v_add_f32 v16, v16, v20
    v_add_f32 v16, v16, v21
    v_add_f32 v16, v16, v22
    v_add_f32 v16, v16, v23
    s_barrier
    v_lshlrev_b32 v5, 2, v0
    ds_write_b32 v5, v16
    s_waitcnt lgkmcnt(0)
    s_barrier
    v_cmp_gt_u32 vcc, 64, v0
    s_and_saveexec_b64 s[50:51], vcc
    s_cbranch_execz sequential_preLN__mha_block__dense_activation_gelu__prompt_kernel_end
    ds_read_b32 v16, v5 offset:0
    ds_read_b32 v17, v5 offset:256
    ds_read_b32 v18, v5 offset:512
    ds_read_b32 v19, v5 offset:768
    ds_read_b32 v20, v5 offset:1024
    ds_read_b32 v21, v5 offset:1280
    ds_read_b32 v22, v5 offset:1536
    ds_read_b32 v23, v5 offset:1792
    s_waitcnt vmcnt(0) lgkmcnt(0)
    v_add_f32 v16, v16, v17
    v_add_f32 v16, v16, v18
    v_add_f32 v16, v16, v19
    v_add_f32 v16, v16, v20
    v_add_f32 v16, v16, v21
    v_add_f32 v16, v16, v22
    v_add_f32 v16, v16, v23
    v_lshlrev_b32 v7, 16, v7
    s_lshl_b32 s26, s25, 8
    s_add_u32 s30, s26, 7168
    buffer_store_dword v16, v5, s[8:11], s26 offen
    buffer_store_dword v7, v5, s[8:11], s30 offen
    s_endpgm
sequential_preLN__mha_block__dense_activation_gelu__prompt_kernel_end:
    s_endpgm
.globl attn_kernel
.p2align 8
.type attn_kernel,@function
attn_kernel:
    s_cmp_ge_u32 s2, 256
    s_cbranch_scc1 attn_kernel_end
    s_load_dwordx2 s[34:35], s[0:1], 80
    s_load_dwordx2 s[36:37], s[0:1], 48
    s_load_dwordx2 s[38:39], s[0:1], 16
    v_lshrrev_b32 v1, 6, v0
    v_and_b32 v0, 63, v0
    s_nop 0
    v_readfirstlane_b32 s24, v1
    s_and_b32 s27, s2, 7
    s_lshr_b32 s28, s2, 3
    s_and_b32 s25, s28, 1
    s_lshl_b32 s27, s27, 1
    s_add_u32 s25, s25, s27
    s_lshr_b32 s26, s28, 1
    s_mov_b32 s46, 0
    s_mov_b32 s47, -1
    s_mov_b32 s44, 0x5d800000
    s_mov_b32 s45, 0
    s_mov_b32 s54, 0x07060302
    v_lshlrev_b32 v1, 4, v0
    s_waitcnt lgkmcnt(0)
    s_mov_b32 s4, s34
    s_mov_b32 s5, s35
    s_mov_b32 s6, 6291456
    s_mov_b32 s7, 0x00020000
    s_add_u32 s8, s34, 6291456
    s_addc_u32 s9, s35, 0
    s_mov_b32 s10, 2097152
    s_mov_b32 s11, 0x00020000
    s_lshl_b32 s55, s2, 3
    s_add_u32 s55, s55, s24
    s_cmp_lt_u32 s55, 1568
    s_cselect_b32 s12, s36, s38
    s_cselect_b32 s13, s37, s39
    s_mov_b32 s29, 401408
    s_cselect_b32 s14, 1605632, s29
    s_mov_b32 s15, 0x00020000
    s_cselect_b32 s29, 0, 1568
    s_sub_u32 s55, s55, s29
    s_lshl_b32 s55, s55, 10
    s_lshl_b32 s29, s25, 6
    s_lshl_b32 s30, s26, 2
    s_add_u32 s30, s30, s29
    s_lshl_b32 s43, s30, 11
    s_lshl_b32 s30, s24, 3
    s_add_u32 s30, s30, s29
    s_lshl_b32 s42, s30, 11
    s_add_u32 s42, s42, 2097152
    s_lshl_b32 s29, s24, 10
    s_add_u32 m0, s29, 135424
    s_add_u32 s30, s43, s29
    buffer_load_dwordx4 v1, s[4:7], s30 offen lds
    v_mov_b32 v2, 135168
    v_mov_b32 v3, 0
    ds_write_b32 v2, v3
    s_cmp_lt_u32 s24, 4
    s_cbranch_scc1 attn_kernel_np
    s_setprio 1
attn_kernel_np:
    s_add_u32 s30, s42, 0
    buffer_load_dwordx4 v[176:179], v1, s[4:7], s30 offen
    buffer_load_dwordx4 v[180:183], v1, s[4:7], s30 offen offset:1024
    s_add_u32 s30, s30, 2097152
    buffer_load_dwordx4 v[184:187], v1, s[4:7], s30 offen
    buffer_load_dwordx4 v[188:191], v1, s[4:7], s30 offen offset:1024
    s_add_u32 s30, s42, 2048
    buffer_load_dwordx4 v[192:195], v1, s[4:7], s30 offen
    buffer_load_dwordx4 v[196:199], v1, s[4:7], s30 offen offset:1024
    s_add_u32 s30, s30, 2097152
    buffer_load_dwordx4 v[200:203], v1, s[4:7], s30 offen
    buffer_load_dwordx4 v[204:207], v1, s[4:7], s30 offen offset:1024
    v_mov_b32 v64, 0
    v_mov_b32 v65, 0
    v_mov_b32 v66, 0
    v_mov_b32 v67, 0
    v_mov_b32 v68, 0
    v_mov_b32 v69, 0
    v_mov_b32 v70, 0
    v_mov_b32 v71, 0
    v_mov_b32 v72, 0
    v_mov_b32 v73, 0
    v_mov_b32 v74, 0
    v_mov_b32 v75, 0
    v_mov_b32 v76, 0
    v_mov_b32 v77, 0
    v_mov_b32 v78, 0
    v_mov_b32 v79, 0
    v_mov_b32 v80, 0
    v_mov_b32 v81, 0
    v_mov_b32 v82, 0
    v_mov_b32 v83, 0
    v_mov_b32 v84, 0
    v_mov_b32 v85, 0
    v_mov_b32 v86, 0
    v_mov_b32 v87, 0
    v_mov_b32 v88, 0
    v_mov_b32 v89, 0
    v_mov_b32 v90, 0
    v_mov_b32 v91, 0
    v_mov_b32 v92, 0
    v_mov_b32 v93, 0
    v_mov_b32 v94, 0
    v_mov_b32 v95, 0
    v_mov_b32 v96, 0
    v_mov_b32 v97, 0
    v_mov_b32 v98, 0
    v_mov_b32 v99, 0
    v_mov_b32 v100, 0
    v_mov_b32 v101, 0
    v_mov_b32 v102, 0
    v_mov_b32 v103, 0
    v_mov_b32 v104, 0
    v_mov_b32 v105, 0
    v_mov_b32 v106, 0
    v_mov_b32 v107, 0
    v_mov_b32 v108, 0
    v_mov_b32 v109, 0
    v_mov_b32 v110, 0
    v_mov_b32 v111, 0
    v_mov_b32 v112, 0
    v_mov_b32 v113, 0
    v_mov_b32 v114, 0
    v_mov_b32 v115, 0
    v_mov_b32 v116, 0
    v_mov_b32 v117, 0
    v_mov_b32 v118, 0
    v_mov_b32 v119, 0
    v_mov_b32 v120, 0
    v_mov_b32 v121, 0
    v_mov_b32 v122, 0
    v_mov_b32 v123, 0
    v_mov_b32 v124, 0
    v_mov_b32 v125, 0
    v_mov_b32 v126, 0
    v_mov_b32 v127, 0
    s_waitcnt vmcnt(8)
    s_barrier
    v_add_u32 v2, 135424, v1
    ds_read_b128 v[32:35], v2 offset:0
    ds_read_b128 v[36:39], v2 offset:1024
    ds_read_b128 v[40:43], v2 offset:2048
    ds_read_b128 v[44:47], v2 offset:3072
    ds_read_b128 v[48:51], v2 offset:4096
    ds_read_b128 v[52:55], v2 offset:5120
    ds_read_b128 v[56:59], v2 offset:6144
    ds_read_b128 v[60:63], v2 offset:7168
    s_waitcnt vmcnt(6) lgkmcnt(0)
    v_mfma_f32_32x32x16_bf16 v[128:143], v[176:179], v[32:35], 0
    v_mfma_f32_32x32x16_bf16 v[128:143], v[180:183], v[36:39], v[128:143]
    s_nop 7
    s_nop 3
    v_mfma_f32_32x32x16_bf16 v[144:159], v[176:179], v[40:43], 0
    v_exp_f32 v128, v128
    v_exp_f32 v129, v129
    v_exp_f32 v130, v130
    v_exp_f32 v131, v131
    v_cvt_pk_bf16_f32 v160, v128, v129
    v_cvt_pk_bf16_f32 v161, v130, v131
    v_mfma_f32_32x32x16_bf16 v[144:159], v[180:183], v[44:47], v[144:159]
    v_exp_f32 v132, v132
    v_exp_f32 v133, v133
    v_exp_f32 v134, v134
    v_exp_f32 v135, v135
    v_cvt_pk_bf16_f32 v162, v132, v133
    v_cvt_pk_bf16_f32 v163, v134, v135
    v_exp_f32 v136, v136
    v_exp_f32 v137, v137
    v_exp_f32 v138, v138
    v_exp_f32 v139, v139
    v_cvt_pk_bf16_f32 v164, v136, v137
    v_cvt_pk_bf16_f32 v165, v138, v139
    v_exp_f32 v140, v140
    v_exp_f32 v141, v141
    v_exp_f32 v142, v142
    v_exp_f32 v143, v143
    v_cvt_pk_bf16_f32 v166, v140, v141
    v_cvt_pk_bf16_f32 v167, v142, v143
    s_waitcnt vmcnt(4)
    v_mfma_f32_32x32x16_bf16 v[128:143], v[176:179], v[48:51], 0
    v_exp_f32 v144, v144
    v_exp_f32 v145, v145
    v_exp_f32 v146, v146
    v_exp_f32 v147, v147
    v_cvt_pk_bf16_f32 v168, v144, v145
    v_cvt_pk_bf16_f32 v169, v146, v147
    v_mfma_f32_32x32x16_bf16 v[128:143], v[180:183], v[52:55], v[128:143]
    v_exp_f32 v148, v148
    v_exp_f32 v149, v149
    v_exp_f32 v150, v150
    v_exp_f32 v151, v151
    v_cvt_pk_bf16_f32 v170, v148, v149
    v_cvt_pk_bf16_f32 v171, v150, v151
    v_mfma_f32_32x32x16_bf16 v[64:79], v[184:187], v[160:163], v[64:79]
    v_exp_f32 v152, v152
    v_exp_f32 v153, v153
    v_exp_f32 v154, v154
    v_exp_f32 v155, v155
    v_cvt_pk_bf16_f32 v172, v152, v153
    v_cvt_pk_bf16_f32 v173, v154, v155
    v_mfma_f32_32x32x16_bf16 v[64:79], v[188:191], v[164:167], v[64:79]
    v_exp_f32 v156, v156
    v_exp_f32 v157, v157
    v_exp_f32 v158, v158
    v_exp_f32 v159, v159
    v_cvt_pk_bf16_f32 v174, v156, v157
    v_cvt_pk_bf16_f32 v175, v158, v159
    s_add_u32 s30, s42, 4096
    buffer_load_dwordx4 v[208:211], v1, s[4:7], s30 offen
    buffer_load_dwordx4 v[212:215], v1, s[4:7], s30 offen offset:1024
    s_add_u32 s30, s30, 2097152
    buffer_load_dwordx4 v[216:219], v1, s[4:7], s30 offen
    buffer_load_dwordx4 v[220:223], v1, s[4:7], s30 offen offset:1024
    v_mfma_f32_32x32x16_bf16 v[144:159], v[176:179], v[56:59], 0
    v_exp_f32 v128, v128
    v_exp_f32 v129, v129
    v_exp_f32 v130, v130
    v_exp_f32 v131, v131
    v_cvt_pk_bf16_f32 v160, v128, v129
    v_cvt_pk_bf16_f32 v161, v130, v131
    v_mfma_f32_32x32x16_bf16 v[144:159], v[180:183], v[60:63], v[144:159]
    v_exp_f32 v132, v132
    v_exp_f32 v133, v133
    v_exp_f32 v134, v134
    v_exp_f32 v135, v135
    v_cvt_pk_bf16_f32 v162, v132, v133
    v_cvt_pk_bf16_f32 v163, v134, v135
    v_mfma_f32_32x32x16_bf16 v[80:95], v[184:187], v[168:171], v[80:95]
    v_exp_f32 v136, v136
    v_exp_f32 v137, v137
    v_exp_f32 v138, v138
    v_exp_f32 v139, v139
    v_cvt_pk_bf16_f32 v164, v136, v137
    v_cvt_pk_bf16_f32 v165, v138, v139
    v_mfma_f32_32x32x16_bf16 v[80:95], v[188:191], v[172:175], v[80:95]
    v_exp_f32 v140, v140
    v_exp_f32 v141, v141
    v_exp_f32 v142, v142
    v_exp_f32 v143, v143
    v_cvt_pk_bf16_f32 v166, v140, v141
    v_cvt_pk_bf16_f32 v167, v142, v143
    s_waitcnt vmcnt(4)
    v_mfma_f32_32x32x16_bf16 v[128:143], v[192:195], v[32:35], 0
    v_exp_f32 v144, v144
    v_exp_f32 v145, v145
    v_exp_f32 v146, v146
    v_exp_f32 v147, v147
    v_cvt_pk_bf16_f32 v168, v144, v145
    v_cvt_pk_bf16_f32 v169, v146, v147
    v_mfma_f32_32x32x16_bf16 v[128:143], v[196:199], v[36:39], v[128:143]
    v_exp_f32 v148, v148
    v_exp_f32 v149, v149
    v_exp_f32 v150, v150
    v_exp_f32 v151, v151
    v_cvt_pk_bf16_f32 v170, v148, v149
    v_cvt_pk_bf16_f32 v171, v150, v151
    v_mfma_f32_32x32x16_bf16 v[96:111], v[184:187], v[160:163], v[96:111]
    v_exp_f32 v152, v152
    v_exp_f32 v153, v153
    v_exp_f32 v154, v154
    v_exp_f32 v155, v155
    v_cvt_pk_bf16_f32 v172, v152, v153
    v_cvt_pk_bf16_f32 v173, v154, v155
    v_mfma_f32_32x32x16_bf16 v[96:111], v[188:191], v[164:167], v[96:111]
    v_exp_f32 v156, v156
    v_exp_f32 v157, v157
    v_exp_f32 v158, v158
    v_exp_f32 v159, v159
    v_cvt_pk_bf16_f32 v174, v156, v157
    v_cvt_pk_bf16_f32 v175, v158, v159
    v_mfma_f32_32x32x16_bf16 v[144:159], v[192:195], v[40:43], 0
    v_exp_f32 v128, v128
    v_exp_f32 v129, v129
    v_exp_f32 v130, v130
    v_exp_f32 v131, v131
    v_cvt_pk_bf16_f32 v160, v128, v129
    v_cvt_pk_bf16_f32 v161, v130, v131
    v_mfma_f32_32x32x16_bf16 v[144:159], v[196:199], v[44:47], v[144:159]
    v_exp_f32 v132, v132
    v_exp_f32 v133, v133
    v_exp_f32 v134, v134
    v_exp_f32 v135, v135
    v_cvt_pk_bf16_f32 v162, v132, v133
    v_cvt_pk_bf16_f32 v163, v134, v135
    v_mfma_f32_32x32x16_bf16 v[112:127], v[184:187], v[168:171], v[112:127]
    v_exp_f32 v136, v136
    v_exp_f32 v137, v137
    v_exp_f32 v138, v138
    v_exp_f32 v139, v139
    v_cvt_pk_bf16_f32 v164, v136, v137
    v_cvt_pk_bf16_f32 v165, v138, v139
    v_mfma_f32_32x32x16_bf16 v[112:127], v[188:191], v[172:175], v[112:127]
    v_exp_f32 v140, v140
    v_exp_f32 v141, v141
    v_exp_f32 v142, v142
    v_exp_f32 v143, v143
    v_cvt_pk_bf16_f32 v166, v140, v141
    v_cvt_pk_bf16_f32 v167, v142, v143
    v_mfma_f32_32x32x16_bf16 v[128:143], v[192:195], v[48:51], 0
    v_exp_f32 v144, v144
    v_exp_f32 v145, v145
    v_exp_f32 v146, v146
    v_exp_f32 v147, v147
    v_cvt_pk_bf16_f32 v168, v144, v145
    v_cvt_pk_bf16_f32 v169, v146, v147
    v_mfma_f32_32x32x16_bf16 v[128:143], v[196:199], v[52:55], v[128:143]
    v_exp_f32 v148, v148
    v_exp_f32 v149, v149
    v_exp_f32 v150, v150
    v_exp_f32 v151, v151
    v_cvt_pk_bf16_f32 v170, v148, v149
    v_cvt_pk_bf16_f32 v171, v150, v151
    v_mfma_f32_32x32x16_bf16 v[64:79], v[200:203], v[160:163], v[64:79]
    v_exp_f32 v152, v152
    v_exp_f32 v153, v153
    v_exp_f32 v154, v154
    v_exp_f32 v155, v155
    v_cvt_pk_bf16_f32 v172, v152, v153
    v_cvt_pk_bf16_f32 v173, v154, v155
    v_mfma_f32_32x32x16_bf16 v[64:79], v[204:207], v[164:167], v[64:79]
    v_exp_f32 v156, v156
    v_exp_f32 v157, v157
    v_exp_f32 v158, v158
    v_exp_f32 v159, v159
    v_cvt_pk_bf16_f32 v174, v156, v157
    v_cvt_pk_bf16_f32 v175, v158, v159
    s_add_u32 s30, s42, 6144
    buffer_load_dwordx4 v[176:179], v1, s[4:7], s30 offen
    buffer_load_dwordx4 v[180:183], v1, s[4:7], s30 offen offset:1024
    s_add_u32 s30, s30, 2097152
    buffer_load_dwordx4 v[184:187], v1, s[4:7], s30 offen
    buffer_load_dwordx4 v[188:191], v1, s[4:7], s30 offen offset:1024
    v_mfma_f32_32x32x16_bf16 v[144:159], v[192:195], v[56:59], 0
    v_exp_f32 v128, v128
    v_exp_f32 v129, v129
    v_exp_f32 v130, v130
    v_exp_f32 v131, v131
    v_cvt_pk_bf16_f32 v160, v128, v129
    v_cvt_pk_bf16_f32 v161, v130, v131
    v_mfma_f32_32x32x16_bf16 v[144:159], v[196:199], v[60:63], v[144:159]
    v_exp_f32 v132, v132
    v_exp_f32 v133, v133
    v_exp_f32 v134, v134
    v_exp_f32 v135, v135
    v_cvt_pk_bf16_f32 v162, v132, v133
    v_cvt_pk_bf16_f32 v163, v134, v135
    v_mfma_f32_32x32x16_bf16 v[80:95], v[200:203], v[168:171], v[80:95]
    v_exp_f32 v136, v136
    v_exp_f32 v137, v137
    v_exp_f32 v138, v138
    v_exp_f32 v139, v139
    v_cvt_pk_bf16_f32 v164, v136, v137
    v_cvt_pk_bf16_f32 v165, v138, v139
    v_mfma_f32_32x32x16_bf16 v[80:95], v[204:207], v[172:175], v[80:95]
    v_exp_f32 v140, v140
    v_exp_f32 v141, v141
    v_exp_f32 v142, v142
    v_exp_f32 v143, v143
    v_cvt_pk_bf16_f32 v166, v140, v141
    v_cvt_pk_bf16_f32 v167, v142, v143
    s_waitcnt vmcnt(4)
    v_mfma_f32_32x32x16_bf16 v[128:143], v[208:211], v[32:35], 0
    v_exp_f32 v144, v144
    v_exp_f32 v145, v145
    v_exp_f32 v146, v146
    v_exp_f32 v147, v147
    v_cvt_pk_bf16_f32 v168, v144, v145
    v_cvt_pk_bf16_f32 v169, v146, v147
    v_mfma_f32_32x32x16_bf16 v[128:143], v[212:215], v[36:39], v[128:143]
    v_exp_f32 v148, v148
    v_exp_f32 v149, v149
    v_exp_f32 v150, v150
    v_exp_f32 v151, v151
    v_cvt_pk_bf16_f32 v170, v148, v149
    v_cvt_pk_bf16_f32 v171, v150, v151
    v_mfma_f32_32x32x16_bf16 v[96:111], v[200:203], v[160:163], v[96:111]
    v_exp_f32 v152, v152
    v_exp_f32 v153, v153
    v_exp_f32 v154, v154
    v_exp_f32 v155, v155
    v_cvt_pk_bf16_f32 v172, v152, v153
    v_cvt_pk_bf16_f32 v173, v154, v155
    v_mfma_f32_32x32x16_bf16 v[96:111], v[204:207], v[164:167], v[96:111]
    v_exp_f32 v156, v156
    v_exp_f32 v157, v157
    v_exp_f32 v158, v158
    v_exp_f32 v159, v159
    v_cvt_pk_bf16_f32 v174, v156, v157
    v_cvt_pk_bf16_f32 v175, v158, v159
    v_mfma_f32_32x32x16_bf16 v[144:159], v[208:211], v[40:43], 0
    v_exp_f32 v128, v128
    v_exp_f32 v129, v129
    v_exp_f32 v130, v130
    v_exp_f32 v131, v131
    v_cvt_pk_bf16_f32 v160, v128, v129
    v_cvt_pk_bf16_f32 v161, v130, v131
    v_mfma_f32_32x32x16_bf16 v[144:159], v[212:215], v[44:47], v[144:159]
    v_exp_f32 v132, v132
    v_exp_f32 v133, v133
    v_exp_f32 v134, v134
    v_exp_f32 v135, v135
    v_cvt_pk_bf16_f32 v162, v132, v133
    v_cvt_pk_bf16_f32 v163, v134, v135
    v_mfma_f32_32x32x16_bf16 v[112:127], v[200:203], v[168:171], v[112:127]
    v_exp_f32 v136, v136
    v_exp_f32 v137, v137
    v_exp_f32 v138, v138
    v_exp_f32 v139, v139
    v_cvt_pk_bf16_f32 v164, v136, v137
    v_cvt_pk_bf16_f32 v165, v138, v139
    v_mfma_f32_32x32x16_bf16 v[112:127], v[204:207], v[172:175], v[112:127]
    v_exp_f32 v140, v140
    v_exp_f32 v141, v141
    v_exp_f32 v142, v142
    v_exp_f32 v143, v143
    v_cvt_pk_bf16_f32 v166, v140, v141
    v_cvt_pk_bf16_f32 v167, v142, v143
    v_mfma_f32_32x32x16_bf16 v[128:143], v[208:211], v[48:51], 0
    v_exp_f32 v144, v144
    v_exp_f32 v145, v145
    v_exp_f32 v146, v146
    v_exp_f32 v147, v147
    v_cvt_pk_bf16_f32 v168, v144, v145
    v_cvt_pk_bf16_f32 v169, v146, v147
    v_mfma_f32_32x32x16_bf16 v[128:143], v[212:215], v[52:55], v[128:143]
    v_exp_f32 v148, v148
    v_exp_f32 v149, v149
    v_exp_f32 v150, v150
    v_exp_f32 v151, v151
    v_cvt_pk_bf16_f32 v170, v148, v149
    v_cvt_pk_bf16_f32 v171, v150, v151
    v_mfma_f32_32x32x16_bf16 v[64:79], v[216:219], v[160:163], v[64:79]
    v_exp_f32 v152, v152
    v_exp_f32 v153, v153
    v_exp_f32 v154, v154
    v_exp_f32 v155, v155
    v_cvt_pk_bf16_f32 v172, v152, v153
    v_cvt_pk_bf16_f32 v173, v154, v155
    v_mfma_f32_32x32x16_bf16 v[64:79], v[220:223], v[164:167], v[64:79]
    v_exp_f32 v156, v156
    v_exp_f32 v157, v157
    v_exp_f32 v158, v158
    v_exp_f32 v159, v159
    v_cvt_pk_bf16_f32 v174, v156, v157
    v_cvt_pk_bf16_f32 v175, v158, v159
    s_add_u32 s30, s42, 8192
    buffer_load_dwordx4 v[192:195], v1, s[4:7], s30 offen
    buffer_load_dwordx4 v[196:199], v1, s[4:7], s30 offen offset:1024
    s_add_u32 s30, s30, 2097152
    buffer_load_dwordx4 v[200:203], v1, s[4:7], s30 offen
    buffer_load_dwordx4 v[204:207], v1, s[4:7], s30 offen offset:1024
    v_mfma_f32_32x32x16_bf16 v[144:159], v[208:211], v[56:59], 0
    v_exp_f32 v128, v128
    v_exp_f32 v129, v129
    v_exp_f32 v130, v130
    v_exp_f32 v131, v131
    v_cvt_pk_bf16_f32 v160, v128, v129
    v_cvt_pk_bf16_f32 v161, v130, v131
    v_mfma_f32_32x32x16_bf16 v[144:159], v[212:215], v[60:63], v[144:159]
    v_exp_f32 v132, v132
    v_exp_f32 v133, v133
    v_exp_f32 v134, v134
    v_exp_f32 v135, v135
    v_cvt_pk_bf16_f32 v162, v132, v133
    v_cvt_pk_bf16_f32 v163, v134, v135
    v_mfma_f32_32x32x16_bf16 v[80:95], v[216:219], v[168:171], v[80:95]
    v_exp_f32 v136, v136
    v_exp_f32 v137, v137
    v_exp_f32 v138, v138
    v_exp_f32 v139, v139
    v_cvt_pk_bf16_f32 v164, v136, v137
    v_cvt_pk_bf16_f32 v165, v138, v139
    v_mfma_f32_32x32x16_bf16 v[80:95], v[220:223], v[172:175], v[80:95]
    v_exp_f32 v140, v140
    v_exp_f32 v141, v141
    v_exp_f32 v142, v142
    v_exp_f32 v143, v143
    v_cvt_pk_bf16_f32 v166, v140, v141
    v_cvt_pk_bf16_f32 v167, v142, v143
    s_waitcnt vmcnt(4)
    v_mfma_f32_32x32x16_bf16 v[128:143], v[176:179], v[32:35], 0
    v_exp_f32 v144, v144
    v_exp_f32 v145, v145
    v_exp_f32 v146, v146
    v_exp_f32 v147, v147
    v_cvt_pk_bf16_f32 v168, v144, v145
    v_cvt_pk_bf16_f32 v169, v146, v147
    v_mfma_f32_32x32x16_bf16 v[128:143], v[180:183], v[36:39], v[128:143]
    v_exp_f32 v148, v148
    v_exp_f32 v149, v149
    v_exp_f32 v150, v150
    v_exp_f32 v151, v151
    v_cvt_pk_bf16_f32 v170, v148, v149
    v_cvt_pk_bf16_f32 v171, v150, v151
    v_mfma_f32_32x32x16_bf16 v[96:111], v[216:219], v[160:163], v[96:111]
    v_exp_f32 v152, v152
    v_exp_f32 v153, v153
    v_exp_f32 v154, v154
    v_exp_f32 v155, v155
    v_cvt_pk_bf16_f32 v172, v152, v153
    v_cvt_pk_bf16_f32 v173, v154, v155
    v_mfma_f32_32x32x16_bf16 v[96:111], v[220:223], v[164:167], v[96:111]
    v_exp_f32 v156, v156
    v_exp_f32 v157, v157
    v_exp_f32 v158, v158
    v_exp_f32 v159, v159
    v_cvt_pk_bf16_f32 v174, v156, v157
    v_cvt_pk_bf16_f32 v175, v158, v159
    v_mfma_f32_32x32x16_bf16 v[144:159], v[176:179], v[40:43], 0
    v_exp_f32 v128, v128
    v_exp_f32 v129, v129
    v_exp_f32 v130, v130
    v_exp_f32 v131, v131
    v_cvt_pk_bf16_f32 v160, v128, v129
    v_cvt_pk_bf16_f32 v161, v130, v131
    v_mfma_f32_32x32x16_bf16 v[144:159], v[180:183], v[44:47], v[144:159]
    v_exp_f32 v132, v132
    v_exp_f32 v133, v133
    v_exp_f32 v134, v134
    v_exp_f32 v135, v135
    v_cvt_pk_bf16_f32 v162, v132, v133
    v_cvt_pk_bf16_f32 v163, v134, v135
    v_mfma_f32_32x32x16_bf16 v[112:127], v[216:219], v[168:171], v[112:127]
    v_exp_f32 v136, v136
    v_exp_f32 v137, v137
    v_exp_f32 v138, v138
    v_exp_f32 v139, v139
    v_cvt_pk_bf16_f32 v164, v136, v137
    v_cvt_pk_bf16_f32 v165, v138, v139
    v_mfma_f32_32x32x16_bf16 v[112:127], v[220:223], v[172:175], v[112:127]
    v_exp_f32 v140, v140
    v_exp_f32 v141, v141
    v_exp_f32 v142, v142
    v_exp_f32 v143, v143
    v_cvt_pk_bf16_f32 v166, v140, v141
    v_cvt_pk_bf16_f32 v167, v142, v143
    v_mfma_f32_32x32x16_bf16 v[128:143], v[176:179], v[48:51], 0
    v_exp_f32 v144, v144
    v_exp_f32 v145, v145
    v_exp_f32 v146, v146
    v_exp_f32 v147, v147
    v_cvt_pk_bf16_f32 v168, v144, v145
    v_cvt_pk_bf16_f32 v169, v146, v147
    v_mfma_f32_32x32x16_bf16 v[128:143], v[180:183], v[52:55], v[128:143]
    v_exp_f32 v148, v148
    v_exp_f32 v149, v149
    v_exp_f32 v150, v150
    v_exp_f32 v151, v151
    v_cvt_pk_bf16_f32 v170, v148, v149
    v_cvt_pk_bf16_f32 v171, v150, v151
    v_mfma_f32_32x32x16_bf16 v[64:79], v[184:187], v[160:163], v[64:79]
    v_exp_f32 v152, v152
    v_exp_f32 v153, v153
    v_exp_f32 v154, v154
    v_exp_f32 v155, v155
    v_cvt_pk_bf16_f32 v172, v152, v153
    v_cvt_pk_bf16_f32 v173, v154, v155
    v_mfma_f32_32x32x16_bf16 v[64:79], v[188:191], v[164:167], v[64:79]
    v_exp_f32 v156, v156
    v_exp_f32 v157, v157
    v_exp_f32 v158, v158
    v_exp_f32 v159, v159
    v_cvt_pk_bf16_f32 v174, v156, v157
    v_cvt_pk_bf16_f32 v175, v158, v159
    s_add_u32 s30, s42, 10240
    buffer_load_dwordx4 v[208:211], v1, s[4:7], s30 offen
    buffer_load_dwordx4 v[212:215], v1, s[4:7], s30 offen offset:1024
    s_add_u32 s30, s30, 2097152
    buffer_load_dwordx4 v[216:219], v1, s[4:7], s30 offen
    buffer_load_dwordx4 v[220:223], v1, s[4:7], s30 offen offset:1024
    v_mfma_f32_32x32x16_bf16 v[144:159], v[176:179], v[56:59], 0
    v_exp_f32 v128, v128
    v_exp_f32 v129, v129
    v_exp_f32 v130, v130
    v_exp_f32 v131, v131
    v_cvt_pk_bf16_f32 v160, v128, v129
    v_cvt_pk_bf16_f32 v161, v130, v131
    v_mfma_f32_32x32x16_bf16 v[144:159], v[180:183], v[60:63], v[144:159]
    v_exp_f32 v132, v132
    v_exp_f32 v133, v133
    v_exp_f32 v134, v134
    v_exp_f32 v135, v135
    v_cvt_pk_bf16_f32 v162, v132, v133
    v_cvt_pk_bf16_f32 v163, v134, v135
    v_mfma_f32_32x32x16_bf16 v[80:95], v[184:187], v[168:171], v[80:95]
    v_exp_f32 v136, v136
    v_exp_f32 v137, v137
    v_exp_f32 v138, v138
    v_exp_f32 v139, v139
    v_cvt_pk_bf16_f32 v164, v136, v137
    v_cvt_pk_bf16_f32 v165, v138, v139
    v_mfma_f32_32x32x16_bf16 v[80:95], v[188:191], v[172:175], v[80:95]
    v_exp_f32 v140, v140
    v_exp_f32 v141, v141
    v_exp_f32 v142, v142
    v_exp_f32 v143, v143
    v_cvt_pk_bf16_f32 v166, v140, v141
    v_cvt_pk_bf16_f32 v167, v142, v143
    s_waitcnt vmcnt(4)
    v_mfma_f32_32x32x16_bf16 v[128:143], v[192:195], v[32:35], 0
    v_exp_f32 v144, v144
    v_exp_f32 v145, v145
    v_exp_f32 v146, v146
    v_exp_f32 v147, v147
    v_cvt_pk_bf16_f32 v168, v144, v145
    v_cvt_pk_bf16_f32 v169, v146, v147
    v_mfma_f32_32x32x16_bf16 v[128:143], v[196:199], v[36:39], v[128:143]
    v_exp_f32 v148, v148
    v_exp_f32 v149, v149
    v_exp_f32 v150, v150
    v_exp_f32 v151, v151
    v_cvt_pk_bf16_f32 v170, v148, v149
    v_cvt_pk_bf16_f32 v171, v150, v151
    v_mfma_f32_32x32x16_bf16 v[96:111], v[184:187], v[160:163], v[96:111]
    v_exp_f32 v152, v152
    v_exp_f32 v153, v153
    v_exp_f32 v154, v154
    v_exp_f32 v155, v155
    v_cvt_pk_bf16_f32 v172, v152, v153
    v_cvt_pk_bf16_f32 v173, v154, v155
    v_mfma_f32_32x32x16_bf16 v[96:111], v[188:191], v[164:167], v[96:111]
    v_exp_f32 v156, v156
    v_exp_f32 v157, v157
    v_exp_f32 v158, v158
    v_exp_f32 v159, v159
    v_cvt_pk_bf16_f32 v174, v156, v157
    v_cvt_pk_bf16_f32 v175, v158, v159
    v_mfma_f32_32x32x16_bf16 v[144:159], v[192:195], v[40:43], 0
    v_exp_f32 v128, v128
    v_exp_f32 v129, v129
    v_exp_f32 v130, v130
    v_exp_f32 v131, v131
    v_cvt_pk_bf16_f32 v160, v128, v129
    v_cvt_pk_bf16_f32 v161, v130, v131
    v_mfma_f32_32x32x16_bf16 v[144:159], v[196:199], v[44:47], v[144:159]
    v_exp_f32 v132, v132
    v_exp_f32 v133, v133
    v_exp_f32 v134, v134
    v_exp_f32 v135, v135
    v_cvt_pk_bf16_f32 v162, v132, v133
    v_cvt_pk_bf16_f32 v163, v134, v135
    v_mfma_f32_32x32x16_bf16 v[112:127], v[184:187], v[168:171], v[112:127]
    v_exp_f32 v136, v136
    v_exp_f32 v137, v137
    v_exp_f32 v138, v138
    v_exp_f32 v139, v139
    v_cvt_pk_bf16_f32 v164, v136, v137
    v_cvt_pk_bf16_f32 v165, v138, v139
    v_mfma_f32_32x32x16_bf16 v[112:127], v[188:191], v[172:175], v[112:127]
    v_exp_f32 v140, v140
    v_exp_f32 v141, v141
    v_exp_f32 v142, v142
    v_exp_f32 v143, v143
    v_cvt_pk_bf16_f32 v166, v140, v141
    v_cvt_pk_bf16_f32 v167, v142, v143
    v_mfma_f32_32x32x16_bf16 v[128:143], v[192:195], v[48:51], 0
    v_exp_f32 v144, v144
    v_exp_f32 v145, v145
    v_exp_f32 v146, v146
    v_exp_f32 v147, v147
    v_cvt_pk_bf16_f32 v168, v144, v145
    v_cvt_pk_bf16_f32 v169, v146, v147
    v_mfma_f32_32x32x16_bf16 v[128:143], v[196:199], v[52:55], v[128:143]
    v_exp_f32 v148, v148
    v_exp_f32 v149, v149
    v_exp_f32 v150, v150
    v_exp_f32 v151, v151
    v_cvt_pk_bf16_f32 v170, v148, v149
    v_cvt_pk_bf16_f32 v171, v150, v151
    v_mfma_f32_32x32x16_bf16 v[64:79], v[200:203], v[160:163], v[64:79]
    v_exp_f32 v152, v152
    v_exp_f32 v153, v153
    v_exp_f32 v154, v154
    v_exp_f32 v155, v155
    v_cvt_pk_bf16_f32 v172, v152, v153
    v_cvt_pk_bf16_f32 v173, v154, v155
    v_mfma_f32_32x32x16_bf16 v[64:79], v[204:207], v[164:167], v[64:79]
    v_exp_f32 v156, v156
    v_exp_f32 v157, v157
    v_exp_f32 v158, v158
    v_exp_f32 v159, v159
    v_cvt_pk_bf16_f32 v174, v156, v157
    v_cvt_pk_bf16_f32 v175, v158, v159
    s_add_u32 s30, s42, 12288
    buffer_load_dwordx4 v[176:179], v1, s[4:7], s30 offen
    buffer_load_dwordx4 v[180:183], v1, s[4:7], s30 offen offset:1024
    s_add_u32 s30, s30, 2097152
    buffer_load_dwordx4 v[184:187], v1, s[4:7], s30 offen
    buffer_load_dwordx4 v[188:191], v1, s[4:7], s30 offen offset:1024
    v_mfma_f32_32x32x16_bf16 v[144:159], v[192:195], v[56:59], 0
    v_exp_f32 v128, v128
    v_exp_f32 v129, v129
    v_exp_f32 v130, v130
    v_exp_f32 v131, v131
    v_cvt_pk_bf16_f32 v160, v128, v129
    v_cvt_pk_bf16_f32 v161, v130, v131
    v_mfma_f32_32x32x16_bf16 v[144:159], v[196:199], v[60:63], v[144:159]
    v_exp_f32 v132, v132
    v_exp_f32 v133, v133
    v_exp_f32 v134, v134
    v_exp_f32 v135, v135
    v_cvt_pk_bf16_f32 v162, v132, v133
    v_cvt_pk_bf16_f32 v163, v134, v135
    v_mfma_f32_32x32x16_bf16 v[80:95], v[200:203], v[168:171], v[80:95]
    v_exp_f32 v136, v136
    v_exp_f32 v137, v137
    v_exp_f32 v138, v138
    v_exp_f32 v139, v139
    v_cvt_pk_bf16_f32 v164, v136, v137
    v_cvt_pk_bf16_f32 v165, v138, v139
    v_mfma_f32_32x32x16_bf16 v[80:95], v[204:207], v[172:175], v[80:95]
    v_exp_f32 v140, v140
    v_exp_f32 v141, v141
    v_exp_f32 v142, v142
    v_exp_f32 v143, v143
    v_cvt_pk_bf16_f32 v166, v140, v141
    v_cvt_pk_bf16_f32 v167, v142, v143
    s_waitcnt vmcnt(4)
    v_mfma_f32_32x32x16_bf16 v[128:143], v[208:211], v[32:35], 0
    v_exp_f32 v144, v144
    v_exp_f32 v145, v145
    v_exp_f32 v146, v146
    v_exp_f32 v147, v147
    v_cvt_pk_bf16_f32 v168, v144, v145
    v_cvt_pk_bf16_f32 v169, v146, v147
    v_mfma_f32_32x32x16_bf16 v[128:143], v[212:215], v[36:39], v[128:143]
    v_exp_f32 v148, v148
    v_exp_f32 v149, v149
    v_exp_f32 v150, v150
    v_exp_f32 v151, v151
    v_cvt_pk_bf16_f32 v170, v148, v149
    v_cvt_pk_bf16_f32 v171, v150, v151
    v_mfma_f32_32x32x16_bf16 v[96:111], v[200:203], v[160:163], v[96:111]
    v_exp_f32 v152, v152
    v_exp_f32 v153, v153
    v_exp_f32 v154, v154
    v_exp_f32 v155, v155
    v_cvt_pk_bf16_f32 v172, v152, v153
    v_cvt_pk_bf16_f32 v173, v154, v155
    v_mfma_f32_32x32x16_bf16 v[96:111], v[204:207], v[164:167], v[96:111]
    v_exp_f32 v156, v156
    v_exp_f32 v157, v157
    v_exp_f32 v158, v158
    v_exp_f32 v159, v159
    v_cvt_pk_bf16_f32 v174, v156, v157
    v_cvt_pk_bf16_f32 v175, v158, v159
    v_mfma_f32_32x32x16_bf16 v[144:159], v[208:211], v[40:43], 0
    v_exp_f32 v128, v128
    v_exp_f32 v129, v129
    v_exp_f32 v130, v130
    v_exp_f32 v131, v131
    v_cvt_pk_bf16_f32 v160, v128, v129
    v_cvt_pk_bf16_f32 v161, v130, v131
    v_mfma_f32_32x32x16_bf16 v[144:159], v[212:215], v[44:47], v[144:159]
    v_exp_f32 v132, v132
    v_exp_f32 v133, v133
    v_exp_f32 v134, v134
    v_exp_f32 v135, v135
    v_cvt_pk_bf16_f32 v162, v132, v133
    v_cvt_pk_bf16_f32 v163, v134, v135
    v_mfma_f32_32x32x16_bf16 v[112:127], v[200:203], v[168:171], v[112:127]
    v_exp_f32 v136, v136
    v_exp_f32 v137, v137
    v_exp_f32 v138, v138
    v_exp_f32 v139, v139
    v_cvt_pk_bf16_f32 v164, v136, v137
    v_cvt_pk_bf16_f32 v165, v138, v139
    v_mfma_f32_32x32x16_bf16 v[112:127], v[204:207], v[172:175], v[112:127]
    v_exp_f32 v140, v140
    v_exp_f32 v141, v141
    v_exp_f32 v142, v142
    v_exp_f32 v143, v143
    v_cvt_pk_bf16_f32 v166, v140, v141
    v_cvt_pk_bf16_f32 v167, v142, v143
    v_mfma_f32_32x32x16_bf16 v[128:143], v[208:211], v[48:51], 0
    v_exp_f32 v144, v144
    v_exp_f32 v145, v145
    v_exp_f32 v146, v146
    v_exp_f32 v147, v147
    v_cvt_pk_bf16_f32 v168, v144, v145
    v_cvt_pk_bf16_f32 v169, v146, v147
    v_mfma_f32_32x32x16_bf16 v[128:143], v[212:215], v[52:55], v[128:143]
    v_exp_f32 v148, v148
    v_exp_f32 v149, v149
    v_exp_f32 v150, v150
    v_exp_f32 v151, v151
    v_cvt_pk_bf16_f32 v170, v148, v149
    v_cvt_pk_bf16_f32 v171, v150, v151
    v_mfma_f32_32x32x16_bf16 v[64:79], v[216:219], v[160:163], v[64:79]
    v_exp_f32 v152, v152
    v_exp_f32 v153, v153
    v_exp_f32 v154, v154
    v_exp_f32 v155, v155
    v_cvt_pk_bf16_f32 v172, v152, v153
    v_cvt_pk_bf16_f32 v173, v154, v155
    v_mfma_f32_32x32x16_bf16 v[64:79], v[220:223], v[164:167], v[64:79]
    v_exp_f32 v156, v156
    v_exp_f32 v157, v157
    v_exp_f32 v158, v158
    v_exp_f32 v159, v159
    v_cvt_pk_bf16_f32 v174, v156, v157
    v_cvt_pk_bf16_f32 v175, v158, v159
    s_add_u32 s30, s42, 14336
    buffer_load_dwordx4 v[192:195], v1, s[4:7], s30 offen
    buffer_load_dwordx4 v[196:199], v1, s[4:7], s30 offen offset:1024
    s_add_u32 s30, s30, 2097152
    buffer_load_dwordx4 v[200:203], v1, s[4:7], s30 offen
    buffer_load_dwordx4 v[204:207], v1, s[4:7], s30 offen offset:1024
    v_mfma_f32_32x32x16_bf16 v[144:159], v[208:211], v[56:59], 0
    v_exp_f32 v128, v128
    v_exp_f32 v129, v129
    v_exp_f32 v130, v130
    v_exp_f32 v131, v131
    v_cvt_pk_bf16_f32 v160, v128, v129
    v_cvt_pk_bf16_f32 v161, v130, v131
    v_mfma_f32_32x32x16_bf16 v[144:159], v[212:215], v[60:63], v[144:159]
    v_exp_f32 v132, v132
    v_exp_f32 v133, v133
    v_exp_f32 v134, v134
    v_exp_f32 v135, v135
    v_cvt_pk_bf16_f32 v162, v132, v133
    v_cvt_pk_bf16_f32 v163, v134, v135
    v_mfma_f32_32x32x16_bf16 v[80:95], v[216:219], v[168:171], v[80:95]
    v_exp_f32 v136, v136
    v_exp_f32 v137, v137
    v_exp_f32 v138, v138
    v_exp_f32 v139, v139
    v_cvt_pk_bf16_f32 v164, v136, v137
    v_cvt_pk_bf16_f32 v165, v138, v139
    v_mfma_f32_32x32x16_bf16 v[80:95], v[220:223], v[172:175], v[80:95]
    v_exp_f32 v140, v140
    v_exp_f32 v141, v141
    v_exp_f32 v142, v142
    v_exp_f32 v143, v143
    v_cvt_pk_bf16_f32 v166, v140, v141
    v_cvt_pk_bf16_f32 v167, v142, v143
    s_waitcnt vmcnt(4)
    v_mfma_f32_32x32x16_bf16 v[128:143], v[176:179], v[32:35], 0
    v_exp_f32 v144, v144
    v_exp_f32 v145, v145
    v_exp_f32 v146, v146
    v_exp_f32 v147, v147
    v_cvt_pk_bf16_f32 v168, v144, v145
    v_cvt_pk_bf16_f32 v169, v146, v147
    v_mfma_f32_32x32x16_bf16 v[128:143], v[180:183], v[36:39], v[128:143]
    v_exp_f32 v148, v148
    v_exp_f32 v149, v149
    v_exp_f32 v150, v150
    v_exp_f32 v151, v151
    v_cvt_pk_bf16_f32 v170, v148, v149
    v_cvt_pk_bf16_f32 v171, v150, v151
    v_mfma_f32_32x32x16_bf16 v[96:111], v[216:219], v[160:163], v[96:111]
    v_exp_f32 v152, v152
    v_exp_f32 v153, v153
    v_exp_f32 v154, v154
    v_exp_f32 v155, v155
    v_cvt_pk_bf16_f32 v172, v152, v153
    v_cvt_pk_bf16_f32 v173, v154, v155
    v_mfma_f32_32x32x16_bf16 v[96:111], v[220:223], v[164:167], v[96:111]
    v_exp_f32 v156, v156
    v_exp_f32 v157, v157
    v_exp_f32 v158, v158
    v_exp_f32 v159, v159
    v_cvt_pk_bf16_f32 v174, v156, v157
    v_cvt_pk_bf16_f32 v175, v158, v159
    v_mfma_f32_32x32x16_bf16 v[144:159], v[176:179], v[40:43], 0
    v_exp_f32 v128, v128
    v_exp_f32 v129, v129
    v_exp_f32 v130, v130
    v_exp_f32 v131, v131
    v_cvt_pk_bf16_f32 v160, v128, v129
    v_cvt_pk_bf16_f32 v161, v130, v131
    v_mfma_f32_32x32x16_bf16 v[144:159], v[180:183], v[44:47], v[144:159]
    v_exp_f32 v132, v132
    v_exp_f32 v133, v133
    v_exp_f32 v134, v134
    v_exp_f32 v135, v135
    v_cvt_pk_bf16_f32 v162, v132, v133
    v_cvt_pk_bf16_f32 v163, v134, v135
    v_mfma_f32_32x32x16_bf16 v[112:127], v[216:219], v[168:171], v[112:127]
    v_exp_f32 v136, v136
    v_exp_f32 v137, v137
    v_exp_f32 v138, v138
    v_exp_f32 v139, v139
    v_cvt_pk_bf16_f32 v164, v136, v137
    v_cvt_pk_bf16_f32 v165, v138, v139
    v_mfma_f32_32x32x16_bf16 v[112:127], v[220:223], v[172:175], v[112:127]
    v_exp_f32 v140, v140
    v_exp_f32 v141, v141
    v_exp_f32 v142, v142
    v_exp_f32 v143, v143
    v_cvt_pk_bf16_f32 v166, v140, v141
    v_cvt_pk_bf16_f32 v167, v142, v143
    v_mfma_f32_32x32x16_bf16 v[128:143], v[176:179], v[48:51], 0
    v_exp_f32 v144, v144
    v_exp_f32 v145, v145
    v_exp_f32 v146, v146
    v_exp_f32 v147, v147
    v_cvt_pk_bf16_f32 v168, v144, v145
    v_cvt_pk_bf16_f32 v169, v146, v147
    v_mfma_f32_32x32x16_bf16 v[128:143], v[180:183], v[52:55], v[128:143]
    v_exp_f32 v148, v148
    v_exp_f32 v149, v149
    v_exp_f32 v150, v150
    v_exp_f32 v151, v151
    v_cvt_pk_bf16_f32 v170, v148, v149
    v_cvt_pk_bf16_f32 v171, v150, v151
    v_mfma_f32_32x32x16_bf16 v[64:79], v[184:187], v[160:163], v[64:79]
    v_exp_f32 v152, v152
    v_exp_f32 v153, v153
    v_exp_f32 v154, v154
    v_exp_f32 v155, v155
    v_cvt_pk_bf16_f32 v172, v152, v153
    v_cvt_pk_bf16_f32 v173, v154, v155
    v_mfma_f32_32x32x16_bf16 v[64:79], v[188:191], v[164:167], v[64:79]
    v_exp_f32 v156, v156
    v_exp_f32 v157, v157
    v_exp_f32 v158, v158
    v_exp_f32 v159, v159
    v_cvt_pk_bf16_f32 v174, v156, v157
    v_cvt_pk_bf16_f32 v175, v158, v159
    v_mfma_f32_32x32x16_bf16 v[144:159], v[176:179], v[56:59], 0
    v_exp_f32 v128, v128
    v_exp_f32 v129, v129
    v_exp_f32 v130, v130
    v_exp_f32 v131, v131
    v_cvt_pk_bf16_f32 v160, v128, v129
    v_cvt_pk_bf16_f32 v161, v130, v131
    v_mfma_f32_32x32x16_bf16 v[144:159], v[180:183], v[60:63], v[144:159]
    v_exp_f32 v132, v132
    v_exp_f32 v133, v133
    v_exp_f32 v134, v134
    v_exp_f32 v135, v135
    v_cvt_pk_bf16_f32 v162, v132, v133
    v_cvt_pk_bf16_f32 v163, v134, v135
    v_mfma_f32_32x32x16_bf16 v[80:95], v[184:187], v[168:171], v[80:95]
    v_exp_f32 v136, v136
    v_exp_f32 v137, v137
    v_exp_f32 v138, v138
    v_exp_f32 v139, v139
    v_cvt_pk_bf16_f32 v164, v136, v137
    v_cvt_pk_bf16_f32 v165, v138, v139
    v_mfma_f32_32x32x16_bf16 v[80:95], v[188:191], v[172:175], v[80:95]
    v_exp_f32 v140, v140
    v_exp_f32 v141, v141
    v_exp_f32 v142, v142
    v_exp_f32 v143, v143
    v_cvt_pk_bf16_f32 v166, v140, v141
    v_cvt_pk_bf16_f32 v167, v142, v143
    s_waitcnt vmcnt(0)
    v_mfma_f32_32x32x16_bf16 v[128:143], v[192:195], v[32:35], 0
    v_exp_f32 v144, v144
    v_exp_f32 v145, v145
    v_exp_f32 v146, v146
    v_exp_f32 v147, v147
    v_cvt_pk_bf16_f32 v168, v144, v145
    v_cvt_pk_bf16_f32 v169, v146, v147
    v_mfma_f32_32x32x16_bf16 v[128:143], v[196:199], v[36:39], v[128:143]
    v_exp_f32 v148, v148
    v_exp_f32 v149, v149
    v_exp_f32 v150, v150
    v_exp_f32 v151, v151
    v_cvt_pk_bf16_f32 v170, v148, v149
    v_cvt_pk_bf16_f32 v171, v150, v151
    v_mfma_f32_32x32x16_bf16 v[96:111], v[184:187], v[160:163], v[96:111]
    v_exp_f32 v152, v152
    v_exp_f32 v153, v153
    v_exp_f32 v154, v154
    v_exp_f32 v155, v155
    v_cvt_pk_bf16_f32 v172, v152, v153
    v_cvt_pk_bf16_f32 v173, v154, v155
    v_mfma_f32_32x32x16_bf16 v[96:111], v[188:191], v[164:167], v[96:111]
    v_exp_f32 v156, v156
    v_exp_f32 v157, v157
    v_exp_f32 v158, v158
    v_exp_f32 v159, v159
    v_cvt_pk_bf16_f32 v174, v156, v157
    v_cvt_pk_bf16_f32 v175, v158, v159
    buffer_load_dwordx4 v[228:231], v1, s[12:15], s55 offen
    v_mfma_f32_32x32x16_bf16 v[144:159], v[192:195], v[40:43], 0
    v_exp_f32 v128, v128
    v_exp_f32 v129, v129
    v_exp_f32 v130, v130
    v_exp_f32 v131, v131
    v_cvt_pk_bf16_f32 v160, v128, v129
    v_cvt_pk_bf16_f32 v161, v130, v131
    v_mfma_f32_32x32x16_bf16 v[144:159], v[196:199], v[44:47], v[144:159]
    v_exp_f32 v132, v132
    v_exp_f32 v133, v133
    v_exp_f32 v134, v134
    v_exp_f32 v135, v135
    v_cvt_pk_bf16_f32 v162, v132, v133
    v_cvt_pk_bf16_f32 v163, v134, v135
    v_mfma_f32_32x32x16_bf16 v[112:127], v[184:187], v[168:171], v[112:127]
    v_exp_f32 v136, v136
    v_exp_f32 v137, v137
    v_exp_f32 v138, v138
    v_exp_f32 v139, v139
    v_cvt_pk_bf16_f32 v164, v136, v137
    v_cvt_pk_bf16_f32 v165, v138, v139
    v_mfma_f32_32x32x16_bf16 v[112:127], v[188:191], v[172:175], v[112:127]
    v_exp_f32 v140, v140
    v_exp_f32 v141, v141
    v_exp_f32 v142, v142
    v_exp_f32 v143, v143
    v_cvt_pk_bf16_f32 v166, v140, v141
    v_cvt_pk_bf16_f32 v167, v142, v143
    v_mfma_f32_32x32x16_bf16 v[128:143], v[192:195], v[48:51], 0
    v_exp_f32 v144, v144
    v_exp_f32 v145, v145
    v_exp_f32 v146, v146
    v_exp_f32 v147, v147
    v_cvt_pk_bf16_f32 v168, v144, v145
    v_cvt_pk_bf16_f32 v169, v146, v147
    v_mfma_f32_32x32x16_bf16 v[128:143], v[196:199], v[52:55], v[128:143]
    v_exp_f32 v148, v148
    v_exp_f32 v149, v149
    v_exp_f32 v150, v150
    v_exp_f32 v151, v151
    v_cvt_pk_bf16_f32 v170, v148, v149
    v_cvt_pk_bf16_f32 v171, v150, v151
    v_mfma_f32_32x32x16_bf16 v[64:79], v[200:203], v[160:163], v[64:79]
    v_exp_f32 v152, v152
    v_exp_f32 v153, v153
    v_exp_f32 v154, v154
    v_exp_f32 v155, v155
    v_cvt_pk_bf16_f32 v172, v152, v153
    v_cvt_pk_bf16_f32 v173, v154, v155
    v_mfma_f32_32x32x16_bf16 v[64:79], v[204:207], v[164:167], v[64:79]
    v_exp_f32 v156, v156
    v_exp_f32 v157, v157
    v_exp_f32 v158, v158
    v_exp_f32 v159, v159
    v_cvt_pk_bf16_f32 v174, v156, v157
    v_cvt_pk_bf16_f32 v175, v158, v159
    v_mfma_f32_32x32x16_bf16 v[144:159], v[192:195], v[56:59], 0
    v_exp_f32 v128, v128
    v_exp_f32 v129, v129
    v_exp_f32 v130, v130
    v_exp_f32 v131, v131
    v_cvt_pk_bf16_f32 v160, v128, v129
    v_cvt_pk_bf16_f32 v161, v130, v131
    v_mfma_f32_32x32x16_bf16 v[144:159], v[196:199], v[60:63], v[144:159]
    v_exp_f32 v132, v132
    v_exp_f32 v133, v133
    v_exp_f32 v134, v134
    v_exp_f32 v135, v135
    v_cvt_pk_bf16_f32 v162, v132, v133
    v_cvt_pk_bf16_f32 v163, v134, v135
    v_mfma_f32_32x32x16_bf16 v[80:95], v[200:203], v[168:171], v[80:95]
    v_exp_f32 v136, v136
    v_exp_f32 v137, v137
    v_exp_f32 v138, v138
    v_exp_f32 v139, v139
    v_cvt_pk_bf16_f32 v164, v136, v137
    v_cvt_pk_bf16_f32 v165, v138, v139
    v_mfma_f32_32x32x16_bf16 v[80:95], v[204:207], v[172:175], v[80:95]
    v_exp_f32 v140, v140
    v_exp_f32 v141, v141
    v_exp_f32 v142, v142
    v_exp_f32 v143, v143
    v_cvt_pk_bf16_f32 v166, v140, v141
    v_cvt_pk_bf16_f32 v167, v142, v143
    v_exp_f32 v144, v144
    v_exp_f32 v145, v145
    v_exp_f32 v146, v146
    v_exp_f32 v147, v147
    v_cvt_pk_bf16_f32 v168, v144, v145
    v_cvt_pk_bf16_f32 v169, v146, v147
    v_exp_f32 v148, v148
    v_exp_f32 v149, v149
    v_exp_f32 v150, v150
    v_exp_f32 v151, v151
    v_cvt_pk_bf16_f32 v170, v148, v149
    v_cvt_pk_bf16_f32 v171, v150, v151
    v_mfma_f32_32x32x16_bf16 v[96:111], v[200:203], v[160:163], v[96:111]
    v_exp_f32 v152, v152
    v_exp_f32 v153, v153
    v_exp_f32 v154, v154
    v_exp_f32 v155, v155
    v_cvt_pk_bf16_f32 v172, v152, v153
    v_cvt_pk_bf16_f32 v173, v154, v155
    v_mfma_f32_32x32x16_bf16 v[96:111], v[204:207], v[164:167], v[96:111]
    v_exp_f32 v156, v156
    v_exp_f32 v157, v157
    v_exp_f32 v158, v158
    v_exp_f32 v159, v159
    v_cvt_pk_bf16_f32 v174, v156, v157
    v_cvt_pk_bf16_f32 v175, v158, v159
    s_nop 1
    v_mfma_f32_32x32x16_bf16 v[112:127], v[200:203], v[168:171], v[112:127]
    v_mfma_f32_32x32x16_bf16 v[112:127], v[204:207], v[172:175], v[112:127]
    s_setprio 0
attn_kernel_reduce:
    s_lshl_b32 s29, s24, 14
    v_add_u32 v2, s29, v1
    s_nop 7
    ds_write_b128 v2, v[64:67] offset:0
    ds_write_b128 v2, v[68:71] offset:1024
    ds_write_b128 v2, v[72:75] offset:2048
    ds_write_b128 v2, v[76:79] offset:3072
    ds_write_b128 v2, v[80:83] offset:4096
    ds_write_b128 v2, v[84:87] offset:5120
    ds_write_b128 v2, v[88:91] offset:6144
    ds_write_b128 v2, v[92:95] offset:7168
    ds_write_b128 v2, v[96:99] offset:8192
    ds_write_b128 v2, v[100:103] offset:9216
    ds_write_b128 v2, v[104:107] offset:10240
    ds_write_b128 v2, v[108:111] offset:11264
    ds_write_b128 v2, v[112:115] offset:12288
    ds_write_b128 v2, v[116:119] offset:13312
    ds_write_b128 v2, v[120:123] offset:14336
    ds_write_b128 v2, v[124:127] offset:15360
    s_waitcnt lgkmcnt(0)
    s_barrier
    s_lshr_b32 s48, s24, 1
    s_and_b32 s49, s24, 1
    s_lshl_b32 s29, s48, 12
    s_lshl_b32 s30, s49, 11
    s_add_u32 s30, s30, s29
    v_add_u32 v2, s30, v1
    v_add_u32 v3, 0x10000, v2
    v_and_b32 v4, 31, v0
    v_lshlrev_b32 v4, 4, v4
    s_add_u32 s29, s29, 3584
    v_add_u32 v4, s29, v4
    v_add_u32 v5, 0x10000, v4
    ds_read_b128 v[64:67], v2 offset:0
    ds_read_b128 v[68:71], v2 offset:1024
    ds_read_b32 v128, v4 offset:0
    ds_read_b128 v[72:75], v2 offset:16384
    ds_read_b128 v[76:79], v2 offset:17408
    ds_read_b32 v129, v4 offset:16384
    ds_read_b128 v[80:83], v2 offset:32768
    ds_read_b128 v[84:87], v2 offset:33792
    ds_read_b32 v130, v4 offset:32768
    ds_read_b128 v[88:91], v2 offset:49152
    ds_read_b128 v[92:95], v2 offset:50176
    ds_read_b32 v131, v4 offset:49152
    s_waitcnt lgkmcnt(6)
    ds_read_b128 v[96:99], v3 offset:0
    ds_read_b128 v[100:103], v3 offset:1024
    ds_read_b32 v132, v5 offset:0
    ds_read_b128 v[104:107], v3 offset:16384
    ds_read_b128 v[108:111], v3 offset:17408
    ds_read_b32 v133, v5 offset:16384
    ds_read_b128 v[112:115], v3 offset:32768
    ds_read_b128 v[116:119], v3 offset:33792
    ds_read_b32 v134, v5 offset:32768
    ds_read_b128 v[120:123], v3 offset:49152
    ds_read_b128 v[124:127], v3 offset:50176
    ds_read_b32 v135, v5 offset:49152
    s_waitcnt lgkmcnt(0)
    v_pk_add_f32 v[64:65], v[64:65], v[96:97]
    v_pk_add_f32 v[66:67], v[66:67], v[98:99]
    v_pk_add_f32 v[68:69], v[68:69], v[100:101]
    v_pk_add_f32 v[70:71], v[70:71], v[102:103]
    v_add_f32 v128, v128, v132
    v_pk_add_f32 v[72:73], v[72:73], v[104:105]
    v_pk_add_f32 v[74:75], v[74:75], v[106:107]
    v_pk_add_f32 v[76:77], v[76:77], v[108:109]
    v_pk_add_f32 v[78:79], v[78:79], v[110:111]
    v_add_f32 v129, v129, v133
    v_pk_add_f32 v[80:81], v[80:81], v[112:113]
    v_pk_add_f32 v[82:83], v[82:83], v[114:115]
    v_pk_add_f32 v[84:85], v[84:85], v[116:117]
    v_pk_add_f32 v[86:87], v[86:87], v[118:119]
    v_add_f32 v130, v130, v134
    v_pk_add_f32 v[88:89], v[88:89], v[120:121]
    v_pk_add_f32 v[90:91], v[90:91], v[122:123]
    v_pk_add_f32 v[92:93], v[92:93], v[124:125]
    v_pk_add_f32 v[94:95], v[94:95], v[126:127]
    v_add_f32 v131, v131, v135
    v_pk_add_f32 v[64:65], v[64:65], v[80:81]
    v_pk_add_f32 v[66:67], v[66:67], v[82:83]
    v_pk_add_f32 v[68:69], v[68:69], v[84:85]
    v_pk_add_f32 v[70:71], v[70:71], v[86:87]
    v_add_f32 v128, v128, v130
    v_pk_add_f32 v[72:73], v[72:73], v[88:89]
    v_pk_add_f32 v[74:75], v[74:75], v[90:91]
    v_pk_add_f32 v[76:77], v[76:77], v[92:93]
    v_pk_add_f32 v[78:79], v[78:79], v[94:95]
    v_add_f32 v129, v129, v131
    v_pk_add_f32 v[64:65], v[64:65], v[72:73]
    v_pk_add_f32 v[66:67], v[66:67], v[74:75]
    v_pk_add_f32 v[68:69], v[68:69], v[76:77]
    v_pk_add_f32 v[70:71], v[70:71], v[78:79]
    v_add_f32 v128, v128, v129
    v_rcp_f32 v129, v128
    v_cmp_le_f32 vcc, 0x21800000, v128
    v_cmp_ge_f32 s[50:51], s44, v128
    v_mul_f32 v64, v64, v129
    v_mul_f32 v65, v65, v129
    v_mul_f32 v66, v66, v129
    v_mul_f32 v67, v67, v129
    v_mul_f32 v68, v68, v129
    v_mul_f32 v69, v69, v129
    v_mul_f32 v70, v70, v129
    v_mul_f32 v71, v71, v129
    s_and_b64 s[50:51], s[50:51], vcc
    s_cmp_eq_u32 s49, 1
    s_cselect_b64 s[52:53], s[46:47], 0
    v_cndmask_b32 v68, v68, 0, s[52:53]
    v_cndmask_b32 v69, v69, 0, s[52:53]
    v_cndmask_b32 v70, v70, 0, s[52:53]
    v_cndmask_b32 v71, v71, 0, s[52:53]
    v_cvt_pk_bf16_f32 v160, v64, v65
    v_cvt_pk_bf16_f32 v161, v66, v67
    v_cvt_pk_bf16_f32 v162, v68, v69
    v_cvt_pk_bf16_f32 v163, v70, v71
    s_lshl_b32 s29, s26, 2
    s_add_u32 s29, s29, s48
    s_lshl_b32 s29, s29, 5
    s_lshl_b32 s30, s25, 1
    s_add_u32 s29, s29, s30
    s_add_u32 s29, s29, s49
    s_lshl_b32 s29, s29, 10
    buffer_store_dwordx4 v[160:163], v1, s[8:11], s29 offen sc1
    s_cmp_eq_u32 s45, 1
    s_cbranch_scc1 attn_kernel_adone
    v_mov_b32 v2, 135168
    v_mov_b32 v3, 1
    s_cmp_eq_u64 s[50:51], -1
    s_cbranch_scc1 attn_kernel_ok
    ds_write_b32 v2, v3
attn_kernel_ok:
    s_waitcnt lgkmcnt(0)
    s_barrier
    ds_read_b32 v3, v2
    s_waitcnt lgkmcnt(0)
    s_nop 0
    v_readfirstlane_b32 s29, v3
    s_nop 3
    s_cmp_eq_u32 s29, 0
    s_cbranch_scc1 attn_kernel_adone
    s_mov_b32 s45, 1
    s_waitcnt vmcnt(0)
    v_mov_b32 v224, 0xff800000
    v_mov_b32 v225, 0xff800000
    v_mov_b32 v226, 0xff800000
    v_mov_b32 v227, 0xff800000
    s_mov_b32 s48, 0
attn_kernel_mx:
    s_lshl_b32 s30, s48, 11
    s_add_u32 s30, s30, s42
    buffer_load_dwordx4 v[176:179], v1, s[4:7], s30 offen
    buffer_load_dwordx4 v[180:183], v1, s[4:7], s30 offen offset:1024
    s_waitcnt vmcnt(0)
    v_mfma_f32_32x32x16_bf16 v[128:143], v[176:179], v[32:35], 0
    v_mfma_f32_32x32x16_bf16 v[128:143], v[180:183], v[36:39], v[128:143]
    s_nop 7
    s_nop 7
    v_max3_f32 v224, v224, v128, v129
    v_max3_f32 v224, v224, v130, v131
    v_max3_f32 v224, v224, v132, v133
    v_max3_f32 v224, v224, v134, v135
    v_max3_f32 v224, v224, v136, v137
    v_max3_f32 v224, v224, v138, v139
    v_max3_f32 v224, v224, v140, v141
    v_max3_f32 v224, v224, v142, v143
    s_nop 7
    v_mfma_f32_32x32x16_bf16 v[128:143], v[176:179], v[40:43], 0
    v_mfma_f32_32x32x16_bf16 v[128:143], v[180:183], v[44:47], v[128:143]
    s_nop 7
    s_nop 7
    v_max3_f32 v225, v225, v128, v129
    v_max3_f32 v225, v225, v130, v131
    v_max3_f32 v225, v225, v132, v133
    v_max3_f32 v225, v225, v134, v135
    v_max3_f32 v225, v225, v136, v137
    v_max3_f32 v225, v225, v138, v139
    v_max3_f32 v225, v225, v140, v141
    v_max3_f32 v225, v225, v142, v143
    s_nop 7
    v_mfma_f32_32x32x16_bf16 v[128:143], v[176:179], v[48:51], 0
    v_mfma_f32_32x32x16_bf16 v[128:143], v[180:183], v[52:55], v[128:143]
    s_nop 7
    s_nop 7
    v_max3_f32 v226, v226, v128, v129
    v_max3_f32 v226, v226, v130, v131
    v_max3_f32 v226, v226, v132, v133
    v_max3_f32 v226, v226, v134, v135
    v_max3_f32 v226, v226, v136, v137
    v_max3_f32 v226, v226, v138, v139
    v_max3_f32 v226, v226, v140, v141
    v_max3_f32 v226, v226, v142, v143
    s_nop 7
    v_mfma_f32_32x32x16_bf16 v[128:143], v[176:179], v[56:59], 0
    v_mfma_f32_32x32x16_bf16 v[128:143], v[180:183], v[60:63], v[128:143]
    s_nop 7
    s_nop 7
    v_max3_f32 v227, v227, v128, v129
    v_max3_f32 v227, v227, v130, v131
    v_max3_f32 v227, v227, v132, v133
    v_max3_f32 v227, v227, v134, v135
    v_max3_f32 v227, v227, v136, v137
    v_max3_f32 v227, v227, v138, v139
    v_max3_f32 v227, v227, v140, v141
    v_max3_f32 v227, v227, v142, v143
    s_nop 7
    s_add_u32 s48, s48, 1
    s_cmp_lt_u32 s48, 8
    s_cbranch_scc1 attn_kernel_mx
    s_lshl_b32 s29, s24, 9
    s_add_u32 s29, s29, 131072
    v_and_b32 v4, 31, v0
    v_lshlrev_b32 v4, 2, v4
    v_add_u32 v2, s29, v4
    v_mov_b32 v3, v224
    s_nop 1
    v_permlane32_swap_b32 v224, v3
    s_nop 1
    v_max_f32 v224, v224, v3
    ds_write_b32 v2, v224 offset:0
    v_mov_b32 v3, v225
    s_nop 1
    v_permlane32_swap_b32 v225, v3
    s_nop 1
    v_max_f32 v225, v225, v3
    ds_write_b32 v2, v225 offset:128
    v_mov_b32 v3, v226
    s_nop 1
    v_permlane32_swap_b32 v226, v3
    s_nop 1
    v_max_f32 v226, v226, v3
    ds_write_b32 v2, v226 offset:256
    v_mov_b32 v3, v227
    s_nop 1
    v_permlane32_swap_b32 v227, v3
    s_nop 1
    v_max_f32 v227, v227, v3
    ds_write_b32 v2, v227 offset:384
    s_waitcnt lgkmcnt(0)
    s_barrier
    v_add_u32 v2, 131072, v4
    ds_read_b32 v128, v2 offset:0
    ds_read_b32 v129, v2 offset:512
    ds_read_b32 v130, v2 offset:1024
    ds_read_b32 v131, v2 offset:1536
    ds_read_b32 v132, v2 offset:2048
    ds_read_b32 v133, v2 offset:2560
    ds_read_b32 v134, v2 offset:3072
    ds_read_b32 v135, v2 offset:3584
    s_waitcnt lgkmcnt(0)
    v_max3_f32 v224, v128, v129, v130
    v_max3_f32 v224, v224, v131, v132
    v_max3_f32 v224, v224, v133, v134
    v_max_f32 v224, v224, v135
    ds_read_b32 v128, v2 offset:128
    ds_read_b32 v129, v2 offset:640
    ds_read_b32 v130, v2 offset:1152
    ds_read_b32 v131, v2 offset:1664
    ds_read_b32 v132, v2 offset:2176
    ds_read_b32 v133, v2 offset:2688
    ds_read_b32 v134, v2 offset:3200
    ds_read_b32 v135, v2 offset:3712
    s_waitcnt lgkmcnt(0)
    v_max3_f32 v225, v128, v129, v130
    v_max3_f32 v225, v225, v131, v132
    v_max3_f32 v225, v225, v133, v134
    v_max_f32 v225, v225, v135
    ds_read_b32 v128, v2 offset:256
    ds_read_b32 v129, v2 offset:768
    ds_read_b32 v130, v2 offset:1280
    ds_read_b32 v131, v2 offset:1792
    ds_read_b32 v132, v2 offset:2304
    ds_read_b32 v133, v2 offset:2816
    ds_read_b32 v134, v2 offset:3328
    ds_read_b32 v135, v2 offset:3840
    s_waitcnt lgkmcnt(0)
    v_max3_f32 v226, v128, v129, v130
    v_max3_f32 v226, v226, v131, v132
    v_max3_f32 v226, v226, v133, v134
    v_max_f32 v226, v226, v135
    ds_read_b32 v128, v2 offset:384
    ds_read_b32 v129, v2 offset:896
    ds_read_b32 v130, v2 offset:1408
    ds_read_b32 v131, v2 offset:1920
    ds_read_b32 v132, v2 offset:2432
    ds_read_b32 v133, v2 offset:2944
    ds_read_b32 v134, v2 offset:3456
    ds_read_b32 v135, v2 offset:3968
    s_waitcnt lgkmcnt(0)
    v_max3_f32 v227, v128, v129, v130
    v_max3_f32 v227, v227, v131, v132
    v_max3_f32 v227, v227, v133, v134
    v_max_f32 v227, v227, v135
    s_add_u32 s30, s42, 0
    buffer_load_dwordx4 v[176:179], v1, s[4:7], s30 offen
    buffer_load_dwordx4 v[180:183], v1, s[4:7], s30 offen offset:1024
    s_add_u32 s30, s30, 2097152
    buffer_load_dwordx4 v[184:187], v1, s[4:7], s30 offen
    buffer_load_dwordx4 v[188:191], v1, s[4:7], s30 offen offset:1024
    s_add_u32 s30, s42, 2048
    buffer_load_dwordx4 v[192:195], v1, s[4:7], s30 offen
    buffer_load_dwordx4 v[196:199], v1, s[4:7], s30 offen offset:1024
    s_add_u32 s30, s30, 2097152
    buffer_load_dwordx4 v[200:203], v1, s[4:7], s30 offen
    buffer_load_dwordx4 v[204:207], v1, s[4:7], s30 offen offset:1024
    v_mov_b32 v64, 0
    v_mov_b32 v65, 0
    v_mov_b32 v66, 0
    v_mov_b32 v67, 0
    v_mov_b32 v68, 0
    v_mov_b32 v69, 0
    v_mov_b32 v70, 0
    v_mov_b32 v71, 0
    v_mov_b32 v72, 0
    v_mov_b32 v73, 0
    v_mov_b32 v74, 0
    v_mov_b32 v75, 0
    v_mov_b32 v76, 0
    v_mov_b32 v77, 0
    v_mov_b32 v78, 0
    v_mov_b32 v79, 0
    v_mov_b32 v80, 0
    v_mov_b32 v81, 0
    v_mov_b32 v82, 0
    v_mov_b32 v83, 0
    v_mov_b32 v84, 0
    v_mov_b32 v85, 0
    v_mov_b32 v86, 0
    v_mov_b32 v87, 0
    v_mov_b32 v88, 0
    v_mov_b32 v89, 0
    v_mov_b32 v90, 0
    v_mov_b32 v91, 0
    v_mov_b32 v92, 0
    v_mov_b32 v93, 0
    v_mov_b32 v94, 0
    v_mov_b32 v95, 0
    v_mov_b32 v96, 0
    v_mov_b32 v97, 0
    v_mov_b32 v98, 0
    v_mov_b32 v99, 0
    v_mov_b32 v100, 0
    v_mov_b32 v101, 0
    v_mov_b32 v102, 0
    v_mov_b32 v103, 0
    v_mov_b32 v104, 0
    v_mov_b32 v105, 0
    v_mov_b32 v106, 0
    v_mov_b32 v107, 0
    v_mov_b32 v108, 0
    v_mov_b32 v109, 0
    v_mov_b32 v110, 0
    v_mov_b32 v111, 0
    v_mov_b32 v112, 0
    v_mov_b32 v113, 0
    v_mov_b32 v114, 0
    v_mov_b32 v115, 0
    v_mov_b32 v116, 0
    v_mov_b32 v117, 0
    v_mov_b32 v118, 0
    v_mov_b32 v119, 0
    v_mov_b32 v120, 0
    v_mov_b32 v121, 0
    v_mov_b32 v122, 0
    v_mov_b32 v123, 0
    v_mov_b32 v124, 0
    v_mov_b32 v125, 0
    v_mov_b32 v126, 0
    v_mov_b32 v127, 0
    s_waitcnt vmcnt(6) lgkmcnt(0)
    v_mfma_f32_32x32x16_bf16 v[128:143], v[176:179], v[32:35], 0
    v_mfma_f32_32x32x16_bf16 v[128:143], v[180:183], v[36:39], v[128:143]
    s_nop 7
    s_nop 3
    v_mfma_f32_32x32x16_bf16 v[144:159], v[176:179], v[40:43], 0
    v_sub_f32 v128, v128, v224
    v_sub_f32 v129, v129, v224
    v_sub_f32 v130, v130, v224
    v_sub_f32 v131, v131, v224
    v_exp_f32 v128, v128
    v_exp_f32 v129, v129
    v_exp_f32 v130, v130
    v_exp_f32 v131, v131
    v_cvt_pk_bf16_f32 v160, v128, v129
    v_cvt_pk_bf16_f32 v161, v130, v131
    v_mfma_f32_32x32x16_bf16 v[144:159], v[180:183], v[44:47], v[144:159]
    v_sub_f32 v132, v132, v224
    v_sub_f32 v133, v133, v224
    v_sub_f32 v134, v134, v224
    v_sub_f32 v135, v135, v224
    v_exp_f32 v132, v132
    v_exp_f32 v133, v133
    v_exp_f32 v134, v134
    v_exp_f32 v135, v135
    v_cvt_pk_bf16_f32 v162, v132, v133
    v_cvt_pk_bf16_f32 v163, v134, v135
    v_sub_f32 v136, v136, v224
    v_sub_f32 v137, v137, v224
    v_sub_f32 v138, v138, v224
    v_sub_f32 v139, v139, v224
    v_exp_f32 v136, v136
    v_exp_f32 v137, v137
    v_exp_f32 v138, v138
    v_exp_f32 v139, v139
    v_cvt_pk_bf16_f32 v164, v136, v137
    v_cvt_pk_bf16_f32 v165, v138, v139
    v_sub_f32 v140, v140, v224
    v_sub_f32 v141, v141, v224
    v_sub_f32 v142, v142, v224
    v_sub_f32 v143, v143, v224
    v_exp_f32 v140, v140
    v_exp_f32 v141, v141
    v_exp_f32 v142, v142
    v_exp_f32 v143, v143
    v_cvt_pk_bf16_f32 v166, v140, v141
    v_cvt_pk_bf16_f32 v167, v142, v143
    s_waitcnt vmcnt(4)
    v_mfma_f32_32x32x16_bf16 v[128:143], v[176:179], v[48:51], 0
    v_sub_f32 v144, v144, v225
    v_sub_f32 v145, v145, v225
    v_sub_f32 v146, v146, v225
    v_sub_f32 v147, v147, v225
    v_exp_f32 v144, v144
    v_exp_f32 v145, v145
    v_exp_f32 v146, v146
    v_exp_f32 v147, v147
    v_cvt_pk_bf16_f32 v168, v144, v145
    v_cvt_pk_bf16_f32 v169, v146, v147
    v_mfma_f32_32x32x16_bf16 v[128:143], v[180:183], v[52:55], v[128:143]
    v_sub_f32 v148, v148, v225
    v_sub_f32 v149, v149, v225
    v_sub_f32 v150, v150, v225
    v_sub_f32 v151, v151, v225
    v_exp_f32 v148, v148
    v_exp_f32 v149, v149
    v_exp_f32 v150, v150
    v_exp_f32 v151, v151
    v_cvt_pk_bf16_f32 v170, v148, v149
    v_cvt_pk_bf16_f32 v171, v150, v151
    v_mfma_f32_32x32x16_bf16 v[64:79], v[184:187], v[160:163], v[64:79]
    v_sub_f32 v152, v152, v225
    v_sub_f32 v153, v153, v225
    v_sub_f32 v154, v154, v225
    v_sub_f32 v155, v155, v225
    v_exp_f32 v152, v152
    v_exp_f32 v153, v153
    v_exp_f32 v154, v154
    v_exp_f32 v155, v155
    v_cvt_pk_bf16_f32 v172, v152, v153
    v_cvt_pk_bf16_f32 v173, v154, v155
    v_mfma_f32_32x32x16_bf16 v[64:79], v[188:191], v[164:167], v[64:79]
    v_sub_f32 v156, v156, v225
    v_sub_f32 v157, v157, v225
    v_sub_f32 v158, v158, v225
    v_sub_f32 v159, v159, v225
    v_exp_f32 v156, v156
    v_exp_f32 v157, v157
    v_exp_f32 v158, v158
    v_exp_f32 v159, v159
    v_cvt_pk_bf16_f32 v174, v156, v157
    v_cvt_pk_bf16_f32 v175, v158, v159
    s_add_u32 s30, s42, 4096
    buffer_load_dwordx4 v[208:211], v1, s[4:7], s30 offen
    buffer_load_dwordx4 v[212:215], v1, s[4:7], s30 offen offset:1024
    s_add_u32 s30, s30, 2097152
    buffer_load_dwordx4 v[216:219], v1, s[4:7], s30 offen
    buffer_load_dwordx4 v[220:223], v1, s[4:7], s30 offen offset:1024
    v_mfma_f32_32x32x16_bf16 v[144:159], v[176:179], v[56:59], 0
    v_sub_f32 v128, v128, v226
    v_sub_f32 v129, v129, v226
    v_sub_f32 v130, v130, v226
    v_sub_f32 v131, v131, v226
    v_exp_f32 v128, v128
    v_exp_f32 v129, v129
    v_exp_f32 v130, v130
    v_exp_f32 v131, v131
    v_cvt_pk_bf16_f32 v160, v128, v129
    v_cvt_pk_bf16_f32 v161, v130, v131
    v_mfma_f32_32x32x16_bf16 v[144:159], v[180:183], v[60:63], v[144:159]
    v_sub_f32 v132, v132, v226
    v_sub_f32 v133, v133, v226
    v_sub_f32 v134, v134, v226
    v_sub_f32 v135, v135, v226
    v_exp_f32 v132, v132
    v_exp_f32 v133, v133
    v_exp_f32 v134, v134
    v_exp_f32 v135, v135
    v_cvt_pk_bf16_f32 v162, v132, v133
    v_cvt_pk_bf16_f32 v163, v134, v135
    v_mfma_f32_32x32x16_bf16 v[80:95], v[184:187], v[168:171], v[80:95]
    v_sub_f32 v136, v136, v226
    v_sub_f32 v137, v137, v226
    v_sub_f32 v138, v138, v226
    v_sub_f32 v139, v139, v226
    v_exp_f32 v136, v136
    v_exp_f32 v137, v137
    v_exp_f32 v138, v138
    v_exp_f32 v139, v139
    v_cvt_pk_bf16_f32 v164, v136, v137
    v_cvt_pk_bf16_f32 v165, v138, v139
    v_mfma_f32_32x32x16_bf16 v[80:95], v[188:191], v[172:175], v[80:95]
    v_sub_f32 v140, v140, v226
    v_sub_f32 v141, v141, v226
    v_sub_f32 v142, v142, v226
    v_sub_f32 v143, v143, v226
    v_exp_f32 v140, v140
    v_exp_f32 v141, v141
    v_exp_f32 v142, v142
    v_exp_f32 v143, v143
    v_cvt_pk_bf16_f32 v166, v140, v141
    v_cvt_pk_bf16_f32 v167, v142, v143
    s_waitcnt vmcnt(4)
    v_mfma_f32_32x32x16_bf16 v[128:143], v[192:195], v[32:35], 0
    v_sub_f32 v144, v144, v227
    v_sub_f32 v145, v145, v227
    v_sub_f32 v146, v146, v227
    v_sub_f32 v147, v147, v227
    v_exp_f32 v144, v144
    v_exp_f32 v145, v145
    v_exp_f32 v146, v146
    v_exp_f32 v147, v147
    v_cvt_pk_bf16_f32 v168, v144, v145
    v_cvt_pk_bf16_f32 v169, v146, v147
    v_mfma_f32_32x32x16_bf16 v[128:143], v[196:199], v[36:39], v[128:143]
    v_sub_f32 v148, v148, v227
    v_sub_f32 v149, v149, v227
    v_sub_f32 v150, v150, v227
    v_sub_f32 v151, v151, v227
    v_exp_f32 v148, v148
    v_exp_f32 v149, v149
    v_exp_f32 v150, v150
    v_exp_f32 v151, v151
    v_cvt_pk_bf16_f32 v170, v148, v149
    v_cvt_pk_bf16_f32 v171, v150, v151
    v_mfma_f32_32x32x16_bf16 v[96:111], v[184:187], v[160:163], v[96:111]
    v_sub_f32 v152, v152, v227
    v_sub_f32 v153, v153, v227
    v_sub_f32 v154, v154, v227
    v_sub_f32 v155, v155, v227
    v_exp_f32 v152, v152
    v_exp_f32 v153, v153
    v_exp_f32 v154, v154
    v_exp_f32 v155, v155
    v_cvt_pk_bf16_f32 v172, v152, v153
    v_cvt_pk_bf16_f32 v173, v154, v155
    v_mfma_f32_32x32x16_bf16 v[96:111], v[188:191], v[164:167], v[96:111]
    v_sub_f32 v156, v156, v227
    v_sub_f32 v157, v157, v227
    v_sub_f32 v158, v158, v227
    v_sub_f32 v159, v159, v227
    v_exp_f32 v156, v156
    v_exp_f32 v157, v157
    v_exp_f32 v158, v158
    v_exp_f32 v159, v159
    v_cvt_pk_bf16_f32 v174, v156, v157
    v_cvt_pk_bf16_f32 v175, v158, v159
    v_mfma_f32_32x32x16_bf16 v[144:159], v[192:195], v[40:43], 0
    v_sub_f32 v128, v128, v224
    v_sub_f32 v129, v129, v224
    v_sub_f32 v130, v130, v224
    v_sub_f32 v131, v131, v224
    v_exp_f32 v128, v128
    v_exp_f32 v129, v129
    v_exp_f32 v130, v130
    v_exp_f32 v131, v131
    v_cvt_pk_bf16_f32 v160, v128, v129
    v_cvt_pk_bf16_f32 v161, v130, v131
    v_mfma_f32_32x32x16_bf16 v[144:159], v[196:199], v[44:47], v[144:159]
    v_sub_f32 v132, v132, v224
    v_sub_f32 v133, v133, v224
    v_sub_f32 v134, v134, v224
    v_sub_f32 v135, v135, v224
    v_exp_f32 v132, v132
    v_exp_f32 v133, v133
    v_exp_f32 v134, v134
    v_exp_f32 v135, v135
    v_cvt_pk_bf16_f32 v162, v132, v133
    v_cvt_pk_bf16_f32 v163, v134, v135
    v_mfma_f32_32x32x16_bf16 v[112:127], v[184:187], v[168:171], v[112:127]
    v_sub_f32 v136, v136, v224
    v_sub_f32 v137, v137, v224
    v_sub_f32 v138, v138, v224
    v_sub_f32 v139, v139, v224
    v_exp_f32 v136, v136
    v_exp_f32 v137, v137
    v_exp_f32 v138, v138
    v_exp_f32 v139, v139
    v_cvt_pk_bf16_f32 v164, v136, v137
    v_cvt_pk_bf16_f32 v165, v138, v139
    v_mfma_f32_32x32x16_bf16 v[112:127], v[188:191], v[172:175], v[112:127]
    v_sub_f32 v140, v140, v224
    v_sub_f32 v141, v141, v224
    v_sub_f32 v142, v142, v224
    v_sub_f32 v143, v143, v224
    v_exp_f32 v140, v140
    v_exp_f32 v141, v141
    v_exp_f32 v142, v142
    v_exp_f32 v143, v143
    v_cvt_pk_bf16_f32 v166, v140, v141
    v_cvt_pk_bf16_f32 v167, v142, v143
    v_mfma_f32_32x32x16_bf16 v[128:143], v[192:195], v[48:51], 0
    v_sub_f32 v144, v144, v225
    v_sub_f32 v145, v145, v225
    v_sub_f32 v146, v146, v225
    v_sub_f32 v147, v147, v225
    v_exp_f32 v144, v144
    v_exp_f32 v145, v145
    v_exp_f32 v146, v146
    v_exp_f32 v147, v147
    v_cvt_pk_bf16_f32 v168, v144, v145
    v_cvt_pk_bf16_f32 v169, v146, v147
    v_mfma_f32_32x32x16_bf16 v[128:143], v[196:199], v[52:55], v[128:143]
    v_sub_f32 v148, v148, v225
    v_sub_f32 v149, v149, v225
    v_sub_f32 v150, v150, v225
    v_sub_f32 v151, v151, v225
    v_exp_f32 v148, v148
    v_exp_f32 v149, v149
    v_exp_f32 v150, v150
    v_exp_f32 v151, v151
    v_cvt_pk_bf16_f32 v170, v148, v149
    v_cvt_pk_bf16_f32 v171, v150, v151
    v_mfma_f32_32x32x16_bf16 v[64:79], v[200:203], v[160:163], v[64:79]
    v_sub_f32 v152, v152, v225
    v_sub_f32 v153, v153, v225
    v_sub_f32 v154, v154, v225
    v_sub_f32 v155, v155, v225
    v_exp_f32 v152, v152
    v_exp_f32 v153, v153
    v_exp_f32 v154, v154
    v_exp_f32 v155, v155
    v_cvt_pk_bf16_f32 v172, v152, v153
    v_cvt_pk_bf16_f32 v173, v154, v155
    v_mfma_f32_32x32x16_bf16 v[64:79], v[204:207], v[164:167], v[64:79]
    v_sub_f32 v156, v156, v225
    v_sub_f32 v157, v157, v225
    v_sub_f32 v158, v158, v225
    v_sub_f32 v159, v159, v225
    v_exp_f32 v156, v156
    v_exp_f32 v157, v157
    v_exp_f32 v158, v158
    v_exp_f32 v159, v159
    v_cvt_pk_bf16_f32 v174, v156, v157
    v_cvt_pk_bf16_f32 v175, v158, v159
    s_add_u32 s30, s42, 6144
    buffer_load_dwordx4 v[176:179], v1, s[4:7], s30 offen
    buffer_load_dwordx4 v[180:183], v1, s[4:7], s30 offen offset:1024
    s_add_u32 s30, s30, 2097152
    buffer_load_dwordx4 v[184:187], v1, s[4:7], s30 offen
    buffer_load_dwordx4 v[188:191], v1, s[4:7], s30 offen offset:1024
    v_mfma_f32_32x32x16_bf16 v[144:159], v[192:195], v[56:59], 0
    v_sub_f32 v128, v128, v226
    v_sub_f32 v129, v129, v226
    v_sub_f32 v130, v130, v226
    v_sub_f32 v131, v131, v226
    v_exp_f32 v128, v128
    v_exp_f32 v129, v129
    v_exp_f32 v130, v130
    v_exp_f32 v131, v131
    v_cvt_pk_bf16_f32 v160, v128, v129
    v_cvt_pk_bf16_f32 v161, v130, v131
    v_mfma_f32_32x32x16_bf16 v[144:159], v[196:199], v[60:63], v[144:159]
    v_sub_f32 v132, v132, v226
    v_sub_f32 v133, v133, v226
    v_sub_f32 v134, v134, v226
    v_sub_f32 v135, v135, v226
    v_exp_f32 v132, v132
    v_exp_f32 v133, v133
    v_exp_f32 v134, v134
    v_exp_f32 v135, v135
    v_cvt_pk_bf16_f32 v162, v132, v133
    v_cvt_pk_bf16_f32 v163, v134, v135
    v_mfma_f32_32x32x16_bf16 v[80:95], v[200:203], v[168:171], v[80:95]
    v_sub_f32 v136, v136, v226
    v_sub_f32 v137, v137, v226
    v_sub_f32 v138, v138, v226
    v_sub_f32 v139, v139, v226
    v_exp_f32 v136, v136
    v_exp_f32 v137, v137
    v_exp_f32 v138, v138
    v_exp_f32 v139, v139
    v_cvt_pk_bf16_f32 v164, v136, v137
    v_cvt_pk_bf16_f32 v165, v138, v139
    v_mfma_f32_32x32x16_bf16 v[80:95], v[204:207], v[172:175], v[80:95]
    v_sub_f32 v140, v140, v226
    v_sub_f32 v141, v141, v226
    v_sub_f32 v142, v142, v226
    v_sub_f32 v143, v143, v226
    v_exp_f32 v140, v140
    v_exp_f32 v141, v141
    v_exp_f32 v142, v142
    v_exp_f32 v143, v143
    v_cvt_pk_bf16_f32 v166, v140, v141
    v_cvt_pk_bf16_f32 v167, v142, v143
    s_waitcnt vmcnt(4)
    v_mfma_f32_32x32x16_bf16 v[128:143], v[208:211], v[32:35], 0
    v_sub_f32 v144, v144, v227
    v_sub_f32 v145, v145, v227
    v_sub_f32 v146, v146, v227
    v_sub_f32 v147, v147, v227
    v_exp_f32 v144, v144
    v_exp_f32 v145, v145
    v_exp_f32 v146, v146
    v_exp_f32 v147, v147
    v_cvt_pk_bf16_f32 v168, v144, v145
    v_cvt_pk_bf16_f32 v169, v146, v147
    v_mfma_f32_32x32x16_bf16 v[128:143], v[212:215], v[36:39], v[128:143]
    v_sub_f32 v148, v148, v227
    v_sub_f32 v149, v149, v227
    v_sub_f32 v150, v150, v227
    v_sub_f32 v151, v151, v227
    v_exp_f32 v148, v148
    v_exp_f32 v149, v149
    v_exp_f32 v150, v150
    v_exp_f32 v151, v151
    v_cvt_pk_bf16_f32 v170, v148, v149
    v_cvt_pk_bf16_f32 v171, v150, v151
    v_mfma_f32_32x32x16_bf16 v[96:111], v[200:203], v[160:163], v[96:111]
    v_sub_f32 v152, v152, v227
    v_sub_f32 v153, v153, v227
    v_sub_f32 v154, v154, v227
    v_sub_f32 v155, v155, v227
    v_exp_f32 v152, v152
    v_exp_f32 v153, v153
    v_exp_f32 v154, v154
    v_exp_f32 v155, v155
    v_cvt_pk_bf16_f32 v172, v152, v153
    v_cvt_pk_bf16_f32 v173, v154, v155
    v_mfma_f32_32x32x16_bf16 v[96:111], v[204:207], v[164:167], v[96:111]
    v_sub_f32 v156, v156, v227
    v_sub_f32 v157, v157, v227
    v_sub_f32 v158, v158, v227
    v_sub_f32 v159, v159, v227
    v_exp_f32 v156, v156
    v_exp_f32 v157, v157
    v_exp_f32 v158, v158
    v_exp_f32 v159, v159
    v_cvt_pk_bf16_f32 v174, v156, v157
    v_cvt_pk_bf16_f32 v175, v158, v159
    v_mfma_f32_32x32x16_bf16 v[144:159], v[208:211], v[40:43], 0
    v_sub_f32 v128, v128, v224
    v_sub_f32 v129, v129, v224
    v_sub_f32 v130, v130, v224
    v_sub_f32 v131, v131, v224
    v_exp_f32 v128, v128
    v_exp_f32 v129, v129
    v_exp_f32 v130, v130
    v_exp_f32 v131, v131
    v_cvt_pk_bf16_f32 v160, v128, v129
    v_cvt_pk_bf16_f32 v161, v130, v131
    v_mfma_f32_32x32x16_bf16 v[144:159], v[212:215], v[44:47], v[144:159]
    v_sub_f32 v132, v132, v224
    v_sub_f32 v133, v133, v224
    v_sub_f32 v134, v134, v224
    v_sub_f32 v135, v135, v224
    v_exp_f32 v132, v132
    v_exp_f32 v133, v133
    v_exp_f32 v134, v134
    v_exp_f32 v135, v135
    v_cvt_pk_bf16_f32 v162, v132, v133
    v_cvt_pk_bf16_f32 v163, v134, v135
    v_mfma_f32_32x32x16_bf16 v[112:127], v[200:203], v[168:171], v[112:127]
    v_sub_f32 v136, v136, v224
    v_sub_f32 v137, v137, v224
    v_sub_f32 v138, v138, v224
    v_sub_f32 v139, v139, v224
    v_exp_f32 v136, v136
    v_exp_f32 v137, v137
    v_exp_f32 v138, v138
    v_exp_f32 v139, v139
    v_cvt_pk_bf16_f32 v164, v136, v137
    v_cvt_pk_bf16_f32 v165, v138, v139
    v_mfma_f32_32x32x16_bf16 v[112:127], v[204:207], v[172:175], v[112:127]
    v_sub_f32 v140, v140, v224
    v_sub_f32 v141, v141, v224
    v_sub_f32 v142, v142, v224
    v_sub_f32 v143, v143, v224
    v_exp_f32 v140, v140
    v_exp_f32 v141, v141
    v_exp_f32 v142, v142
    v_exp_f32 v143, v143
    v_cvt_pk_bf16_f32 v166, v140, v141
    v_cvt_pk_bf16_f32 v167, v142, v143
    v_mfma_f32_32x32x16_bf16 v[128:143], v[208:211], v[48:51], 0
    v_sub_f32 v144, v144, v225
    v_sub_f32 v145, v145, v225
    v_sub_f32 v146, v146, v225
    v_sub_f32 v147, v147, v225
    v_exp_f32 v144, v144
    v_exp_f32 v145, v145
    v_exp_f32 v146, v146
    v_exp_f32 v147, v147
    v_cvt_pk_bf16_f32 v168, v144, v145
    v_cvt_pk_bf16_f32 v169, v146, v147
    v_mfma_f32_32x32x16_bf16 v[128:143], v[212:215], v[52:55], v[128:143]
    v_sub_f32 v148, v148, v225
    v_sub_f32 v149, v149, v225
    v_sub_f32 v150, v150, v225
    v_sub_f32 v151, v151, v225
    v_exp_f32 v148, v148
    v_exp_f32 v149, v149
    v_exp_f32 v150, v150
    v_exp_f32 v151, v151
    v_cvt_pk_bf16_f32 v170, v148, v149
    v_cvt_pk_bf16_f32 v171, v150, v151
    v_mfma_f32_32x32x16_bf16 v[64:79], v[216:219], v[160:163], v[64:79]
    v_sub_f32 v152, v152, v225
    v_sub_f32 v153, v153, v225
    v_sub_f32 v154, v154, v225
    v_sub_f32 v155, v155, v225
    v_exp_f32 v152, v152
    v_exp_f32 v153, v153
    v_exp_f32 v154, v154
    v_exp_f32 v155, v155
    v_cvt_pk_bf16_f32 v172, v152, v153
    v_cvt_pk_bf16_f32 v173, v154, v155
    v_mfma_f32_32x32x16_bf16 v[64:79], v[220:223], v[164:167], v[64:79]
    v_sub_f32 v156, v156, v225
    v_sub_f32 v157, v157, v225
    v_sub_f32 v158, v158, v225
    v_sub_f32 v159, v159, v225
    v_exp_f32 v156, v156
    v_exp_f32 v157, v157
    v_exp_f32 v158, v158
    v_exp_f32 v159, v159
    v_cvt_pk_bf16_f32 v174, v156, v157
    v_cvt_pk_bf16_f32 v175, v158, v159
    s_add_u32 s30, s42, 8192
    buffer_load_dwordx4 v[192:195], v1, s[4:7], s30 offen
    buffer_load_dwordx4 v[196:199], v1, s[4:7], s30 offen offset:1024
    s_add_u32 s30, s30, 2097152
    buffer_load_dwordx4 v[200:203], v1, s[4:7], s30 offen
    buffer_load_dwordx4 v[204:207], v1, s[4:7], s30 offen offset:1024
    v_mfma_f32_32x32x16_bf16 v[144:159], v[208:211], v[56:59], 0
    v_sub_f32 v128, v128, v226
    v_sub_f32 v129, v129, v226
    v_sub_f32 v130, v130, v226
    v_sub_f32 v131, v131, v226
    v_exp_f32 v128, v128
    v_exp_f32 v129, v129
    v_exp_f32 v130, v130
    v_exp_f32 v131, v131
    v_cvt_pk_bf16_f32 v160, v128, v129
    v_cvt_pk_bf16_f32 v161, v130, v131
    v_mfma_f32_32x32x16_bf16 v[144:159], v[212:215], v[60:63], v[144:159]
    v_sub_f32 v132, v132, v226
    v_sub_f32 v133, v133, v226
    v_sub_f32 v134, v134, v226
    v_sub_f32 v135, v135, v226
    v_exp_f32 v132, v132
    v_exp_f32 v133, v133
    v_exp_f32 v134, v134
    v_exp_f32 v135, v135
    v_cvt_pk_bf16_f32 v162, v132, v133
    v_cvt_pk_bf16_f32 v163, v134, v135
    v_mfma_f32_32x32x16_bf16 v[80:95], v[216:219], v[168:171], v[80:95]
    v_sub_f32 v136, v136, v226
    v_sub_f32 v137, v137, v226
    v_sub_f32 v138, v138, v226
    v_sub_f32 v139, v139, v226
    v_exp_f32 v136, v136
    v_exp_f32 v137, v137
    v_exp_f32 v138, v138
    v_exp_f32 v139, v139
    v_cvt_pk_bf16_f32 v164, v136, v137
    v_cvt_pk_bf16_f32 v165, v138, v139
    v_mfma_f32_32x32x16_bf16 v[80:95], v[220:223], v[172:175], v[80:95]
    v_sub_f32 v140, v140, v226
    v_sub_f32 v141, v141, v226
    v_sub_f32 v142, v142, v226
    v_sub_f32 v143, v143, v226
    v_exp_f32 v140, v140
    v_exp_f32 v141, v141
    v_exp_f32 v142, v142
    v_exp_f32 v143, v143
    v_cvt_pk_bf16_f32 v166, v140, v141
    v_cvt_pk_bf16_f32 v167, v142, v143
    s_waitcnt vmcnt(4)
    v_mfma_f32_32x32x16_bf16 v[128:143], v[176:179], v[32:35], 0
    v_sub_f32 v144, v144, v227
    v_sub_f32 v145, v145, v227
    v_sub_f32 v146, v146, v227
    v_sub_f32 v147, v147, v227
    v_exp_f32 v144, v144
    v_exp_f32 v145, v145
    v_exp_f32 v146, v146
    v_exp_f32 v147, v147
    v_cvt_pk_bf16_f32 v168, v144, v145
    v_cvt_pk_bf16_f32 v169, v146, v147
    v_mfma_f32_32x32x16_bf16 v[128:143], v[180:183], v[36:39], v[128:143]
    v_sub_f32 v148, v148, v227
    v_sub_f32 v149, v149, v227
    v_sub_f32 v150, v150, v227
    v_sub_f32 v151, v151, v227
    v_exp_f32 v148, v148
    v_exp_f32 v149, v149
    v_exp_f32 v150, v150
    v_exp_f32 v151, v151
    v_cvt_pk_bf16_f32 v170, v148, v149
    v_cvt_pk_bf16_f32 v171, v150, v151
    v_mfma_f32_32x32x16_bf16 v[96:111], v[216:219], v[160:163], v[96:111]
    v_sub_f32 v152, v152, v227
    v_sub_f32 v153, v153, v227
    v_sub_f32 v154, v154, v227
    v_sub_f32 v155, v155, v227
    v_exp_f32 v152, v152
    v_exp_f32 v153, v153
    v_exp_f32 v154, v154
    v_exp_f32 v155, v155
    v_cvt_pk_bf16_f32 v172, v152, v153
    v_cvt_pk_bf16_f32 v173, v154, v155
    v_mfma_f32_32x32x16_bf16 v[96:111], v[220:223], v[164:167], v[96:111]
    v_sub_f32 v156, v156, v227
    v_sub_f32 v157, v157, v227
    v_sub_f32 v158, v158, v227
    v_sub_f32 v159, v159, v227
    v_exp_f32 v156, v156
    v_exp_f32 v157, v157
    v_exp_f32 v158, v158
    v_exp_f32 v159, v159
    v_cvt_pk_bf16_f32 v174, v156, v157
    v_cvt_pk_bf16_f32 v175, v158, v159
    v_mfma_f32_32x32x16_bf16 v[144:159], v[176:179], v[40:43], 0
    v_sub_f32 v128, v128, v224
    v_sub_f32 v129, v129, v224
    v_sub_f32 v130, v130, v224
    v_sub_f32 v131, v131, v224
    v_exp_f32 v128, v128
    v_exp_f32 v129, v129
    v_exp_f32 v130, v130
    v_exp_f32 v131, v131
    v_cvt_pk_bf16_f32 v160, v128, v129
    v_cvt_pk_bf16_f32 v161, v130, v131
    v_mfma_f32_32x32x16_bf16 v[144:159], v[180:183], v[44:47], v[144:159]
    v_sub_f32 v132, v132, v224
    v_sub_f32 v133, v133, v224
    v_sub_f32 v134, v134, v224
    v_sub_f32 v135, v135, v224
    v_exp_f32 v132, v132
    v_exp_f32 v133, v133
    v_exp_f32 v134, v134
    v_exp_f32 v135, v135
    v_cvt_pk_bf16_f32 v162, v132, v133
    v_cvt_pk_bf16_f32 v163, v134, v135
    v_mfma_f32_32x32x16_bf16 v[112:127], v[216:219], v[168:171], v[112:127]
    v_sub_f32 v136, v136, v224
    v_sub_f32 v137, v137, v224
    v_sub_f32 v138, v138, v224
    v_sub_f32 v139, v139, v224
    v_exp_f32 v136, v136
    v_exp_f32 v137, v137
    v_exp_f32 v138, v138
    v_exp_f32 v139, v139
    v_cvt_pk_bf16_f32 v164, v136, v137
    v_cvt_pk_bf16_f32 v165, v138, v139
    v_mfma_f32_32x32x16_bf16 v[112:127], v[220:223], v[172:175], v[112:127]
    v_sub_f32 v140, v140, v224
    v_sub_f32 v141, v141, v224
    v_sub_f32 v142, v142, v224
    v_sub_f32 v143, v143, v224
    v_exp_f32 v140, v140
    v_exp_f32 v141, v141
    v_exp_f32 v142, v142
    v_exp_f32 v143, v143
    v_cvt_pk_bf16_f32 v166, v140, v141
    v_cvt_pk_bf16_f32 v167, v142, v143
    v_mfma_f32_32x32x16_bf16 v[128:143], v[176:179], v[48:51], 0
    v_sub_f32 v144, v144, v225
    v_sub_f32 v145, v145, v225
    v_sub_f32 v146, v146, v225
    v_sub_f32 v147, v147, v225
    v_exp_f32 v144, v144
    v_exp_f32 v145, v145
    v_exp_f32 v146, v146
    v_exp_f32 v147, v147
    v_cvt_pk_bf16_f32 v168, v144, v145
    v_cvt_pk_bf16_f32 v169, v146, v147
    v_mfma_f32_32x32x16_bf16 v[128:143], v[180:183], v[52:55], v[128:143]
    v_sub_f32 v148, v148, v225
    v_sub_f32 v149, v149, v225
    v_sub_f32 v150, v150, v225
    v_sub_f32 v151, v151, v225
    v_exp_f32 v148, v148
    v_exp_f32 v149, v149
    v_exp_f32 v150, v150
    v_exp_f32 v151, v151
    v_cvt_pk_bf16_f32 v170, v148, v149
    v_cvt_pk_bf16_f32 v171, v150, v151
    v_mfma_f32_32x32x16_bf16 v[64:79], v[184:187], v[160:163], v[64:79]
    v_sub_f32 v152, v152, v225
    v_sub_f32 v153, v153, v225
    v_sub_f32 v154, v154, v225
    v_sub_f32 v155, v155, v225
    v_exp_f32 v152, v152
    v_exp_f32 v153, v153
    v_exp_f32 v154, v154
    v_exp_f32 v155, v155
    v_cvt_pk_bf16_f32 v172, v152, v153
    v_cvt_pk_bf16_f32 v173, v154, v155
    v_mfma_f32_32x32x16_bf16 v[64:79], v[188:191], v[164:167], v[64:79]
    v_sub_f32 v156, v156, v225
    v_sub_f32 v157, v157, v225
    v_sub_f32 v158, v158, v225
    v_sub_f32 v159, v159, v225
    v_exp_f32 v156, v156
    v_exp_f32 v157, v157
    v_exp_f32 v158, v158
    v_exp_f32 v159, v159
    v_cvt_pk_bf16_f32 v174, v156, v157
    v_cvt_pk_bf16_f32 v175, v158, v159
    s_add_u32 s30, s42, 10240
    buffer_load_dwordx4 v[208:211], v1, s[4:7], s30 offen
    buffer_load_dwordx4 v[212:215], v1, s[4:7], s30 offen offset:1024
    s_add_u32 s30, s30, 2097152
    buffer_load_dwordx4 v[216:219], v1, s[4:7], s30 offen
    buffer_load_dwordx4 v[220:223], v1, s[4:7], s30 offen offset:1024
    v_mfma_f32_32x32x16_bf16 v[144:159], v[176:179], v[56:59], 0
    v_sub_f32 v128, v128, v226
    v_sub_f32 v129, v129, v226
    v_sub_f32 v130, v130, v226
    v_sub_f32 v131, v131, v226
    v_exp_f32 v128, v128
    v_exp_f32 v129, v129
    v_exp_f32 v130, v130
    v_exp_f32 v131, v131
    v_cvt_pk_bf16_f32 v160, v128, v129
    v_cvt_pk_bf16_f32 v161, v130, v131
    v_mfma_f32_32x32x16_bf16 v[144:159], v[180:183], v[60:63], v[144:159]
    v_sub_f32 v132, v132, v226
    v_sub_f32 v133, v133, v226
    v_sub_f32 v134, v134, v226
    v_sub_f32 v135, v135, v226
    v_exp_f32 v132, v132
    v_exp_f32 v133, v133
    v_exp_f32 v134, v134
    v_exp_f32 v135, v135
    v_cvt_pk_bf16_f32 v162, v132, v133
    v_cvt_pk_bf16_f32 v163, v134, v135
    v_mfma_f32_32x32x16_bf16 v[80:95], v[184:187], v[168:171], v[80:95]
    v_sub_f32 v136, v136, v226
    v_sub_f32 v137, v137, v226
    v_sub_f32 v138, v138, v226
    v_sub_f32 v139, v139, v226
    v_exp_f32 v136, v136
    v_exp_f32 v137, v137
    v_exp_f32 v138, v138
    v_exp_f32 v139, v139
    v_cvt_pk_bf16_f32 v164, v136, v137
    v_cvt_pk_bf16_f32 v165, v138, v139
    v_mfma_f32_32x32x16_bf16 v[80:95], v[188:191], v[172:175], v[80:95]
    v_sub_f32 v140, v140, v226
    v_sub_f32 v141, v141, v226
    v_sub_f32 v142, v142, v226
    v_sub_f32 v143, v143, v226
    v_exp_f32 v140, v140
    v_exp_f32 v141, v141
    v_exp_f32 v142, v142
    v_exp_f32 v143, v143
    v_cvt_pk_bf16_f32 v166, v140, v141
    v_cvt_pk_bf16_f32 v167, v142, v143
    s_waitcnt vmcnt(4)
    v_mfma_f32_32x32x16_bf16 v[128:143], v[192:195], v[32:35], 0
    v_sub_f32 v144, v144, v227
    v_sub_f32 v145, v145, v227
    v_sub_f32 v146, v146, v227
    v_sub_f32 v147, v147, v227
    v_exp_f32 v144, v144
    v_exp_f32 v145, v145
    v_exp_f32 v146, v146
    v_exp_f32 v147, v147
    v_cvt_pk_bf16_f32 v168, v144, v145
    v_cvt_pk_bf16_f32 v169, v146, v147
    v_mfma_f32_32x32x16_bf16 v[128:143], v[196:199], v[36:39], v[128:143]
    v_sub_f32 v148, v148, v227
    v_sub_f32 v149, v149, v227
    v_sub_f32 v150, v150, v227
    v_sub_f32 v151, v151, v227
    v_exp_f32 v148, v148
    v_exp_f32 v149, v149
    v_exp_f32 v150, v150
    v_exp_f32 v151, v151
    v_cvt_pk_bf16_f32 v170, v148, v149
    v_cvt_pk_bf16_f32 v171, v150, v151
    v_mfma_f32_32x32x16_bf16 v[96:111], v[184:187], v[160:163], v[96:111]
    v_sub_f32 v152, v152, v227
    v_sub_f32 v153, v153, v227
    v_sub_f32 v154, v154, v227
    v_sub_f32 v155, v155, v227
    v_exp_f32 v152, v152
    v_exp_f32 v153, v153
    v_exp_f32 v154, v154
    v_exp_f32 v155, v155
    v_cvt_pk_bf16_f32 v172, v152, v153
    v_cvt_pk_bf16_f32 v173, v154, v155
    v_mfma_f32_32x32x16_bf16 v[96:111], v[188:191], v[164:167], v[96:111]
    v_sub_f32 v156, v156, v227
    v_sub_f32 v157, v157, v227
    v_sub_f32 v158, v158, v227
    v_sub_f32 v159, v159, v227
    v_exp_f32 v156, v156
    v_exp_f32 v157, v157
    v_exp_f32 v158, v158
    v_exp_f32 v159, v159
    v_cvt_pk_bf16_f32 v174, v156, v157
    v_cvt_pk_bf16_f32 v175, v158, v159
    v_mfma_f32_32x32x16_bf16 v[144:159], v[192:195], v[40:43], 0
    v_sub_f32 v128, v128, v224
    v_sub_f32 v129, v129, v224
    v_sub_f32 v130, v130, v224
    v_sub_f32 v131, v131, v224
    v_exp_f32 v128, v128
    v_exp_f32 v129, v129
    v_exp_f32 v130, v130
    v_exp_f32 v131, v131
    v_cvt_pk_bf16_f32 v160, v128, v129
    v_cvt_pk_bf16_f32 v161, v130, v131
    v_mfma_f32_32x32x16_bf16 v[144:159], v[196:199], v[44:47], v[144:159]
    v_sub_f32 v132, v132, v224
    v_sub_f32 v133, v133, v224
    v_sub_f32 v134, v134, v224
    v_sub_f32 v135, v135, v224
    v_exp_f32 v132, v132
    v_exp_f32 v133, v133
    v_exp_f32 v134, v134
    v_exp_f32 v135, v135
    v_cvt_pk_bf16_f32 v162, v132, v133
    v_cvt_pk_bf16_f32 v163, v134, v135
    v_mfma_f32_32x32x16_bf16 v[112:127], v[184:187], v[168:171], v[112:127]
    v_sub_f32 v136, v136, v224
    v_sub_f32 v137, v137, v224
    v_sub_f32 v138, v138, v224
    v_sub_f32 v139, v139, v224
    v_exp_f32 v136, v136
    v_exp_f32 v137, v137
    v_exp_f32 v138, v138
    v_exp_f32 v139, v139
    v_cvt_pk_bf16_f32 v164, v136, v137
    v_cvt_pk_bf16_f32 v165, v138, v139
    v_mfma_f32_32x32x16_bf16 v[112:127], v[188:191], v[172:175], v[112:127]
    v_sub_f32 v140, v140, v224
    v_sub_f32 v141, v141, v224
    v_sub_f32 v142, v142, v224
    v_sub_f32 v143, v143, v224
    v_exp_f32 v140, v140
    v_exp_f32 v141, v141
    v_exp_f32 v142, v142
    v_exp_f32 v143, v143
    v_cvt_pk_bf16_f32 v166, v140, v141
    v_cvt_pk_bf16_f32 v167, v142, v143
    v_mfma_f32_32x32x16_bf16 v[128:143], v[192:195], v[48:51], 0
    v_sub_f32 v144, v144, v225
    v_sub_f32 v145, v145, v225
    v_sub_f32 v146, v146, v225
    v_sub_f32 v147, v147, v225
    v_exp_f32 v144, v144
    v_exp_f32 v145, v145
    v_exp_f32 v146, v146
    v_exp_f32 v147, v147
    v_cvt_pk_bf16_f32 v168, v144, v145
    v_cvt_pk_bf16_f32 v169, v146, v147
    v_mfma_f32_32x32x16_bf16 v[128:143], v[196:199], v[52:55], v[128:143]
    v_sub_f32 v148, v148, v225
    v_sub_f32 v149, v149, v225
    v_sub_f32 v150, v150, v225
    v_sub_f32 v151, v151, v225
    v_exp_f32 v148, v148
    v_exp_f32 v149, v149
    v_exp_f32 v150, v150
    v_exp_f32 v151, v151
    v_cvt_pk_bf16_f32 v170, v148, v149
    v_cvt_pk_bf16_f32 v171, v150, v151
    v_mfma_f32_32x32x16_bf16 v[64:79], v[200:203], v[160:163], v[64:79]
    v_sub_f32 v152, v152, v225
    v_sub_f32 v153, v153, v225
    v_sub_f32 v154, v154, v225
    v_sub_f32 v155, v155, v225
    v_exp_f32 v152, v152
    v_exp_f32 v153, v153
    v_exp_f32 v154, v154
    v_exp_f32 v155, v155
    v_cvt_pk_bf16_f32 v172, v152, v153
    v_cvt_pk_bf16_f32 v173, v154, v155
    v_mfma_f32_32x32x16_bf16 v[64:79], v[204:207], v[164:167], v[64:79]
    v_sub_f32 v156, v156, v225
    v_sub_f32 v157, v157, v225
    v_sub_f32 v158, v158, v225
    v_sub_f32 v159, v159, v225
    v_exp_f32 v156, v156
    v_exp_f32 v157, v157
    v_exp_f32 v158, v158
    v_exp_f32 v159, v159
    v_cvt_pk_bf16_f32 v174, v156, v157
    v_cvt_pk_bf16_f32 v175, v158, v159
    s_add_u32 s30, s42, 12288
    buffer_load_dwordx4 v[176:179], v1, s[4:7], s30 offen
    buffer_load_dwordx4 v[180:183], v1, s[4:7], s30 offen offset:1024
    s_add_u32 s30, s30, 2097152
    buffer_load_dwordx4 v[184:187], v1, s[4:7], s30 offen
    buffer_load_dwordx4 v[188:191], v1, s[4:7], s30 offen offset:1024
    v_mfma_f32_32x32x16_bf16 v[144:159], v[192:195], v[56:59], 0
    v_sub_f32 v128, v128, v226
    v_sub_f32 v129, v129, v226
    v_sub_f32 v130, v130, v226
    v_sub_f32 v131, v131, v226
    v_exp_f32 v128, v128
    v_exp_f32 v129, v129
    v_exp_f32 v130, v130
    v_exp_f32 v131, v131
    v_cvt_pk_bf16_f32 v160, v128, v129
    v_cvt_pk_bf16_f32 v161, v130, v131
    v_mfma_f32_32x32x16_bf16 v[144:159], v[196:199], v[60:63], v[144:159]
    v_sub_f32 v132, v132, v226
    v_sub_f32 v133, v133, v226
    v_sub_f32 v134, v134, v226
    v_sub_f32 v135, v135, v226
    v_exp_f32 v132, v132
    v_exp_f32 v133, v133
    v_exp_f32 v134, v134
    v_exp_f32 v135, v135
    v_cvt_pk_bf16_f32 v162, v132, v133
    v_cvt_pk_bf16_f32 v163, v134, v135
    v_mfma_f32_32x32x16_bf16 v[80:95], v[200:203], v[168:171], v[80:95]
    v_sub_f32 v136, v136, v226
    v_sub_f32 v137, v137, v226
    v_sub_f32 v138, v138, v226
    v_sub_f32 v139, v139, v226
    v_exp_f32 v136, v136
    v_exp_f32 v137, v137
    v_exp_f32 v138, v138
    v_exp_f32 v139, v139
    v_cvt_pk_bf16_f32 v164, v136, v137
    v_cvt_pk_bf16_f32 v165, v138, v139
    v_mfma_f32_32x32x16_bf16 v[80:95], v[204:207], v[172:175], v[80:95]
    v_sub_f32 v140, v140, v226
    v_sub_f32 v141, v141, v226
    v_sub_f32 v142, v142, v226
    v_sub_f32 v143, v143, v226
    v_exp_f32 v140, v140
    v_exp_f32 v141, v141
    v_exp_f32 v142, v142
    v_exp_f32 v143, v143
    v_cvt_pk_bf16_f32 v166, v140, v141
    v_cvt_pk_bf16_f32 v167, v142, v143
    s_waitcnt vmcnt(4)
    v_mfma_f32_32x32x16_bf16 v[128:143], v[208:211], v[32:35], 0
    v_sub_f32 v144, v144, v227
    v_sub_f32 v145, v145, v227
    v_sub_f32 v146, v146, v227
    v_sub_f32 v147, v147, v227
    v_exp_f32 v144, v144
    v_exp_f32 v145, v145
    v_exp_f32 v146, v146
    v_exp_f32 v147, v147
    v_cvt_pk_bf16_f32 v168, v144, v145
    v_cvt_pk_bf16_f32 v169, v146, v147
    v_mfma_f32_32x32x16_bf16 v[128:143], v[212:215], v[36:39], v[128:143]
    v_sub_f32 v148, v148, v227
    v_sub_f32 v149, v149, v227
    v_sub_f32 v150, v150, v227
    v_sub_f32 v151, v151, v227
    v_exp_f32 v148, v148
    v_exp_f32 v149, v149
    v_exp_f32 v150, v150
    v_exp_f32 v151, v151
    v_cvt_pk_bf16_f32 v170, v148, v149
    v_cvt_pk_bf16_f32 v171, v150, v151
    v_mfma_f32_32x32x16_bf16 v[96:111], v[200:203], v[160:163], v[96:111]
    v_sub_f32 v152, v152, v227
    v_sub_f32 v153, v153, v227
    v_sub_f32 v154, v154, v227
    v_sub_f32 v155, v155, v227
    v_exp_f32 v152, v152
    v_exp_f32 v153, v153
    v_exp_f32 v154, v154
    v_exp_f32 v155, v155
    v_cvt_pk_bf16_f32 v172, v152, v153
    v_cvt_pk_bf16_f32 v173, v154, v155
    v_mfma_f32_32x32x16_bf16 v[96:111], v[204:207], v[164:167], v[96:111]
    v_sub_f32 v156, v156, v227
    v_sub_f32 v157, v157, v227
    v_sub_f32 v158, v158, v227
    v_sub_f32 v159, v159, v227
    v_exp_f32 v156, v156
    v_exp_f32 v157, v157
    v_exp_f32 v158, v158
    v_exp_f32 v159, v159
    v_cvt_pk_bf16_f32 v174, v156, v157
    v_cvt_pk_bf16_f32 v175, v158, v159
    v_mfma_f32_32x32x16_bf16 v[144:159], v[208:211], v[40:43], 0
    v_sub_f32 v128, v128, v224
    v_sub_f32 v129, v129, v224
    v_sub_f32 v130, v130, v224
    v_sub_f32 v131, v131, v224
    v_exp_f32 v128, v128
    v_exp_f32 v129, v129
    v_exp_f32 v130, v130
    v_exp_f32 v131, v131
    v_cvt_pk_bf16_f32 v160, v128, v129
    v_cvt_pk_bf16_f32 v161, v130, v131
    v_mfma_f32_32x32x16_bf16 v[144:159], v[212:215], v[44:47], v[144:159]
    v_sub_f32 v132, v132, v224
    v_sub_f32 v133, v133, v224
    v_sub_f32 v134, v134, v224
    v_sub_f32 v135, v135, v224
    v_exp_f32 v132, v132
    v_exp_f32 v133, v133
    v_exp_f32 v134, v134
    v_exp_f32 v135, v135
    v_cvt_pk_bf16_f32 v162, v132, v133
    v_cvt_pk_bf16_f32 v163, v134, v135
    v_mfma_f32_32x32x16_bf16 v[112:127], v[200:203], v[168:171], v[112:127]
    v_sub_f32 v136, v136, v224
    v_sub_f32 v137, v137, v224
    v_sub_f32 v138, v138, v224
    v_sub_f32 v139, v139, v224
    v_exp_f32 v136, v136
    v_exp_f32 v137, v137
    v_exp_f32 v138, v138
    v_exp_f32 v139, v139
    v_cvt_pk_bf16_f32 v164, v136, v137
    v_cvt_pk_bf16_f32 v165, v138, v139
    v_mfma_f32_32x32x16_bf16 v[112:127], v[204:207], v[172:175], v[112:127]
    v_sub_f32 v140, v140, v224
    v_sub_f32 v141, v141, v224
    v_sub_f32 v142, v142, v224
    v_sub_f32 v143, v143, v224
    v_exp_f32 v140, v140
    v_exp_f32 v141, v141
    v_exp_f32 v142, v142
    v_exp_f32 v143, v143
    v_cvt_pk_bf16_f32 v166, v140, v141
    v_cvt_pk_bf16_f32 v167, v142, v143
    v_mfma_f32_32x32x16_bf16 v[128:143], v[208:211], v[48:51], 0
    v_sub_f32 v144, v144, v225
    v_sub_f32 v145, v145, v225
    v_sub_f32 v146, v146, v225
    v_sub_f32 v147, v147, v225
    v_exp_f32 v144, v144
    v_exp_f32 v145, v145
    v_exp_f32 v146, v146
    v_exp_f32 v147, v147
    v_cvt_pk_bf16_f32 v168, v144, v145
    v_cvt_pk_bf16_f32 v169, v146, v147
    v_mfma_f32_32x32x16_bf16 v[128:143], v[212:215], v[52:55], v[128:143]
    v_sub_f32 v148, v148, v225
    v_sub_f32 v149, v149, v225
    v_sub_f32 v150, v150, v225
    v_sub_f32 v151, v151, v225
    v_exp_f32 v148, v148
    v_exp_f32 v149, v149
    v_exp_f32 v150, v150
    v_exp_f32 v151, v151
    v_cvt_pk_bf16_f32 v170, v148, v149
    v_cvt_pk_bf16_f32 v171, v150, v151
    v_mfma_f32_32x32x16_bf16 v[64:79], v[216:219], v[160:163], v[64:79]
    v_sub_f32 v152, v152, v225
    v_sub_f32 v153, v153, v225
    v_sub_f32 v154, v154, v225
    v_sub_f32 v155, v155, v225
    v_exp_f32 v152, v152
    v_exp_f32 v153, v153
    v_exp_f32 v154, v154
    v_exp_f32 v155, v155
    v_cvt_pk_bf16_f32 v172, v152, v153
    v_cvt_pk_bf16_f32 v173, v154, v155
    v_mfma_f32_32x32x16_bf16 v[64:79], v[220:223], v[164:167], v[64:79]
    v_sub_f32 v156, v156, v225
    v_sub_f32 v157, v157, v225
    v_sub_f32 v158, v158, v225
    v_sub_f32 v159, v159, v225
    v_exp_f32 v156, v156
    v_exp_f32 v157, v157
    v_exp_f32 v158, v158
    v_exp_f32 v159, v159
    v_cvt_pk_bf16_f32 v174, v156, v157
    v_cvt_pk_bf16_f32 v175, v158, v159
    s_add_u32 s30, s42, 14336
    buffer_load_dwordx4 v[192:195], v1, s[4:7], s30 offen
    buffer_load_dwordx4 v[196:199], v1, s[4:7], s30 offen offset:1024
    s_add_u32 s30, s30, 2097152
    buffer_load_dwordx4 v[200:203], v1, s[4:7], s30 offen
    buffer_load_dwordx4 v[204:207], v1, s[4:7], s30 offen offset:1024
    v_mfma_f32_32x32x16_bf16 v[144:159], v[208:211], v[56:59], 0
    v_sub_f32 v128, v128, v226
    v_sub_f32 v129, v129, v226
    v_sub_f32 v130, v130, v226
    v_sub_f32 v131, v131, v226
    v_exp_f32 v128, v128
    v_exp_f32 v129, v129
    v_exp_f32 v130, v130
    v_exp_f32 v131, v131
    v_cvt_pk_bf16_f32 v160, v128, v129
    v_cvt_pk_bf16_f32 v161, v130, v131
    v_mfma_f32_32x32x16_bf16 v[144:159], v[212:215], v[60:63], v[144:159]
    v_sub_f32 v132, v132, v226
    v_sub_f32 v133, v133, v226
    v_sub_f32 v134, v134, v226
    v_sub_f32 v135, v135, v226
    v_exp_f32 v132, v132
    v_exp_f32 v133, v133
    v_exp_f32 v134, v134
    v_exp_f32 v135, v135
    v_cvt_pk_bf16_f32 v162, v132, v133
    v_cvt_pk_bf16_f32 v163, v134, v135
    v_mfma_f32_32x32x16_bf16 v[80:95], v[216:219], v[168:171], v[80:95]
    v_sub_f32 v136, v136, v226
    v_sub_f32 v137, v137, v226
    v_sub_f32 v138, v138, v226
    v_sub_f32 v139, v139, v226
    v_exp_f32 v136, v136
    v_exp_f32 v137, v137
    v_exp_f32 v138, v138
    v_exp_f32 v139, v139
    v_cvt_pk_bf16_f32 v164, v136, v137
    v_cvt_pk_bf16_f32 v165, v138, v139
    v_mfma_f32_32x32x16_bf16 v[80:95], v[220:223], v[172:175], v[80:95]
    v_sub_f32 v140, v140, v226
    v_sub_f32 v141, v141, v226
    v_sub_f32 v142, v142, v226
    v_sub_f32 v143, v143, v226
    v_exp_f32 v140, v140
    v_exp_f32 v141, v141
    v_exp_f32 v142, v142
    v_exp_f32 v143, v143
    v_cvt_pk_bf16_f32 v166, v140, v141
    v_cvt_pk_bf16_f32 v167, v142, v143
    s_waitcnt vmcnt(4)
    v_mfma_f32_32x32x16_bf16 v[128:143], v[176:179], v[32:35], 0
    v_sub_f32 v144, v144, v227
    v_sub_f32 v145, v145, v227
    v_sub_f32 v146, v146, v227
    v_sub_f32 v147, v147, v227
    v_exp_f32 v144, v144
    v_exp_f32 v145, v145
    v_exp_f32 v146, v146
    v_exp_f32 v147, v147
    v_cvt_pk_bf16_f32 v168, v144, v145
    v_cvt_pk_bf16_f32 v169, v146, v147
    v_mfma_f32_32x32x16_bf16 v[128:143], v[180:183], v[36:39], v[128:143]
    v_sub_f32 v148, v148, v227
    v_sub_f32 v149, v149, v227
    v_sub_f32 v150, v150, v227
    v_sub_f32 v151, v151, v227
    v_exp_f32 v148, v148
    v_exp_f32 v149, v149
    v_exp_f32 v150, v150
    v_exp_f32 v151, v151
    v_cvt_pk_bf16_f32 v170, v148, v149
    v_cvt_pk_bf16_f32 v171, v150, v151
    v_mfma_f32_32x32x16_bf16 v[96:111], v[216:219], v[160:163], v[96:111]
    v_sub_f32 v152, v152, v227
    v_sub_f32 v153, v153, v227
    v_sub_f32 v154, v154, v227
    v_sub_f32 v155, v155, v227
    v_exp_f32 v152, v152
    v_exp_f32 v153, v153
    v_exp_f32 v154, v154
    v_exp_f32 v155, v155
    v_cvt_pk_bf16_f32 v172, v152, v153
    v_cvt_pk_bf16_f32 v173, v154, v155
    v_mfma_f32_32x32x16_bf16 v[96:111], v[220:223], v[164:167], v[96:111]
    v_sub_f32 v156, v156, v227
    v_sub_f32 v157, v157, v227
    v_sub_f32 v158, v158, v227
    v_sub_f32 v159, v159, v227
    v_exp_f32 v156, v156
    v_exp_f32 v157, v157
    v_exp_f32 v158, v158
    v_exp_f32 v159, v159
    v_cvt_pk_bf16_f32 v174, v156, v157
    v_cvt_pk_bf16_f32 v175, v158, v159
    v_mfma_f32_32x32x16_bf16 v[144:159], v[176:179], v[40:43], 0
    v_sub_f32 v128, v128, v224
    v_sub_f32 v129, v129, v224
    v_sub_f32 v130, v130, v224
    v_sub_f32 v131, v131, v224
    v_exp_f32 v128, v128
    v_exp_f32 v129, v129
    v_exp_f32 v130, v130
    v_exp_f32 v131, v131
    v_cvt_pk_bf16_f32 v160, v128, v129
    v_cvt_pk_bf16_f32 v161, v130, v131
    v_mfma_f32_32x32x16_bf16 v[144:159], v[180:183], v[44:47], v[144:159]
    v_sub_f32 v132, v132, v224
    v_sub_f32 v133, v133, v224
    v_sub_f32 v134, v134, v224
    v_sub_f32 v135, v135, v224
    v_exp_f32 v132, v132
    v_exp_f32 v133, v133
    v_exp_f32 v134, v134
    v_exp_f32 v135, v135
    v_cvt_pk_bf16_f32 v162, v132, v133
    v_cvt_pk_bf16_f32 v163, v134, v135
    v_mfma_f32_32x32x16_bf16 v[112:127], v[216:219], v[168:171], v[112:127]
    v_sub_f32 v136, v136, v224
    v_sub_f32 v137, v137, v224
    v_sub_f32 v138, v138, v224
    v_sub_f32 v139, v139, v224
    v_exp_f32 v136, v136
    v_exp_f32 v137, v137
    v_exp_f32 v138, v138
    v_exp_f32 v139, v139
    v_cvt_pk_bf16_f32 v164, v136, v137
    v_cvt_pk_bf16_f32 v165, v138, v139
    v_mfma_f32_32x32x16_bf16 v[112:127], v[220:223], v[172:175], v[112:127]
    v_sub_f32 v140, v140, v224
    v_sub_f32 v141, v141, v224
    v_sub_f32 v142, v142, v224
    v_sub_f32 v143, v143, v224
    v_exp_f32 v140, v140
    v_exp_f32 v141, v141
    v_exp_f32 v142, v142
    v_exp_f32 v143, v143
    v_cvt_pk_bf16_f32 v166, v140, v141
    v_cvt_pk_bf16_f32 v167, v142, v143
    v_mfma_f32_32x32x16_bf16 v[128:143], v[176:179], v[48:51], 0
    v_sub_f32 v144, v144, v225
    v_sub_f32 v145, v145, v225
    v_sub_f32 v146, v146, v225
    v_sub_f32 v147, v147, v225
    v_exp_f32 v144, v144
    v_exp_f32 v145, v145
    v_exp_f32 v146, v146
    v_exp_f32 v147, v147
    v_cvt_pk_bf16_f32 v168, v144, v145
    v_cvt_pk_bf16_f32 v169, v146, v147
    v_mfma_f32_32x32x16_bf16 v[128:143], v[180:183], v[52:55], v[128:143]
    v_sub_f32 v148, v148, v225
    v_sub_f32 v149, v149, v225
    v_sub_f32 v150, v150, v225
    v_sub_f32 v151, v151, v225
    v_exp_f32 v148, v148
    v_exp_f32 v149, v149
    v_exp_f32 v150, v150
    v_exp_f32 v151, v151
    v_cvt_pk_bf16_f32 v170, v148, v149
    v_cvt_pk_bf16_f32 v171, v150, v151
    v_mfma_f32_32x32x16_bf16 v[64:79], v[184:187], v[160:163], v[64:79]
    v_sub_f32 v152, v152, v225
    v_sub_f32 v153, v153, v225
    v_sub_f32 v154, v154, v225
    v_sub_f32 v155, v155, v225
    v_exp_f32 v152, v152
    v_exp_f32 v153, v153
    v_exp_f32 v154, v154
    v_exp_f32 v155, v155
    v_cvt_pk_bf16_f32 v172, v152, v153
    v_cvt_pk_bf16_f32 v173, v154, v155
    v_mfma_f32_32x32x16_bf16 v[64:79], v[188:191], v[164:167], v[64:79]
    v_sub_f32 v156, v156, v225
    v_sub_f32 v157, v157, v225
    v_sub_f32 v158, v158, v225
    v_sub_f32 v159, v159, v225
    v_exp_f32 v156, v156
    v_exp_f32 v157, v157
    v_exp_f32 v158, v158
    v_exp_f32 v159, v159
    v_cvt_pk_bf16_f32 v174, v156, v157
    v_cvt_pk_bf16_f32 v175, v158, v159
    v_mfma_f32_32x32x16_bf16 v[144:159], v[176:179], v[56:59], 0
    v_sub_f32 v128, v128, v226
    v_sub_f32 v129, v129, v226
    v_sub_f32 v130, v130, v226
    v_sub_f32 v131, v131, v226
    v_exp_f32 v128, v128
    v_exp_f32 v129, v129
    v_exp_f32 v130, v130
    v_exp_f32 v131, v131
    v_cvt_pk_bf16_f32 v160, v128, v129
    v_cvt_pk_bf16_f32 v161, v130, v131
    v_mfma_f32_32x32x16_bf16 v[144:159], v[180:183], v[60:63], v[144:159]
    v_sub_f32 v132, v132, v226
    v_sub_f32 v133, v133, v226
    v_sub_f32 v134, v134, v226
    v_sub_f32 v135, v135, v226
    v_exp_f32 v132, v132
    v_exp_f32 v133, v133
    v_exp_f32 v134, v134
    v_exp_f32 v135, v135
    v_cvt_pk_bf16_f32 v162, v132, v133
    v_cvt_pk_bf16_f32 v163, v134, v135
    v_mfma_f32_32x32x16_bf16 v[80:95], v[184:187], v[168:171], v[80:95]
    v_sub_f32 v136, v136, v226
    v_sub_f32 v137, v137, v226
    v_sub_f32 v138, v138, v226
    v_sub_f32 v139, v139, v226
    v_exp_f32 v136, v136
    v_exp_f32 v137, v137
    v_exp_f32 v138, v138
    v_exp_f32 v139, v139
    v_cvt_pk_bf16_f32 v164, v136, v137
    v_cvt_pk_bf16_f32 v165, v138, v139
    v_mfma_f32_32x32x16_bf16 v[80:95], v[188:191], v[172:175], v[80:95]
    v_sub_f32 v140, v140, v226
    v_sub_f32 v141, v141, v226
    v_sub_f32 v142, v142, v226
    v_sub_f32 v143, v143, v226
    v_exp_f32 v140, v140
    v_exp_f32 v141, v141
    v_exp_f32 v142, v142
    v_exp_f32 v143, v143
    v_cvt_pk_bf16_f32 v166, v140, v141
    v_cvt_pk_bf16_f32 v167, v142, v143
    s_waitcnt vmcnt(0)
    v_mfma_f32_32x32x16_bf16 v[128:143], v[192:195], v[32:35], 0
    v_sub_f32 v144, v144, v227
    v_sub_f32 v145, v145, v227
    v_sub_f32 v146, v146, v227
    v_sub_f32 v147, v147, v227
    v_exp_f32 v144, v144
    v_exp_f32 v145, v145
    v_exp_f32 v146, v146
    v_exp_f32 v147, v147
    v_cvt_pk_bf16_f32 v168, v144, v145
    v_cvt_pk_bf16_f32 v169, v146, v147
    v_mfma_f32_32x32x16_bf16 v[128:143], v[196:199], v[36:39], v[128:143]
    v_sub_f32 v148, v148, v227
    v_sub_f32 v149, v149, v227
    v_sub_f32 v150, v150, v227
    v_sub_f32 v151, v151, v227
    v_exp_f32 v148, v148
    v_exp_f32 v149, v149
    v_exp_f32 v150, v150
    v_exp_f32 v151, v151
    v_cvt_pk_bf16_f32 v170, v148, v149
    v_cvt_pk_bf16_f32 v171, v150, v151
    v_mfma_f32_32x32x16_bf16 v[96:111], v[184:187], v[160:163], v[96:111]
    v_sub_f32 v152, v152, v227
    v_sub_f32 v153, v153, v227
    v_sub_f32 v154, v154, v227
    v_sub_f32 v155, v155, v227
    v_exp_f32 v152, v152
    v_exp_f32 v153, v153
    v_exp_f32 v154, v154
    v_exp_f32 v155, v155
    v_cvt_pk_bf16_f32 v172, v152, v153
    v_cvt_pk_bf16_f32 v173, v154, v155
    v_mfma_f32_32x32x16_bf16 v[96:111], v[188:191], v[164:167], v[96:111]
    v_sub_f32 v156, v156, v227
    v_sub_f32 v157, v157, v227
    v_sub_f32 v158, v158, v227
    v_sub_f32 v159, v159, v227
    v_exp_f32 v156, v156
    v_exp_f32 v157, v157
    v_exp_f32 v158, v158
    v_exp_f32 v159, v159
    v_cvt_pk_bf16_f32 v174, v156, v157
    v_cvt_pk_bf16_f32 v175, v158, v159
    v_mfma_f32_32x32x16_bf16 v[144:159], v[192:195], v[40:43], 0
    v_sub_f32 v128, v128, v224
    v_sub_f32 v129, v129, v224
    v_sub_f32 v130, v130, v224
    v_sub_f32 v131, v131, v224
    v_exp_f32 v128, v128
    v_exp_f32 v129, v129
    v_exp_f32 v130, v130
    v_exp_f32 v131, v131
    v_cvt_pk_bf16_f32 v160, v128, v129
    v_cvt_pk_bf16_f32 v161, v130, v131
    v_mfma_f32_32x32x16_bf16 v[144:159], v[196:199], v[44:47], v[144:159]
    v_sub_f32 v132, v132, v224
    v_sub_f32 v133, v133, v224
    v_sub_f32 v134, v134, v224
    v_sub_f32 v135, v135, v224
    v_exp_f32 v132, v132
    v_exp_f32 v133, v133
    v_exp_f32 v134, v134
    v_exp_f32 v135, v135
    v_cvt_pk_bf16_f32 v162, v132, v133
    v_cvt_pk_bf16_f32 v163, v134, v135
    v_mfma_f32_32x32x16_bf16 v[112:127], v[184:187], v[168:171], v[112:127]
    v_sub_f32 v136, v136, v224
    v_sub_f32 v137, v137, v224
    v_sub_f32 v138, v138, v224
    v_sub_f32 v139, v139, v224
    v_exp_f32 v136, v136
    v_exp_f32 v137, v137
    v_exp_f32 v138, v138
    v_exp_f32 v139, v139
    v_cvt_pk_bf16_f32 v164, v136, v137
    v_cvt_pk_bf16_f32 v165, v138, v139
    v_mfma_f32_32x32x16_bf16 v[112:127], v[188:191], v[172:175], v[112:127]
    v_sub_f32 v140, v140, v224
    v_sub_f32 v141, v141, v224
    v_sub_f32 v142, v142, v224
    v_sub_f32 v143, v143, v224
    v_exp_f32 v140, v140
    v_exp_f32 v141, v141
    v_exp_f32 v142, v142
    v_exp_f32 v143, v143
    v_cvt_pk_bf16_f32 v166, v140, v141
    v_cvt_pk_bf16_f32 v167, v142, v143
    v_mfma_f32_32x32x16_bf16 v[128:143], v[192:195], v[48:51], 0
    v_sub_f32 v144, v144, v225
    v_sub_f32 v145, v145, v225
    v_sub_f32 v146, v146, v225
    v_sub_f32 v147, v147, v225
    v_exp_f32 v144, v144
    v_exp_f32 v145, v145
    v_exp_f32 v146, v146
    v_exp_f32 v147, v147
    v_cvt_pk_bf16_f32 v168, v144, v145
    v_cvt_pk_bf16_f32 v169, v146, v147
    v_mfma_f32_32x32x16_bf16 v[128:143], v[196:199], v[52:55], v[128:143]
    v_sub_f32 v148, v148, v225
    v_sub_f32 v149, v149, v225
    v_sub_f32 v150, v150, v225
    v_sub_f32 v151, v151, v225
    v_exp_f32 v148, v148
    v_exp_f32 v149, v149
    v_exp_f32 v150, v150
    v_exp_f32 v151, v151
    v_cvt_pk_bf16_f32 v170, v148, v149
    v_cvt_pk_bf16_f32 v171, v150, v151
    v_mfma_f32_32x32x16_bf16 v[64:79], v[200:203], v[160:163], v[64:79]
    v_sub_f32 v152, v152, v225
    v_sub_f32 v153, v153, v225
    v_sub_f32 v154, v154, v225
    v_sub_f32 v155, v155, v225
    v_exp_f32 v152, v152
    v_exp_f32 v153, v153
    v_exp_f32 v154, v154
    v_exp_f32 v155, v155
    v_cvt_pk_bf16_f32 v172, v152, v153
    v_cvt_pk_bf16_f32 v173, v154, v155
    v_mfma_f32_32x32x16_bf16 v[64:79], v[204:207], v[164:167], v[64:79]
    v_sub_f32 v156, v156, v225
    v_sub_f32 v157, v157, v225
    v_sub_f32 v158, v158, v225
    v_sub_f32 v159, v159, v225
    v_exp_f32 v156, v156
    v_exp_f32 v157, v157
    v_exp_f32 v158, v158
    v_exp_f32 v159, v159
    v_cvt_pk_bf16_f32 v174, v156, v157
    v_cvt_pk_bf16_f32 v175, v158, v159
    v_mfma_f32_32x32x16_bf16 v[144:159], v[192:195], v[56:59], 0
    v_sub_f32 v128, v128, v226
    v_sub_f32 v129, v129, v226
    v_sub_f32 v130, v130, v226
    v_sub_f32 v131, v131, v226
    v_exp_f32 v128, v128
    v_exp_f32 v129, v129
    v_exp_f32 v130, v130
    v_exp_f32 v131, v131
    v_cvt_pk_bf16_f32 v160, v128, v129
    v_cvt_pk_bf16_f32 v161, v130, v131
    v_mfma_f32_32x32x16_bf16 v[144:159], v[196:199], v[60:63], v[144:159]
    v_sub_f32 v132, v132, v226
    v_sub_f32 v133, v133, v226
    v_sub_f32 v134, v134, v226
    v_sub_f32 v135, v135, v226
    v_exp_f32 v132, v132
    v_exp_f32 v133, v133
    v_exp_f32 v134, v134
    v_exp_f32 v135, v135
    v_cvt_pk_bf16_f32 v162, v132, v133
    v_cvt_pk_bf16_f32 v163, v134, v135
    v_mfma_f32_32x32x16_bf16 v[80:95], v[200:203], v[168:171], v[80:95]
    v_sub_f32 v136, v136, v226
    v_sub_f32 v137, v137, v226
    v_sub_f32 v138, v138, v226
    v_sub_f32 v139, v139, v226
    v_exp_f32 v136, v136
    v_exp_f32 v137, v137
    v_exp_f32 v138, v138
    v_exp_f32 v139, v139
    v_cvt_pk_bf16_f32 v164, v136, v137
    v_cvt_pk_bf16_f32 v165, v138, v139
    v_mfma_f32_32x32x16_bf16 v[80:95], v[204:207], v[172:175], v[80:95]
    v_sub_f32 v140, v140, v226
    v_sub_f32 v141, v141, v226
    v_sub_f32 v142, v142, v226
    v_sub_f32 v143, v143, v226
    v_exp_f32 v140, v140
    v_exp_f32 v141, v141
    v_exp_f32 v142, v142
    v_exp_f32 v143, v143
    v_cvt_pk_bf16_f32 v166, v140, v141
    v_cvt_pk_bf16_f32 v167, v142, v143
    v_sub_f32 v144, v144, v227
    v_sub_f32 v145, v145, v227
    v_sub_f32 v146, v146, v227
    v_sub_f32 v147, v147, v227
    v_exp_f32 v144, v144
    v_exp_f32 v145, v145
    v_exp_f32 v146, v146
    v_exp_f32 v147, v147
    v_cvt_pk_bf16_f32 v168, v144, v145
    v_cvt_pk_bf16_f32 v169, v146, v147
    v_sub_f32 v148, v148, v227
    v_sub_f32 v149, v149, v227
    v_sub_f32 v150, v150, v227
    v_sub_f32 v151, v151, v227
    v_exp_f32 v148, v148
    v_exp_f32 v149, v149
    v_exp_f32 v150, v150
    v_exp_f32 v151, v151
    v_cvt_pk_bf16_f32 v170, v148, v149
    v_cvt_pk_bf16_f32 v171, v150, v151
    v_mfma_f32_32x32x16_bf16 v[96:111], v[200:203], v[160:163], v[96:111]
    v_sub_f32 v152, v152, v227
    v_sub_f32 v153, v153, v227
    v_sub_f32 v154, v154, v227
    v_sub_f32 v155, v155, v227
    v_exp_f32 v152, v152
    v_exp_f32 v153, v153
    v_exp_f32 v154, v154
    v_exp_f32 v155, v155
    v_cvt_pk_bf16_f32 v172, v152, v153
    v_cvt_pk_bf16_f32 v173, v154, v155
    v_mfma_f32_32x32x16_bf16 v[96:111], v[204:207], v[164:167], v[96:111]
    v_sub_f32 v156, v156, v227
    v_sub_f32 v157, v157, v227
    v_sub_f32 v158, v158, v227
    v_sub_f32 v159, v159, v227
    v_exp_f32 v156, v156
    v_exp_f32 v157, v157
    v_exp_f32 v158, v158
    v_exp_f32 v159, v159
    v_cvt_pk_bf16_f32 v174, v156, v157
    v_cvt_pk_bf16_f32 v175, v158, v159
    s_nop 1
    v_mfma_f32_32x32x16_bf16 v[112:127], v[200:203], v[168:171], v[112:127]
    v_mfma_f32_32x32x16_bf16 v[112:127], v[204:207], v[172:175], v[112:127]
    s_branch attn_kernel_reduce
attn_kernel_adone:
    s_waitcnt vmcnt(0)
    s_barrier
    s_cmp_lg_u32 s24, 0
    s_cbranch_scc1 attn_kernel_asig
    s_lshl_b32 s29, s26, 7
    s_add_u32 s29, s29, 19927040
    v_mov_b32 v2, s29
    v_mov_b32 v3, 1
    s_mov_b64 exec, 1
    global_atomic_add v2, v3, s[34:35]
    s_mov_b64 exec, -1
attn_kernel_asig:
    s_cmp_ge_u32 s2, 224
    s_cbranch_scc1 attn_kernel_end
    s_load_dwordx2 s[32:33], s[0:1], 16
    s_load_dwordx2 s[36:37], s[0:1], 0
    s_load_dwordx2 s[38:39], s[0:1], 56
    s_load_dwordx2 s[40:41], s[0:1], 64
    s_load_dwordx2 s[58:59], s[0:1], 32
    s_load_dwordx2 s[84:85], s[0:1], 48
    s_and_b32 s27, s2, 7
    s_lshr_b32 s28, s2, 3
    s_and_b32 s29, s28, 1
    s_lshl_b32 s90, s27, 1
    s_add_u32 s90, s90, s29
    s_lshr_b32 s91, s28, 1
    s_and_b32 s29, s91, 1
    s_lshl_b32 s92, s90, 1
    s_add_u32 s92, s92, s29
    s_lshr_b32 s93, s91, 1
    s_mov_b32 s25, s92
    s_mov_b32 s26, s93
    s_waitcnt lgkmcnt(0)
    v_mov_b32 v2, 136192
    v_mov_b32 v3, 0
    ds_write_b32 v2, v3
    ds_write_b32 v2, v3 offset:4
    v_lshrrev_b32 v2, 3, v0
    v_and_b32 v3, 7, v0
    v_bfe_u32 v4, v0, 4, 1
    v_lshlrev_b32 v4, 2, v4
    v_xor_b32 v3, v3, v4
    v_mul_u32_u24 v2, 896, v2
    v_lshl_add_u32 v10, v3, 4, v2
    v_lshlrev_b32 v11, 4, v0
    s_mul_i32 s42, s24, 25088
    s_lshl_b32 s30, s26, 7
    s_add_u32 s42, s42, s30
    s_mul_i32 s43, s25, 65536
    s_lshl_b32 s30, s24, 11
    s_add_u32 s43, s43, s30
    s_lshl_b32 s44, s24, 14
    s_mov_b32 s4, s32
    s_mov_b32 s5, s33
    s_mov_b32 s6, 401408
    s_mov_b32 s7, 0x00020000
    s_add_u32 s8, s34, 6291456
    s_addc_u32 s9, s35, 0
    s_mov_b32 s10, 2097152
    s_mov_b32 s11, 0x00020000
    s_add_u32 m0, s44, 0
    s_add_u32 s30, s42, 0
    buffer_load_dwordx4 v10, s[4:7], s30 offen lds
    s_add_u32 m0, s44, 1024
    s_add_u32 s30, s42, 7168
    buffer_load_dwordx4 v10, s[4:7], s30 offen lds
    s_add_u32 m0, s44, 2048
    s_add_u32 s30, s42, 14336
    buffer_load_dwordx4 v10, s[4:7], s30 offen lds
    s_add_u32 m0, s44, 3072
    s_add_u32 s30, s42, 21504
    buffer_load_dwordx4 v10, s[4:7], s30 offen lds
    s_add_u32 m0, s44, 4096
    s_add_u32 s30, s42, 200704
    buffer_load_dwordx4 v10, s[4:7], s30 offen lds
    s_add_u32 m0, s44, 5120
    s_add_u32 s30, s42, 207872
    buffer_load_dwordx4 v10, s[4:7], s30 offen lds
    s_add_u32 m0, s44, 6144
    s_add_u32 s30, s42, 215040
    buffer_load_dwordx4 v10, s[4:7], s30 offen lds
    s_add_u32 m0, s44, 7168
    s_add_u32 s30, s42, 222208
    buffer_load_dwordx4 v10, s[4:7], s30 offen lds
    v_lshrrev_b32 v12, 5, v0
    v_and_b32 v15, 31, v0
    s_lshr_b32 s48, s24, 2
    s_bfe_u32 s50, s24, 0x10001
    s_and_b32 s53, s24, 1
    s_lshl_b32 s29, s25, 1
    s_add_u32 s51, s29, s50
    s_lshl_b32 s29, s26, 1
    s_add_u32 s49, s29, s48
    s_lshl_b32 s29, s51, 5
    v_add_u32 v16, s29, v15
    v_mul_u32_u24 v16, 896, v16
    v_lshl_add_u32 v16, v12, 3, v16
    s_lshl_b32 s52, s49, 6
    s_lshl_b32 s29, s53, 5
    s_add_u32 s52, s52, s29
    s_mul_i32 s29, s51, 28
    s_lshl_b32 s30, s49, 1
    s_add_u32 s29, s29, s30
    s_add_u32 s29, s29, s53
    s_lshl_b32 s55, s29, 10
    s_add_u32 s12, s34, 8388608
    s_addc_u32 s13, s35, 0
    s_mov_b32 s14, 1835008
    s_mov_b32 s15, 0x00020000
    s_mov_b32 s20, s36
    s_mov_b32 s21, s37
    s_mov_b32 s22, 1835008
    s_mov_b32 s23, 0x00020000
    s_add_u32 s16, s34, 17825792
    s_addc_u32 s17, s35, 0
    s_mov_b32 s18, 114688
    s_mov_b32 s19, 0x00020000
    buffer_load_dwordx2 v[208:209], v16, s[20:23], s52 offen offset:0
    buffer_load_dwordx2 v[210:211], v16, s[20:23], s52 offen offset:16
    s_waitcnt lgkmcnt(0)
    s_barrier
    s_mov_b32 s31, 0
    s_cmp_lg_u32 s24, 0
    s_cbranch_scc1 attn_kernel_oQ
    s_lshl_b32 s29, s90, 7
    s_add_u32 s29, s29, 19927040
    v_mov_b32 v2, s29
    v_mov_b32 v3, 1
    s_mov_b64 exec, 1
attn_kernel_pQ:
    global_load_dword v4, v2, s[34:35] sc1
    s_add_u32 s31, s31, 1
    s_waitcnt vmcnt(0)
    v_readfirstlane_b32 s30, v4
    s_nop 1
    s_cmp_ge_u32 s31, 0x100000
    s_cbranch_scc1 attn_kernel_qQ
    s_cmp_ge_u32 s30, 16
    s_cbranch_scc1 attn_kernel_qQ
    s_sleep 3
    s_branch attn_kernel_pQ
attn_kernel_qQ:
    s_mov_b64 exec, -1
    v_mov_b32 v2, 136192
    ds_write_b32 v2, v3 offset:4
    s_waitcnt lgkmcnt(0)
    s_branch attn_kernel_wQ
attn_kernel_oQ:
    v_mov_b32 v2, 136192
attn_kernel_lQ:
    ds_read_b32 v4, v2 offset:4
    s_add_u32 s31, s31, 1
    s_waitcnt lgkmcnt(0)
    v_readfirstlane_b32 s30, v4
    s_nop 1
    s_cmp_ge_u32 s31, 0x1000000
    s_cbranch_scc1 attn_kernel_wQ
    s_cmp_eq_u32 s30, 1
    s_cbranch_scc1 attn_kernel_wQ
    s_sleep 1
    s_branch attn_kernel_lQ
attn_kernel_wQ:
    v_lshlrev_b32 v11, 4, v0
    s_add_u32 s30, s43, 0
    buffer_load_dwordx4 v[128:131], v11, s[8:11], s30 offen sc1
    s_add_u32 s30, s43, 32768
    buffer_load_dwordx4 v[132:135], v11, s[8:11], s30 offen sc1
    s_add_u32 s30, s43, 1024
    buffer_load_dwordx4 v[136:139], v11, s[8:11], s30 offen sc1
    s_add_u32 s30, s43, 33792
    buffer_load_dwordx4 v[140:143], v11, s[8:11], s30 offen sc1
    s_add_u32 s30, s43, 16384
    buffer_load_dwordx4 v[144:147], v11, s[8:11], s30 offen sc1
    s_add_u32 s30, s43, 49152
    buffer_load_dwordx4 v[148:151], v11, s[8:11], s30 offen sc1
    s_add_u32 s30, s43, 17408
    buffer_load_dwordx4 v[152:155], v11, s[8:11], s30 offen sc1
    s_add_u32 s30, s43, 50176
    buffer_load_dwordx4 v[156:159], v11, s[8:11], s30 offen sc1
    v_bfe_u32 v13, v0, 2, 2
    v_and_b32 v14, 3, v0
    v_bfe_u32 v18, v0, 4, 1
    v_lshl_add_u32 v19, v12, 2, v13
    v_lshlrev_b32 v19, 7, v19
    v_add_u32 v19, s44, v19
    v_and_b32 v20, 1, v14
    v_lshl_add_u32 v19, v20, 3, v19
    v_lshrrev_b32 v20, 1, v14
    v_lshl_add_u32 v20, v18, 1, v20
    v_lshrrev_b32 v21, 1, v13
    v_lshlrev_b32 v21, 2, v21
    v_xor_b32 v22, v20, v21
    v_lshl_add_u32 v2, v22, 4, v19
    v_add_u32 v20, 4, v20
    v_xor_b32 v22, v20, v21
    v_lshl_add_u32 v4, v22, 4, v19
    s_waitcnt vmcnt(4)
    ds_read_b64_tr_b16 v[192:193], v2 offset:0
    ds_read_b64_tr_b16 v[194:195], v2 offset:1024
    ds_read_b64_tr_b16 v[196:197], v4 offset:0
    ds_read_b64_tr_b16 v[198:199], v4 offset:1024
    ds_read_b64_tr_b16 v[200:201], v2 offset:2048
    ds_read_b64_tr_b16 v[202:203], v2 offset:3072
    ds_read_b64_tr_b16 v[204:205], v4 offset:2048
    ds_read_b64_tr_b16 v[206:207], v4 offset:3072
    s_waitcnt lgkmcnt(4)
    v_mfma_f32_32x32x16_bf16 v[64:79], v[192:195], v[128:131], 0
    v_mfma_f32_32x32x16_bf16 v[80:95], v[192:195], v[132:135], 0
    v_mfma_f32_32x32x16_bf16 v[96:111], v[196:199], v[128:131], 0
    v_mfma_f32_32x32x16_bf16 v[112:127], v[196:199], v[132:135], 0
    s_waitcnt lgkmcnt(0)
    v_mfma_f32_32x32x16_bf16 v[64:79], v[200:203], v[136:139], v[64:79]
    v_mfma_f32_32x32x16_bf16 v[80:95], v[200:203], v[140:143], v[80:95]
    v_mfma_f32_32x32x16_bf16 v[96:111], v[204:207], v[136:139], v[96:111]
    v_mfma_f32_32x32x16_bf16 v[112:127], v[204:207], v[140:143], v[112:127]
    s_waitcnt vmcnt(0)
    ds_read_b64_tr_b16 v[192:193], v2 offset:4096
    ds_read_b64_tr_b16 v[194:195], v2 offset:5120
    ds_read_b64_tr_b16 v[196:197], v4 offset:4096
    ds_read_b64_tr_b16 v[198:199], v4 offset:5120
    ds_read_b64_tr_b16 v[200:201], v2 offset:6144
    ds_read_b64_tr_b16 v[202:203], v2 offset:7168
    ds_read_b64_tr_b16 v[204:205], v4 offset:6144
    ds_read_b64_tr_b16 v[206:207], v4 offset:7168
    s_waitcnt lgkmcnt(4)
    v_mfma_f32_32x32x16_bf16 v[64:79], v[192:195], v[144:147], v[64:79]
    v_mfma_f32_32x32x16_bf16 v[80:95], v[192:195], v[148:151], v[80:95]
    v_mfma_f32_32x32x16_bf16 v[96:111], v[196:199], v[144:147], v[96:111]
    v_mfma_f32_32x32x16_bf16 v[112:127], v[196:199], v[148:151], v[112:127]
    s_waitcnt lgkmcnt(0)
    v_mfma_f32_32x32x16_bf16 v[64:79], v[200:203], v[152:155], v[64:79]
    v_mfma_f32_32x32x16_bf16 v[80:95], v[200:203], v[156:159], v[80:95]
    v_mfma_f32_32x32x16_bf16 v[96:111], v[204:207], v[152:155], v[96:111]
    v_mfma_f32_32x32x16_bf16 v[112:127], v[204:207], v[156:159], v[112:127]
    v_add_u32 v17, s44, v11
    s_nop 7
    ds_write_b128 v17, v[64:67] offset:0
    ds_write_b128 v17, v[68:71] offset:1024
    ds_write_b128 v17, v[72:75] offset:2048
    ds_write_b128 v17, v[76:79] offset:3072
    ds_write_b128 v17, v[80:83] offset:4096
    ds_write_b128 v17, v[84:87] offset:5120
    ds_write_b128 v17, v[88:91] offset:6144
    ds_write_b128 v17, v[92:95] offset:7168
    ds_write_b128 v17, v[96:99] offset:8192
    ds_write_b128 v17, v[100:103] offset:9216
    ds_write_b128 v17, v[104:107] offset:10240
    ds_write_b128 v17, v[108:111] offset:11264
    ds_write_b128 v17, v[112:115] offset:12288
    ds_write_b128 v17, v[116:119] offset:13312
    ds_write_b128 v17, v[120:123] offset:14336
    ds_write_b128 v17, v[124:127] offset:15360
    s_waitcnt lgkmcnt(0)
    s_barrier
    s_lshl_b32 s29, s24, 11
    v_add_u32 v17, s29, v11
    v_add_u32 v18, 0x10000, v17
    ds_read_b128 v[64:67], v17 offset:0
    ds_read_b128 v[68:71], v17 offset:1024
    ds_read_b128 v[72:75], v17 offset:16384
    ds_read_b128 v[76:79], v17 offset:17408
    ds_read_b128 v[80:83], v17 offset:32768
    ds_read_b128 v[84:87], v17 offset:33792
    ds_read_b128 v[88:91], v17 offset:49152
    ds_read_b128 v[92:95], v17 offset:50176
    ds_read_b128 v[96:99], v18 offset:0
    ds_read_b128 v[100:103], v18 offset:1024
    ds_read_b128 v[104:107], v18 offset:16384
    ds_read_b128 v[108:111], v18 offset:17408
    ds_read_b128 v[112:115], v18 offset:32768
    ds_read_b128 v[116:119], v18 offset:33792
    ds_read_b128 v[120:123], v18 offset:49152
    ds_read_b128 v[124:127], v18 offset:50176
    s_waitcnt vmcnt(0)
    v_and_b32 v225, 0xffff0000, v208
    v_lshlrev_b32 v224, 16, v208
    v_and_b32 v227, 0xffff0000, v209
    v_lshlrev_b32 v226, 16, v209
    v_and_b32 v229, 0xffff0000, v210
    v_lshlrev_b32 v228, 16, v210
    v_and_b32 v231, 0xffff0000, v211
    v_lshlrev_b32 v230, 16, v211
    s_waitcnt lgkmcnt(0)
    v_pk_add_f32 v[64:65], v[64:65], v[96:97]
    v_pk_add_f32 v[66:67], v[66:67], v[98:99]
    v_pk_add_f32 v[68:69], v[68:69], v[100:101]
    v_pk_add_f32 v[70:71], v[70:71], v[102:103]
    v_pk_add_f32 v[72:73], v[72:73], v[104:105]
    v_pk_add_f32 v[74:75], v[74:75], v[106:107]
    v_pk_add_f32 v[76:77], v[76:77], v[108:109]
    v_pk_add_f32 v[78:79], v[78:79], v[110:111]
    v_pk_add_f32 v[80:81], v[80:81], v[112:113]
    v_pk_add_f32 v[82:83], v[82:83], v[114:115]
    v_pk_add_f32 v[84:85], v[84:85], v[116:117]
    v_pk_add_f32 v[86:87], v[86:87], v[118:119]
    v_pk_add_f32 v[88:89], v[88:89], v[120:121]
    v_pk_add_f32 v[90:91], v[90:91], v[122:123]
    v_pk_add_f32 v[92:93], v[92:93], v[124:125]
    v_pk_add_f32 v[94:95], v[94:95], v[126:127]
    v_pk_add_f32 v[64:65], v[64:65], v[80:81]
    v_pk_add_f32 v[66:67], v[66:67], v[82:83]
    v_pk_add_f32 v[68:69], v[68:69], v[84:85]
    v_pk_add_f32 v[70:71], v[70:71], v[86:87]
    v_pk_add_f32 v[72:73], v[72:73], v[88:89]
    v_pk_add_f32 v[74:75], v[74:75], v[90:91]
    v_pk_add_f32 v[76:77], v[76:77], v[92:93]
    v_pk_add_f32 v[78:79], v[78:79], v[94:95]
    v_pk_add_f32 v[64:65], v[64:65], v[72:73]
    v_pk_add_f32 v[66:67], v[66:67], v[74:75]
    v_pk_add_f32 v[68:69], v[68:69], v[76:77]
    v_pk_add_f32 v[70:71], v[70:71], v[78:79]
    v_pk_add_f32 v[64:65], v[64:65], v[224:225]
    v_pk_add_f32 v[66:67], v[66:67], v[226:227]
    v_pk_add_f32 v[68:69], v[68:69], v[228:229]
    v_pk_add_f32 v[70:71], v[70:71], v[230:231]
    v_cvt_pk_bf16_f32 v240, v64, v65
    v_cvt_pk_bf16_f32 v241, v66, v67
    v_cvt_pk_bf16_f32 v242, v68, v69
    v_cvt_pk_bf16_f32 v243, v70, v71
    buffer_store_dwordx4 v[240:243], v11, s[12:15], s55 offen sc1
    v_mov_b32 v26, v240
    v_mov_b32 v27, v241
    v_mov_b32 v28, v242
    v_mov_b32 v29, v243
    v_and_b32 v65, 0xffff0000, v240
    v_lshlrev_b32 v64, 16, v240
    v_and_b32 v67, 0xffff0000, v241
    v_lshlrev_b32 v66, 16, v241
    v_and_b32 v69, 0xffff0000, v242
    v_lshlrev_b32 v68, 16, v242
    v_and_b32 v71, 0xffff0000, v243
    v_lshlrev_b32 v70, 16, v243
    v_add_f32 v224, v64, v65
    v_mul_f32 v225, v64, v64
    v_fmac_f32 v225, v65, v65
    v_add_f32 v224, v224, v66
    v_fmac_f32 v225, v66, v66
    v_add_f32 v224, v224, v67
    v_fmac_f32 v225, v67, v67
    v_add_f32 v224, v224, v68
    v_fmac_f32 v225, v68, v68
    v_add_f32 v224, v224, v69
    v_fmac_f32 v225, v69, v69
    v_add_f32 v224, v224, v70
    v_fmac_f32 v225, v70, v70
    v_add_f32 v224, v224, v71
    v_fmac_f32 v225, v71, v71
    s_lshl_b32 s29, s24, 9
    s_add_u32 s29, s29, 131072
    v_lshlrev_b32 v3, 3, v0
    v_add_u32 v3, s29, v3
    ds_write_b64 v3, v[224:225]
    s_waitcnt lgkmcnt(0)
    s_barrier
    s_cmp_ge_u32 s24, 4
    s_cbranch_scc1 attn_kernel_ldA
    s_cmp_lg_u32 s24, 0
    s_cbranch_scc1 attn_kernel_done
    v_lshlrev_b32 v3, 3, v15
    v_lshl_add_u32 v3, v12, 10, v3
    v_add_u32 v3, 131072, v3
    ds_read_b64 v[64:65], v3 offset:0
    ds_read_b64 v[66:67], v3 offset:256
    ds_read_b64 v[68:69], v3 offset:512
    ds_read_b64 v[70:71], v3 offset:768
    ds_read_b64 v[72:73], v3 offset:2048
    ds_read_b64 v[74:75], v3 offset:2304
    ds_read_b64 v[76:77], v3 offset:2560
    ds_read_b64 v[78:79], v3 offset:2816
    s_waitcnt lgkmcnt(0)
    v_pk_add_f32 v[64:65], v[64:65], v[66:67]
    v_pk_add_f32 v[64:65], v[64:65], v[68:69]
    v_pk_add_f32 v[64:65], v[64:65], v[70:71]
    v_pk_add_f32 v[64:65], v[64:65], v[72:73]
    v_pk_add_f32 v[64:65], v[64:65], v[74:75]
    v_pk_add_f32 v[64:65], v[64:65], v[76:77]
    v_pk_add_f32 v[64:65], v[64:65], v[78:79]
    v_mov_b32 v4, v64
    v_mov_b32 v5, v65
    s_lshl_b32 s29, s26, 11
    s_lshl_b32 s30, s25, 6
    s_add_u32 s29, s29, s30
    s_lshl_b32 s29, s29, 3
    v_lshlrev_b32 v3, 3, v0
    buffer_store_dwordx2 v[4:5], v3, s[16:19], s29 offen sc1
attn_kernel_done:
    s_waitcnt vmcnt(0)
    s_barrier
    s_mov_b32 s31, 0
    s_cmp_lg_u32 s24, 0
    s_cbranch_scc1 attn_kernel_oA
    s_lshl_b32 s29, s90, 7
    s_add_u32 s29, s29, 19922944
    v_mov_b32 v2, s29
    v_mov_b32 v3, 1
    s_mov_b64 exec, 1
    global_atomic_add v2, v3, s[34:35]
attn_kernel_pA:
    global_load_dword v4, v2, s[34:35] sc1
    s_add_u32 s31, s31, 1
    s_waitcnt vmcnt(0)
    v_readfirstlane_b32 s30, v4
    s_nop 1
    s_cmp_ge_u32 s31, 0x100000
    s_cbranch_scc1 attn_kernel_qA
    s_cmp_ge_u32 s30, 14
    s_cbranch_scc1 attn_kernel_qA
    s_sleep 3
    s_branch attn_kernel_pA
attn_kernel_qA:
    s_mov_b64 exec, -1
    v_mov_b32 v2, 136192
    ds_write_b32 v2, v3
    s_waitcnt lgkmcnt(0)
    s_branch attn_kernel_wA
attn_kernel_oA:
    v_mov_b32 v2, 136192
attn_kernel_lA:
    ds_read_b32 v4, v2
    s_add_u32 s31, s31, 1
    s_waitcnt lgkmcnt(0)
    v_readfirstlane_b32 s30, v4
    s_nop 1
    s_cmp_ge_u32 s31, 0x1000000
    s_cbranch_scc1 attn_kernel_wA
    s_cmp_eq_u32 s30, 1
    s_cbranch_scc1 attn_kernel_wA
    s_sleep 1
    s_branch attn_kernel_lA
attn_kernel_wA:
    s_branch attn_kernel_cB
attn_kernel_ldA:
    s_sub_u32 s30, s24, 4
    s_lshl_b32 s44, s30, 12
    v_lshrrev_b32 v2, 4, v0
    v_and_b32 v3, 15, v0
    v_lshlrev_b32 v4, 2, v2
    v_xor_b32 v3, v3, v4
    v_mul_u32_u24 v2, 3584, v2
    v_lshl_add_u32 v10, v3, 4, v2
    v_lshlrev_b32 v11, 2, v0
    s_mul_i32 s42, s30, 57344
    s_lshl_b32 s31, s91, 8
    s_add_u32 s42, s42, s31
    s_and_b32 s31, s30, 1
    s_lshl_b32 s31, s31, 8
    s_lshr_b32 s29, s30, 1
    s_mul_i32 s43, s29, 7168
    s_add_u32 s43, s43, s31
    s_lshl_b32 s31, s91, 9
    s_add_u32 s43, s43, s31
    s_lshl_b32 s45, s30, 8
    s_add_u32 s45, s45, 135168
    s_mov_b32 s4, s58
    s_mov_b32 s5, s59
    s_mov_b32 s6, 1605632
    s_mov_b32 s7, 0x00020000
    s_add_u32 s8, s34, 18874368
    s_addc_u32 s9, s35, 0
    s_mov_b32 s10, 14336
    s_mov_b32 s11, 0x00020000
    s_waitcnt vmcnt(0)
    s_barrier
    s_mov_b32 m0, s45
    s_nop 0
    buffer_load_dword v11, s[8:11], s43 offen lds
    s_add_u32 m0, s44, 0
    s_add_u32 s30, s42, 0
    buffer_load_dwordx4 v10, s[4:7], s30 offen lds
    s_add_u32 m0, s44, 1024
    s_add_u32 s30, s42, 14336
    buffer_load_dwordx4 v10, s[4:7], s30 offen lds
    s_add_u32 m0, s44, 2048
    s_add_u32 s30, s42, 28672
    buffer_load_dwordx4 v10, s[4:7], s30 offen lds
    s_add_u32 m0, s44, 3072
    s_add_u32 s30, s42, 43008
    buffer_load_dwordx4 v10, s[4:7], s30 offen lds
    s_add_u32 m0, s44, 16384
    s_add_u32 s30, s42, 229376
    buffer_load_dwordx4 v10, s[4:7], s30 offen lds
    s_add_u32 m0, s44, 17408
    s_add_u32 s30, s42, 243712
    buffer_load_dwordx4 v10, s[4:7], s30 offen lds
    s_add_u32 m0, s44, 18432
    s_add_u32 s30, s42, 258048
    buffer_load_dwordx4 v10, s[4:7], s30 offen lds
    s_add_u32 m0, s44, 19456
    s_add_u32 s30, s42, 272384
    buffer_load_dwordx4 v10, s[4:7], s30 offen lds
    s_add_u32 m0, s44, 32768
    s_add_u32 s30, s42, 458752
    buffer_load_dwordx4 v10, s[4:7], s30 offen lds
    s_add_u32 m0, s44, 33792
    s_add_u32 s30, s42, 473088
    buffer_load_dwordx4 v10, s[4:7], s30 offen lds
    s_add_u32 m0, s44, 34816
    s_add_u32 s30, s42, 487424
    buffer_load_dwordx4 v10, s[4:7], s30 offen lds
    s_add_u32 m0, s44, 35840
    s_add_u32 s30, s42, 501760
    buffer_load_dwordx4 v10, s[4:7], s30 offen lds
    s_waitcnt vmcnt(8)
    s_barrier
    s_add_u32 m0, s44, 49152
    s_add_u32 s30, s42, 688128
    buffer_load_dwordx4 v10, s[4:7], s30 offen lds
    s_add_u32 m0, s44, 50176
    s_add_u32 s30, s42, 702464
    buffer_load_dwordx4 v10, s[4:7], s30 offen lds
    s_add_u32 m0, s44, 51200
    s_add_u32 s30, s42, 716800
    buffer_load_dwordx4 v10, s[4:7], s30 offen lds
    s_add_u32 m0, s44, 52224
    s_add_u32 s30, s42, 731136
    buffer_load_dwordx4 v10, s[4:7], s30 offen lds
    s_add_u32 m0, s44, 65536
    s_add_u32 s30, s42, 917504
    buffer_load_dwordx4 v10, s[4:7], s30 offen lds
    s_add_u32 m0, s44, 66560
    s_add_u32 s30, s42, 931840
    buffer_load_dwordx4 v10, s[4:7], s30 offen lds
    s_add_u32 m0, s44, 67584
    s_add_u32 s30, s42, 946176
    buffer_load_dwordx4 v10, s[4:7], s30 offen lds
    s_add_u32 m0, s44, 68608
    s_add_u32 s30, s42, 960512
    buffer_load_dwordx4 v10, s[4:7], s30 offen lds
    s_waitcnt vmcnt(12)
    s_barrier
    s_add_u32 m0, s44, 81920
    s_add_u32 s30, s42, 1146880
    buffer_load_dwordx4 v10, s[4:7], s30 offen lds
    s_add_u32 m0, s44, 82944
    s_add_u32 s30, s42, 1161216
    buffer_load_dwordx4 v10, s[4:7], s30 offen lds
    s_add_u32 m0, s44, 83968
    s_add_u32 s30, s42, 1175552
    buffer_load_dwordx4 v10, s[4:7], s30 offen lds
    s_add_u32 m0, s44, 84992
    s_add_u32 s30, s42, 1189888
    buffer_load_dwordx4 v10, s[4:7], s30 offen lds
    s_waitcnt vmcnt(12)
    s_barrier
    s_add_u32 m0, s44, 98304
    s_add_u32 s30, s42, 1376256
    buffer_load_dwordx4 v10, s[4:7], s30 offen lds
    s_add_u32 m0, s44, 99328
    s_add_u32 s30, s42, 1390592
    buffer_load_dwordx4 v10, s[4:7], s30 offen lds
    s_add_u32 m0, s44, 100352
    s_add_u32 s30, s42, 1404928
    buffer_load_dwordx4 v10, s[4:7], s30 offen lds
    s_add_u32 m0, s44, 101376
    s_add_u32 s30, s42, 1419264
    buffer_load_dwordx4 v10, s[4:7], s30 offen lds
    s_waitcnt vmcnt(12)
    s_barrier
    s_waitcnt vmcnt(8)
    s_barrier
    s_waitcnt vmcnt(4)
    s_barrier
    s_waitcnt vmcnt(0)
    s_barrier
    s_barrier
    s_mov_b32 s4, s84
    s_mov_b32 s5, s85
    s_mov_b32 s6, 1605632
    s_mov_b32 s7, 0x00020000
    v_lshrrev_b32 v2, 3, v0
    v_and_b32 v3, 7, v0
    v_bfe_u32 v4, v0, 4, 1
    v_lshlrev_b32 v4, 2, v4
    v_xor_b32 v3, v3, v4
    v_mul_u32_u24 v2, 896, v2
    v_lshl_add_u32 v10, v3, 4, v2
    s_sub_u32 s31, s24, 4
    s_mul_i32 s42, s31, 28672
    s_lshl_b32 s30, s93, 7
    s_add_u32 s42, s42, s30
    s_lshl_b32 s44, s31, 14
    s_add_u32 m0, s44, 0
    s_add_u32 s30, s42, 0
    buffer_load_dwordx4 v10, s[4:7], s30 offen lds
    s_add_u32 m0, s44, 1024
    s_add_u32 s30, s42, 7168
    buffer_load_dwordx4 v10, s[4:7], s30 offen lds
    s_add_u32 m0, s44, 2048
    s_add_u32 s30, s42, 14336
    buffer_load_dwordx4 v10, s[4:7], s30 offen lds
    s_add_u32 m0, s44, 3072
    s_add_u32 s30, s42, 21504
    buffer_load_dwordx4 v10, s[4:7], s30 offen lds
    s_add_u32 m0, s44, 4096
    s_add_u32 s30, s42, 229376
    buffer_load_dwordx4 v10, s[4:7], s30 offen lds
    s_add_u32 m0, s44, 5120
    s_add_u32 s30, s42, 236544
    buffer_load_dwordx4 v10, s[4:7], s30 offen lds
    s_add_u32 m0, s44, 6144
    s_add_u32 s30, s42, 243712
    buffer_load_dwordx4 v10, s[4:7], s30 offen lds
    s_add_u32 m0, s44, 7168
    s_add_u32 s30, s42, 250880
    buffer_load_dwordx4 v10, s[4:7], s30 offen lds
    s_add_u32 m0, s44, 8192
    s_add_u32 s30, s42, 458752
    buffer_load_dwordx4 v10, s[4:7], s30 offen lds
    s_add_u32 m0, s44, 9216
    s_add_u32 s30, s42, 465920
    buffer_load_dwordx4 v10, s[4:7], s30 offen lds
    s_add_u32 m0, s44, 10240
    s_add_u32 s30, s42, 473088
    buffer_load_dwordx4 v10, s[4:7], s30 offen lds
    s_add_u32 m0, s44, 11264
    s_add_u32 s30, s42, 480256
    buffer_load_dwordx4 v10, s[4:7], s30 offen lds
    s_add_u32 m0, s44, 12288
    s_add_u32 s30, s42, 688128
    buffer_load_dwordx4 v10, s[4:7], s30 offen lds
    s_add_u32 m0, s44, 13312
    s_add_u32 s30, s42, 695296
    buffer_load_dwordx4 v10, s[4:7], s30 offen lds
    s_add_u32 m0, s44, 14336
    s_add_u32 s30, s42, 702464
    buffer_load_dwordx4 v10, s[4:7], s30 offen lds
    s_add_u32 m0, s44, 15360
    s_add_u32 s30, s42, 709632
    buffer_load_dwordx4 v10, s[4:7], s30 offen lds
    s_sub_u32 s31, s24, 0
    s_mul_i32 s42, s31, 28672
    s_lshl_b32 s30, s93, 7
    s_add_u32 s42, s42, s30
    s_lshl_b32 s44, s31, 14
    s_add_u32 m0, s44, 0
    s_add_u32 s30, s42, 0
    buffer_load_dwordx4 v10, s[4:7], s30 offen lds
    s_add_u32 m0, s44, 1024
    s_add_u32 s30, s42, 7168
    buffer_load_dwordx4 v10, s[4:7], s30 offen lds
    s_add_u32 m0, s44, 2048
    s_add_u32 s30, s42, 14336
    buffer_load_dwordx4 v10, s[4:7], s30 offen lds
    s_add_u32 m0, s44, 3072
    s_add_u32 s30, s42, 21504
    buffer_load_dwordx4 v10, s[4:7], s30 offen lds
    s_add_u32 m0, s44, 4096
    s_add_u32 s30, s42, 229376
    buffer_load_dwordx4 v10, s[4:7], s30 offen lds
    s_add_u32 m0, s44, 5120
    s_add_u32 s30, s42, 236544
    buffer_load_dwordx4 v10, s[4:7], s30 offen lds
    s_add_u32 m0, s44, 6144
    s_add_u32 s30, s42, 243712
    buffer_load_dwordx4 v10, s[4:7], s30 offen lds
    s_add_u32 m0, s44, 7168
    s_add_u32 s30, s42, 250880
    buffer_load_dwordx4 v10, s[4:7], s30 offen lds
    s_add_u32 m0, s44, 8192
    s_add_u32 s30, s42, 458752
    buffer_load_dwordx4 v10, s[4:7], s30 offen lds
    s_add_u32 m0, s44, 9216
    s_add_u32 s30, s42, 465920
    buffer_load_dwordx4 v10, s[4:7], s30 offen lds
    s_add_u32 m0, s44, 10240
    s_add_u32 s30, s42, 473088
    buffer_load_dwordx4 v10, s[4:7], s30 offen lds
    s_add_u32 m0, s44, 11264
    s_add_u32 s30, s42, 480256
    buffer_load_dwordx4 v10, s[4:7], s30 offen lds
    s_add_u32 m0, s44, 12288
    s_add_u32 s30, s42, 688128
    buffer_load_dwordx4 v10, s[4:7], s30 offen lds
    s_add_u32 m0, s44, 13312
    s_add_u32 s30, s42, 695296
    buffer_load_dwordx4 v10, s[4:7], s30 offen lds
    s_add_u32 m0, s44, 14336
    s_add_u32 s30, s42, 702464
    buffer_load_dwordx4 v10, s[4:7], s30 offen lds
    s_add_u32 m0, s44, 15360
    s_add_u32 s30, s42, 709632
    buffer_load_dwordx4 v10, s[4:7], s30 offen lds
    s_barrier
    s_waitcnt vmcnt(0)
    s_barrier
    s_branch attn_kernel_C
attn_kernel_cB:
    v_lshlrev_b32 v24, 4, v0
    v_and_b32 v15, 31, v0
    v_lshrrev_b32 v12, 5, v0
    s_lshl_b32 s51, s90, 2
    s_add_u32 s51, s51, s24
    s_mul_i32 s43, s51, 28672
    s_lshl_b32 s42, s51, 8
    v_lshlrev_b32 v16, 3, v15
    s_add_u32 s8, s34, 8388608
    s_addc_u32 s9, s35, 0
    s_mov_b32 s10, 1835008
    s_mov_b32 s11, 0x00020000
    s_add_u32 s16, s34, 17825792
    s_addc_u32 s17, s35, 0
    s_mov_b32 s18, 114688
    s_mov_b32 s19, 0x00020000
    s_add_u32 s12, s34, 10485760
    s_addc_u32 s13, s35, 0
    s_mov_b32 s14, 7340032
    s_mov_b32 s15, 0x00020000
    s_add_u32 s30, s43, 0
    buffer_load_dwordx4 v[128:131], v24, s[8:11], s30 offen offset:0 sc1
    buffer_load_dwordx4 v[132:135], v24, s[8:11], s30 offen offset:1024 sc1
    buffer_load_dwordx4 v[136:139], v24, s[8:11], s30 offen offset:2048 sc1
    buffer_load_dwordx4 v[140:143], v24, s[8:11], s30 offen offset:3072 sc1
    s_add_u32 s31, s42, 0
    buffer_load_dwordx2 v[240:241], v16, s[16:19], s31 offen sc1
    s_add_u32 s31, s42, 16384
    buffer_load_dwordx2 v[242:243], v16, s[16:19], s31 offen sc1
    s_add_u32 s31, s42, 32768
    buffer_load_dwordx2 v[244:245], v16, s[16:19], s31 offen sc1
    s_add_u32 s31, s42, 49152
    buffer_load_dwordx2 v[246:247], v16, s[16:19], s31 offen sc1
    s_add_u32 s31, s42, 65536
    buffer_load_dwordx2 v[248:249], v16, s[16:19], s31 offen sc1
    s_add_u32 s31, s42, 81920
    buffer_load_dwordx2 v[250:251], v16, s[16:19], s31 offen sc1
    s_add_u32 s31, s42, 98304
    buffer_load_dwordx2 v[252:253], v16, s[16:19], s31 offen sc1
    s_add_u32 s30, s43, 4096
    buffer_load_dwordx4 v[144:147], v24, s[8:11], s30 offen offset:0 sc1
    buffer_load_dwordx4 v[148:151], v24, s[8:11], s30 offen offset:1024 sc1
    buffer_load_dwordx4 v[152:155], v24, s[8:11], s30 offen offset:2048 sc1
    buffer_load_dwordx4 v[156:159], v24, s[8:11], s30 offen offset:3072 sc1
    s_add_u32 s30, s43, 8192
    buffer_load_dwordx4 v[160:163], v24, s[8:11], s30 offen offset:0 sc1
    buffer_load_dwordx4 v[164:167], v24, s[8:11], s30 offen offset:1024 sc1
    buffer_load_dwordx4 v[168:171], v24, s[8:11], s30 offen offset:2048 sc1
    buffer_load_dwordx4 v[172:175], v24, s[8:11], s30 offen offset:3072 sc1
    s_add_u32 s30, s43, 12288
    buffer_load_dwordx4 v[176:179], v24, s[8:11], s30 offen offset:0 sc1
    buffer_load_dwordx4 v[180:183], v24, s[8:11], s30 offen offset:1024 sc1
    buffer_load_dwordx4 v[184:187], v24, s[8:11], s30 offen offset:2048 sc1
    buffer_load_dwordx4 v[188:191], v24, s[8:11], s30 offen offset:3072 sc1
    s_add_u32 s30, s43, 16384
    buffer_load_dwordx4 v[192:195], v24, s[8:11], s30 offen offset:0 sc1
    buffer_load_dwordx4 v[196:199], v24, s[8:11], s30 offen offset:1024 sc1
    buffer_load_dwordx4 v[200:203], v24, s[8:11], s30 offen offset:2048 sc1
    buffer_load_dwordx4 v[204:207], v24, s[8:11], s30 offen offset:3072 sc1
    s_add_u32 s30, s43, 20480
    buffer_load_dwordx4 v[208:211], v24, s[8:11], s30 offen offset:0 sc1
    buffer_load_dwordx4 v[212:215], v24, s[8:11], s30 offen offset:1024 sc1
    buffer_load_dwordx4 v[216:219], v24, s[8:11], s30 offen offset:2048 sc1
    buffer_load_dwordx4 v[220:223], v24, s[8:11], s30 offen offset:3072 sc1
    s_add_u32 s30, s43, 24576
    buffer_load_dwordx4 v[224:227], v24, s[8:11], s30 offen offset:0 sc1
    buffer_load_dwordx4 v[228:231], v24, s[8:11], s30 offen offset:1024 sc1
    buffer_load_dwordx4 v[232:235], v24, s[8:11], s30 offen offset:2048 sc1
    buffer_load_dwordx4 v[236:239], v24, s[8:11], s30 offen offset:3072 sc1
    v_bfe_u32 v11, v0, 4, 1
    v_bfe_u32 v13, v0, 2, 2
    v_and_b32 v14, 3, v0
    v_lshl_add_u32 v17, v12, 2, v13
    v_lshlrev_b32 v17, 8, v17
    v_and_b32 v18, 1, v14
    v_lshl_add_u32 v17, v18, 3, v17
    v_lshrrev_b32 v18, 1, v14
    v_lshl_add_u32 v18, v11, 1, v18
    v_lshlrev_b32 v19, 2, v13
    v_add_u32 v20, 0, v18
    v_xor_b32 v20, v20, v19
    v_lshl_add_u32 v2, v20, 4, v17
    v_add_u32 v3, 0x10000, v2
    v_add_u32 v20, 4, v18
    v_xor_b32 v20, v20, v19
    v_lshl_add_u32 v4, v20, 4, v17
    v_add_u32 v5, 0x10000, v4
    v_add_u32 v20, 8, v18
    v_xor_b32 v20, v20, v19
    v_lshl_add_u32 v6, v20, 4, v17
    v_add_u32 v7, 0x10000, v6
    v_add_u32 v20, 12, v18
    v_xor_b32 v20, v20, v19
    v_lshl_add_u32 v8, v20, 4, v17
    v_add_u32 v9, 0x10000, v8
    s_barrier
    ds_read_b64_tr_b16 v[32:33], v2 offset:0
    ds_read_b64_tr_b16 v[34:35], v2 offset:2048
    ds_read_b64_tr_b16 v[36:37], v4 offset:0
    ds_read_b64_tr_b16 v[38:39], v4 offset:2048
    ds_read_b64_tr_b16 v[40:41], v6 offset:0
    ds_read_b64_tr_b16 v[42:43], v6 offset:2048
    ds_read_b64_tr_b16 v[44:45], v8 offset:0
    ds_read_b64_tr_b16 v[46:47], v8 offset:2048
    s_waitcnt vmcnt(24) lgkmcnt(0)
    v_mfma_f32_32x32x16_bf16 v[64:79], v[32:35], v[128:131], 0
    ds_read_b64_tr_b16 v[48:49], v2 offset:4096
    ds_read_b64_tr_b16 v[50:51], v2 offset:6144
    ds_read_b64_tr_b16 v[52:53], v4 offset:4096
    v_mfma_f32_32x32x16_bf16 v[80:95], v[36:39], v[128:131], 0
    ds_read_b64_tr_b16 v[54:55], v4 offset:6144
    ds_read_b64_tr_b16 v[56:57], v6 offset:4096
    ds_read_b64_tr_b16 v[58:59], v6 offset:6144
    v_mfma_f32_32x32x16_bf16 v[96:111], v[40:43], v[128:131], 0
    ds_read_b64_tr_b16 v[60:61], v8 offset:4096
    ds_read_b64_tr_b16 v[62:63], v8 offset:6144
    v_mfma_f32_32x32x16_bf16 v[112:127], v[44:47], v[128:131], 0
    s_waitcnt vmcnt(24) lgkmcnt(0)
    v_mfma_f32_32x32x16_bf16 v[64:79], v[48:51], v[132:135], v[64:79]
    ds_read_b64_tr_b16 v[32:33], v2 offset:8192
    ds_read_b64_tr_b16 v[34:35], v2 offset:10240
    ds_read_b64_tr_b16 v[36:37], v4 offset:8192
    v_mfma_f32_32x32x16_bf16 v[80:95], v[52:55], v[132:135], v[80:95]
    ds_read_b64_tr_b16 v[38:39], v4 offset:10240
    ds_read_b64_tr_b16 v[40:41], v6 offset:8192
    ds_read_b64_tr_b16 v[42:43], v6 offset:10240
    v_mfma_f32_32x32x16_bf16 v[96:111], v[56:59], v[132:135], v[96:111]
    ds_read_b64_tr_b16 v[44:45], v8 offset:8192
    ds_read_b64_tr_b16 v[46:47], v8 offset:10240
    v_mfma_f32_32x32x16_bf16 v[112:127], v[60:63], v[132:135], v[112:127]
    s_waitcnt vmcnt(24) lgkmcnt(0)
    v_mfma_f32_32x32x16_bf16 v[64:79], v[32:35], v[136:139], v[64:79]
    ds_read_b64_tr_b16 v[48:49], v2 offset:12288
    ds_read_b64_tr_b16 v[50:51], v2 offset:14336
    ds_read_b64_tr_b16 v[52:53], v4 offset:12288
    v_mfma_f32_32x32x16_bf16 v[80:95], v[36:39], v[136:139], v[80:95]
    ds_read_b64_tr_b16 v[54:55], v4 offset:14336
    ds_read_b64_tr_b16 v[56:57], v6 offset:12288
    ds_read_b64_tr_b16 v[58:59], v6 offset:14336
    v_mfma_f32_32x32x16_bf16 v[96:111], v[40:43], v[136:139], v[96:111]
    ds_read_b64_tr_b16 v[60:61], v8 offset:12288
    ds_read_b64_tr_b16 v[62:63], v8 offset:14336
    v_mfma_f32_32x32x16_bf16 v[112:127], v[44:47], v[136:139], v[112:127]
    s_waitcnt vmcnt(24) lgkmcnt(0)
    s_barrier
    v_mfma_f32_32x32x16_bf16 v[64:79], v[48:51], v[140:143], v[64:79]
    ds_read_b64_tr_b16 v[32:33], v2 offset:16384
    ds_read_b64_tr_b16 v[34:35], v2 offset:18432
    ds_read_b64_tr_b16 v[36:37], v4 offset:16384
    v_mfma_f32_32x32x16_bf16 v[80:95], v[52:55], v[140:143], v[80:95]
    ds_read_b64_tr_b16 v[38:39], v4 offset:18432
    ds_read_b64_tr_b16 v[40:41], v6 offset:16384
    ds_read_b64_tr_b16 v[42:43], v6 offset:18432
    v_mfma_f32_32x32x16_bf16 v[96:111], v[56:59], v[140:143], v[96:111]
    ds_read_b64_tr_b16 v[44:45], v8 offset:16384
    ds_read_b64_tr_b16 v[46:47], v8 offset:18432
    v_mfma_f32_32x32x16_bf16 v[112:127], v[60:63], v[140:143], v[112:127]
    s_waitcnt vmcnt(23) lgkmcnt(0)
    v_mfma_f32_32x32x16_bf16 v[64:79], v[32:35], v[144:147], v[64:79]
    ds_read_b64_tr_b16 v[48:49], v2 offset:20480
    ds_read_b64_tr_b16 v[50:51], v2 offset:22528
    ds_read_b64_tr_b16 v[52:53], v4 offset:20480
    v_mfma_f32_32x32x16_bf16 v[80:95], v[36:39], v[144:147], v[80:95]
    ds_read_b64_tr_b16 v[54:55], v4 offset:22528
    ds_read_b64_tr_b16 v[56:57], v6 offset:20480
    ds_read_b64_tr_b16 v[58:59], v6 offset:22528
    v_mfma_f32_32x32x16_bf16 v[96:111], v[40:43], v[144:147], v[96:111]
    ds_read_b64_tr_b16 v[60:61], v8 offset:20480
    ds_read_b64_tr_b16 v[62:63], v8 offset:22528
    v_mfma_f32_32x32x16_bf16 v[112:127], v[44:47], v[144:147], v[112:127]
    s_waitcnt vmcnt(22) lgkmcnt(0)
    v_mfma_f32_32x32x16_bf16 v[64:79], v[48:51], v[148:151], v[64:79]
    ds_read_b64_tr_b16 v[32:33], v2 offset:24576
    ds_read_b64_tr_b16 v[34:35], v2 offset:26624
    ds_read_b64_tr_b16 v[36:37], v4 offset:24576
    v_mfma_f32_32x32x16_bf16 v[80:95], v[52:55], v[148:151], v[80:95]
    ds_read_b64_tr_b16 v[38:39], v4 offset:26624
    ds_read_b64_tr_b16 v[40:41], v6 offset:24576
    ds_read_b64_tr_b16 v[42:43], v6 offset:26624
    v_mfma_f32_32x32x16_bf16 v[96:111], v[56:59], v[148:151], v[96:111]
    ds_read_b64_tr_b16 v[44:45], v8 offset:24576
    ds_read_b64_tr_b16 v[46:47], v8 offset:26624
    v_mfma_f32_32x32x16_bf16 v[112:127], v[60:63], v[148:151], v[112:127]
    s_waitcnt vmcnt(21) lgkmcnt(0)
    v_mfma_f32_32x32x16_bf16 v[64:79], v[32:35], v[152:155], v[64:79]
    ds_read_b64_tr_b16 v[48:49], v2 offset:28672
    ds_read_b64_tr_b16 v[50:51], v2 offset:30720
    ds_read_b64_tr_b16 v[52:53], v4 offset:28672
    v_mfma_f32_32x32x16_bf16 v[80:95], v[36:39], v[152:155], v[80:95]
    ds_read_b64_tr_b16 v[54:55], v4 offset:30720
    ds_read_b64_tr_b16 v[56:57], v6 offset:28672
    ds_read_b64_tr_b16 v[58:59], v6 offset:30720
    v_mfma_f32_32x32x16_bf16 v[96:111], v[40:43], v[152:155], v[96:111]
    ds_read_b64_tr_b16 v[60:61], v8 offset:28672
    ds_read_b64_tr_b16 v[62:63], v8 offset:30720
    v_mfma_f32_32x32x16_bf16 v[112:127], v[44:47], v[152:155], v[112:127]
    s_waitcnt vmcnt(20) lgkmcnt(0)
    s_barrier
    v_mfma_f32_32x32x16_bf16 v[64:79], v[48:51], v[156:159], v[64:79]
    ds_read_b64_tr_b16 v[32:33], v2 offset:32768
    ds_read_b64_tr_b16 v[34:35], v2 offset:34816
    ds_read_b64_tr_b16 v[36:37], v4 offset:32768
    v_mfma_f32_32x32x16_bf16 v[80:95], v[52:55], v[156:159], v[80:95]
    ds_read_b64_tr_b16 v[38:39], v4 offset:34816
    ds_read_b64_tr_b16 v[40:41], v6 offset:32768
    ds_read_b64_tr_b16 v[42:43], v6 offset:34816
    v_mfma_f32_32x32x16_bf16 v[96:111], v[56:59], v[156:159], v[96:111]
    ds_read_b64_tr_b16 v[44:45], v8 offset:32768
    ds_read_b64_tr_b16 v[46:47], v8 offset:34816
    v_mfma_f32_32x32x16_bf16 v[112:127], v[60:63], v[156:159], v[112:127]
    s_waitcnt vmcnt(19) lgkmcnt(0)
    v_mfma_f32_32x32x16_bf16 v[64:79], v[32:35], v[160:163], v[64:79]
    ds_read_b64_tr_b16 v[48:49], v2 offset:36864
    ds_read_b64_tr_b16 v[50:51], v2 offset:38912
    ds_read_b64_tr_b16 v[52:53], v4 offset:36864
    v_mfma_f32_32x32x16_bf16 v[80:95], v[36:39], v[160:163], v[80:95]
    ds_read_b64_tr_b16 v[54:55], v4 offset:38912
    ds_read_b64_tr_b16 v[56:57], v6 offset:36864
    ds_read_b64_tr_b16 v[58:59], v6 offset:38912
    v_mfma_f32_32x32x16_bf16 v[96:111], v[40:43], v[160:163], v[96:111]
    ds_read_b64_tr_b16 v[60:61], v8 offset:36864
    ds_read_b64_tr_b16 v[62:63], v8 offset:38912
    v_mfma_f32_32x32x16_bf16 v[112:127], v[44:47], v[160:163], v[112:127]
    s_waitcnt vmcnt(18) lgkmcnt(0)
    v_mfma_f32_32x32x16_bf16 v[64:79], v[48:51], v[164:167], v[64:79]
    ds_read_b64_tr_b16 v[32:33], v2 offset:40960
    ds_read_b64_tr_b16 v[34:35], v2 offset:43008
    ds_read_b64_tr_b16 v[36:37], v4 offset:40960
    v_mfma_f32_32x32x16_bf16 v[80:95], v[52:55], v[164:167], v[80:95]
    ds_read_b64_tr_b16 v[38:39], v4 offset:43008
    ds_read_b64_tr_b16 v[40:41], v6 offset:40960
    ds_read_b64_tr_b16 v[42:43], v6 offset:43008
    v_mfma_f32_32x32x16_bf16 v[96:111], v[56:59], v[164:167], v[96:111]
    ds_read_b64_tr_b16 v[44:45], v8 offset:40960
    ds_read_b64_tr_b16 v[46:47], v8 offset:43008
    v_mfma_f32_32x32x16_bf16 v[112:127], v[60:63], v[164:167], v[112:127]
    s_waitcnt vmcnt(17) lgkmcnt(0)
    v_mfma_f32_32x32x16_bf16 v[64:79], v[32:35], v[168:171], v[64:79]
    ds_read_b64_tr_b16 v[48:49], v2 offset:45056
    ds_read_b64_tr_b16 v[50:51], v2 offset:47104
    ds_read_b64_tr_b16 v[52:53], v4 offset:45056
    v_mfma_f32_32x32x16_bf16 v[80:95], v[36:39], v[168:171], v[80:95]
    ds_read_b64_tr_b16 v[54:55], v4 offset:47104
    ds_read_b64_tr_b16 v[56:57], v6 offset:45056
    ds_read_b64_tr_b16 v[58:59], v6 offset:47104
    v_mfma_f32_32x32x16_bf16 v[96:111], v[40:43], v[168:171], v[96:111]
    ds_read_b64_tr_b16 v[60:61], v8 offset:45056
    ds_read_b64_tr_b16 v[62:63], v8 offset:47104
    v_mfma_f32_32x32x16_bf16 v[112:127], v[44:47], v[168:171], v[112:127]
    s_waitcnt vmcnt(16) lgkmcnt(0)
    s_barrier
    v_mfma_f32_32x32x16_bf16 v[64:79], v[48:51], v[172:175], v[64:79]
    ds_read_b64_tr_b16 v[32:33], v2 offset:49152
    ds_read_b64_tr_b16 v[34:35], v2 offset:51200
    ds_read_b64_tr_b16 v[36:37], v4 offset:49152
    v_mfma_f32_32x32x16_bf16 v[80:95], v[52:55], v[172:175], v[80:95]
    ds_read_b64_tr_b16 v[38:39], v4 offset:51200
    ds_read_b64_tr_b16 v[40:41], v6 offset:49152
    ds_read_b64_tr_b16 v[42:43], v6 offset:51200
    v_mfma_f32_32x32x16_bf16 v[96:111], v[56:59], v[172:175], v[96:111]
    ds_read_b64_tr_b16 v[44:45], v8 offset:49152
    ds_read_b64_tr_b16 v[46:47], v8 offset:51200
    v_mfma_f32_32x32x16_bf16 v[112:127], v[60:63], v[172:175], v[112:127]
    s_waitcnt vmcnt(15) lgkmcnt(0)
    v_mfma_f32_32x32x16_bf16 v[64:79], v[32:35], v[176:179], v[64:79]
    ds_read_b64_tr_b16 v[48:49], v2 offset:53248
    ds_read_b64_tr_b16 v[50:51], v2 offset:55296
    ds_read_b64_tr_b16 v[52:53], v4 offset:53248
    v_mfma_f32_32x32x16_bf16 v[80:95], v[36:39], v[176:179], v[80:95]
    ds_read_b64_tr_b16 v[54:55], v4 offset:55296
    ds_read_b64_tr_b16 v[56:57], v6 offset:53248
    ds_read_b64_tr_b16 v[58:59], v6 offset:55296
    v_mfma_f32_32x32x16_bf16 v[96:111], v[40:43], v[176:179], v[96:111]
    ds_read_b64_tr_b16 v[60:61], v8 offset:53248
    ds_read_b64_tr_b16 v[62:63], v8 offset:55296
    v_mfma_f32_32x32x16_bf16 v[112:127], v[44:47], v[176:179], v[112:127]
    s_waitcnt vmcnt(14) lgkmcnt(0)
    v_mfma_f32_32x32x16_bf16 v[64:79], v[48:51], v[180:183], v[64:79]
    ds_read_b64_tr_b16 v[32:33], v2 offset:57344
    ds_read_b64_tr_b16 v[34:35], v2 offset:59392
    ds_read_b64_tr_b16 v[36:37], v4 offset:57344
    v_mfma_f32_32x32x16_bf16 v[80:95], v[52:55], v[180:183], v[80:95]
    ds_read_b64_tr_b16 v[38:39], v4 offset:59392
    ds_read_b64_tr_b16 v[40:41], v6 offset:57344
    ds_read_b64_tr_b16 v[42:43], v6 offset:59392
    v_mfma_f32_32x32x16_bf16 v[96:111], v[56:59], v[180:183], v[96:111]
    ds_read_b64_tr_b16 v[44:45], v8 offset:57344
    ds_read_b64_tr_b16 v[46:47], v8 offset:59392
    v_mfma_f32_32x32x16_bf16 v[112:127], v[60:63], v[180:183], v[112:127]
    s_waitcnt vmcnt(13) lgkmcnt(0)
    v_mfma_f32_32x32x16_bf16 v[64:79], v[32:35], v[184:187], v[64:79]
    ds_read_b64_tr_b16 v[48:49], v2 offset:61440
    ds_read_b64_tr_b16 v[50:51], v2 offset:63488
    ds_read_b64_tr_b16 v[52:53], v4 offset:61440
    v_mfma_f32_32x32x16_bf16 v[80:95], v[36:39], v[184:187], v[80:95]
    ds_read_b64_tr_b16 v[54:55], v4 offset:63488
    ds_read_b64_tr_b16 v[56:57], v6 offset:61440
    ds_read_b64_tr_b16 v[58:59], v6 offset:63488
    v_mfma_f32_32x32x16_bf16 v[96:111], v[40:43], v[184:187], v[96:111]
    ds_read_b64_tr_b16 v[60:61], v8 offset:61440
    ds_read_b64_tr_b16 v[62:63], v8 offset:63488
    v_mfma_f32_32x32x16_bf16 v[112:127], v[44:47], v[184:187], v[112:127]
    s_waitcnt vmcnt(12) lgkmcnt(0)
    s_barrier
    v_mfma_f32_32x32x16_bf16 v[64:79], v[48:51], v[188:191], v[64:79]
    ds_read_b64_tr_b16 v[32:33], v3 offset:0
    ds_read_b64_tr_b16 v[34:35], v3 offset:2048
    ds_read_b64_tr_b16 v[36:37], v5 offset:0
    v_mfma_f32_32x32x16_bf16 v[80:95], v[52:55], v[188:191], v[80:95]
    ds_read_b64_tr_b16 v[38:39], v5 offset:2048
    ds_read_b64_tr_b16 v[40:41], v7 offset:0
    ds_read_b64_tr_b16 v[42:43], v7 offset:2048
    v_mfma_f32_32x32x16_bf16 v[96:111], v[56:59], v[188:191], v[96:111]
    ds_read_b64_tr_b16 v[44:45], v9 offset:0
    ds_read_b64_tr_b16 v[46:47], v9 offset:2048
    v_mfma_f32_32x32x16_bf16 v[112:127], v[60:63], v[188:191], v[112:127]
    s_waitcnt vmcnt(11) lgkmcnt(0)
    v_mfma_f32_32x32x16_bf16 v[64:79], v[32:35], v[192:195], v[64:79]
    ds_read_b64_tr_b16 v[48:49], v3 offset:4096
    ds_read_b64_tr_b16 v[50:51], v3 offset:6144
    ds_read_b64_tr_b16 v[52:53], v5 offset:4096
    v_mfma_f32_32x32x16_bf16 v[80:95], v[36:39], v[192:195], v[80:95]
    ds_read_b64_tr_b16 v[54:55], v5 offset:6144
    ds_read_b64_tr_b16 v[56:57], v7 offset:4096
    ds_read_b64_tr_b16 v[58:59], v7 offset:6144
    v_mfma_f32_32x32x16_bf16 v[96:111], v[40:43], v[192:195], v[96:111]
    ds_read_b64_tr_b16 v[60:61], v9 offset:4096
    ds_read_b64_tr_b16 v[62:63], v9 offset:6144
    v_mfma_f32_32x32x16_bf16 v[112:127], v[44:47], v[192:195], v[112:127]
    s_waitcnt vmcnt(10) lgkmcnt(0)
    v_mfma_f32_32x32x16_bf16 v[64:79], v[48:51], v[196:199], v[64:79]
    ds_read_b64_tr_b16 v[32:33], v3 offset:8192
    ds_read_b64_tr_b16 v[34:35], v3 offset:10240
    ds_read_b64_tr_b16 v[36:37], v5 offset:8192
    v_mfma_f32_32x32x16_bf16 v[80:95], v[52:55], v[196:199], v[80:95]
    ds_read_b64_tr_b16 v[38:39], v5 offset:10240
    ds_read_b64_tr_b16 v[40:41], v7 offset:8192
    ds_read_b64_tr_b16 v[42:43], v7 offset:10240
    v_mfma_f32_32x32x16_bf16 v[96:111], v[56:59], v[196:199], v[96:111]
    ds_read_b64_tr_b16 v[44:45], v9 offset:8192
    ds_read_b64_tr_b16 v[46:47], v9 offset:10240
    v_mfma_f32_32x32x16_bf16 v[112:127], v[60:63], v[196:199], v[112:127]
    s_waitcnt vmcnt(9) lgkmcnt(0)
    v_mfma_f32_32x32x16_bf16 v[64:79], v[32:35], v[200:203], v[64:79]
    ds_read_b64_tr_b16 v[48:49], v3 offset:12288
    ds_read_b64_tr_b16 v[50:51], v3 offset:14336
    ds_read_b64_tr_b16 v[52:53], v5 offset:12288
    v_mfma_f32_32x32x16_bf16 v[80:95], v[36:39], v[200:203], v[80:95]
    ds_read_b64_tr_b16 v[54:55], v5 offset:14336
    ds_read_b64_tr_b16 v[56:57], v7 offset:12288
    ds_read_b64_tr_b16 v[58:59], v7 offset:14336
    v_mfma_f32_32x32x16_bf16 v[96:111], v[40:43], v[200:203], v[96:111]
    ds_read_b64_tr_b16 v[60:61], v9 offset:12288
    ds_read_b64_tr_b16 v[62:63], v9 offset:14336
    v_mfma_f32_32x32x16_bf16 v[112:127], v[44:47], v[200:203], v[112:127]
    s_waitcnt vmcnt(8) lgkmcnt(0)
    s_barrier
    v_mfma_f32_32x32x16_bf16 v[64:79], v[48:51], v[204:207], v[64:79]
    ds_read_b64_tr_b16 v[32:33], v3 offset:16384
    ds_read_b64_tr_b16 v[34:35], v3 offset:18432
    ds_read_b64_tr_b16 v[36:37], v5 offset:16384
    v_mfma_f32_32x32x16_bf16 v[80:95], v[52:55], v[204:207], v[80:95]
    ds_read_b64_tr_b16 v[38:39], v5 offset:18432
    ds_read_b64_tr_b16 v[40:41], v7 offset:16384
    ds_read_b64_tr_b16 v[42:43], v7 offset:18432
    v_mfma_f32_32x32x16_bf16 v[96:111], v[56:59], v[204:207], v[96:111]
    ds_read_b64_tr_b16 v[44:45], v9 offset:16384
    ds_read_b64_tr_b16 v[46:47], v9 offset:18432
    v_mfma_f32_32x32x16_bf16 v[112:127], v[60:63], v[204:207], v[112:127]
    s_waitcnt vmcnt(7) lgkmcnt(0)
    v_mfma_f32_32x32x16_bf16 v[64:79], v[32:35], v[208:211], v[64:79]
    ds_read_b64_tr_b16 v[48:49], v3 offset:20480
    ds_read_b64_tr_b16 v[50:51], v3 offset:22528
    ds_read_b64_tr_b16 v[52:53], v5 offset:20480
    v_mfma_f32_32x32x16_bf16 v[80:95], v[36:39], v[208:211], v[80:95]
    ds_read_b64_tr_b16 v[54:55], v5 offset:22528
    ds_read_b64_tr_b16 v[56:57], v7 offset:20480
    ds_read_b64_tr_b16 v[58:59], v7 offset:22528
    v_mfma_f32_32x32x16_bf16 v[96:111], v[40:43], v[208:211], v[96:111]
    ds_read_b64_tr_b16 v[60:61], v9 offset:20480
    ds_read_b64_tr_b16 v[62:63], v9 offset:22528
    v_mfma_f32_32x32x16_bf16 v[112:127], v[44:47], v[208:211], v[112:127]
    s_waitcnt vmcnt(6) lgkmcnt(0)
    v_mfma_f32_32x32x16_bf16 v[64:79], v[48:51], v[212:215], v[64:79]
    ds_read_b64_tr_b16 v[32:33], v3 offset:24576
    ds_read_b64_tr_b16 v[34:35], v3 offset:26624
    ds_read_b64_tr_b16 v[36:37], v5 offset:24576
    v_mfma_f32_32x32x16_bf16 v[80:95], v[52:55], v[212:215], v[80:95]
    ds_read_b64_tr_b16 v[38:39], v5 offset:26624
    ds_read_b64_tr_b16 v[40:41], v7 offset:24576
    ds_read_b64_tr_b16 v[42:43], v7 offset:26624
    v_mfma_f32_32x32x16_bf16 v[96:111], v[56:59], v[212:215], v[96:111]
    ds_read_b64_tr_b16 v[44:45], v9 offset:24576
    ds_read_b64_tr_b16 v[46:47], v9 offset:26624
    v_mfma_f32_32x32x16_bf16 v[112:127], v[60:63], v[212:215], v[112:127]
    s_waitcnt vmcnt(5) lgkmcnt(0)
    v_mfma_f32_32x32x16_bf16 v[64:79], v[32:35], v[216:219], v[64:79]
    ds_read_b64_tr_b16 v[48:49], v3 offset:28672
    ds_read_b64_tr_b16 v[50:51], v3 offset:30720
    ds_read_b64_tr_b16 v[52:53], v5 offset:28672
    v_mfma_f32_32x32x16_bf16 v[80:95], v[36:39], v[216:219], v[80:95]
    ds_read_b64_tr_b16 v[54:55], v5 offset:30720
    ds_read_b64_tr_b16 v[56:57], v7 offset:28672
    ds_read_b64_tr_b16 v[58:59], v7 offset:30720
    v_mfma_f32_32x32x16_bf16 v[96:111], v[40:43], v[216:219], v[96:111]
    ds_read_b64_tr_b16 v[60:61], v9 offset:28672
    ds_read_b64_tr_b16 v[62:63], v9 offset:30720
    v_mfma_f32_32x32x16_bf16 v[112:127], v[44:47], v[216:219], v[112:127]
    s_waitcnt vmcnt(4) lgkmcnt(0)
    s_barrier
    v_mfma_f32_32x32x16_bf16 v[64:79], v[48:51], v[220:223], v[64:79]
    ds_read_b64_tr_b16 v[32:33], v3 offset:32768
    ds_read_b64_tr_b16 v[34:35], v3 offset:34816
    ds_read_b64_tr_b16 v[36:37], v5 offset:32768
    v_mfma_f32_32x32x16_bf16 v[80:95], v[52:55], v[220:223], v[80:95]
    ds_read_b64_tr_b16 v[38:39], v5 offset:34816
    ds_read_b64_tr_b16 v[40:41], v7 offset:32768
    ds_read_b64_tr_b16 v[42:43], v7 offset:34816
    v_mfma_f32_32x32x16_bf16 v[96:111], v[56:59], v[220:223], v[96:111]
    ds_read_b64_tr_b16 v[44:45], v9 offset:32768
    ds_read_b64_tr_b16 v[46:47], v9 offset:34816
    v_mfma_f32_32x32x16_bf16 v[112:127], v[60:63], v[220:223], v[112:127]
    s_waitcnt vmcnt(3) lgkmcnt(0)
    v_mfma_f32_32x32x16_bf16 v[64:79], v[32:35], v[224:227], v[64:79]
    ds_read_b64_tr_b16 v[48:49], v3 offset:36864
    ds_read_b64_tr_b16 v[50:51], v3 offset:38912
    ds_read_b64_tr_b16 v[52:53], v5 offset:36864
    v_mfma_f32_32x32x16_bf16 v[80:95], v[36:39], v[224:227], v[80:95]
    ds_read_b64_tr_b16 v[54:55], v5 offset:38912
    ds_read_b64_tr_b16 v[56:57], v7 offset:36864
    ds_read_b64_tr_b16 v[58:59], v7 offset:38912
    v_mfma_f32_32x32x16_bf16 v[96:111], v[40:43], v[224:227], v[96:111]
    ds_read_b64_tr_b16 v[60:61], v9 offset:36864
    ds_read_b64_tr_b16 v[62:63], v9 offset:38912
    v_mfma_f32_32x32x16_bf16 v[112:127], v[44:47], v[224:227], v[112:127]
    s_waitcnt vmcnt(2) lgkmcnt(0)
    v_mfma_f32_32x32x16_bf16 v[64:79], v[48:51], v[228:231], v[64:79]
    ds_read_b64_tr_b16 v[32:33], v3 offset:40960
    ds_read_b64_tr_b16 v[34:35], v3 offset:43008
    ds_read_b64_tr_b16 v[36:37], v5 offset:40960
    v_mfma_f32_32x32x16_bf16 v[80:95], v[52:55], v[228:231], v[80:95]
    ds_read_b64_tr_b16 v[38:39], v5 offset:43008
    ds_read_b64_tr_b16 v[40:41], v7 offset:40960
    ds_read_b64_tr_b16 v[42:43], v7 offset:43008
    v_mfma_f32_32x32x16_bf16 v[96:111], v[56:59], v[228:231], v[96:111]
    ds_read_b64_tr_b16 v[44:45], v9 offset:40960
    ds_read_b64_tr_b16 v[46:47], v9 offset:43008
    v_mfma_f32_32x32x16_bf16 v[112:127], v[60:63], v[228:231], v[112:127]
    s_waitcnt vmcnt(1) lgkmcnt(0)
    v_mfma_f32_32x32x16_bf16 v[64:79], v[32:35], v[232:235], v[64:79]
    ds_read_b64_tr_b16 v[48:49], v3 offset:45056
    ds_read_b64_tr_b16 v[50:51], v3 offset:47104
    ds_read_b64_tr_b16 v[52:53], v5 offset:45056
    v_mfma_f32_32x32x16_bf16 v[80:95], v[36:39], v[232:235], v[80:95]
    ds_read_b64_tr_b16 v[54:55], v5 offset:47104
    ds_read_b64_tr_b16 v[56:57], v7 offset:45056
    ds_read_b64_tr_b16 v[58:59], v7 offset:47104
    v_mfma_f32_32x32x16_bf16 v[96:111], v[40:43], v[232:235], v[96:111]
    ds_read_b64_tr_b16 v[60:61], v9 offset:45056
    ds_read_b64_tr_b16 v[62:63], v9 offset:47104
    v_mfma_f32_32x32x16_bf16 v[112:127], v[44:47], v[232:235], v[112:127]
    s_waitcnt vmcnt(0) lgkmcnt(0)
    v_mfma_f32_32x32x16_bf16 v[64:79], v[48:51], v[236:239], v[64:79]
    v_mfma_f32_32x32x16_bf16 v[80:95], v[52:55], v[236:239], v[80:95]
    v_mfma_f32_32x32x16_bf16 v[96:111], v[56:59], v[236:239], v[96:111]
    v_mfma_f32_32x32x16_bf16 v[112:127], v[60:63], v[236:239], v[112:127]
    s_barrier
    v_pk_add_f32 v[240:241], v[240:241], v[242:243]
    v_pk_add_f32 v[240:241], v[240:241], v[244:245]
    v_pk_add_f32 v[240:241], v[240:241], v[246:247]
    v_pk_add_f32 v[240:241], v[240:241], v[248:249]
    v_pk_add_f32 v[240:241], v[240:241], v[250:251]
    v_pk_add_f32 v[240:241], v[240:241], v[252:253]
    s_mov_b32 s29, 0x3b124925
    v_mul_f32 v241, s29, v241
    v_mul_f32 v242, s29, v240
    v_fma_f32 v240, -v242, v242, v241
    v_max_f32 v240, 0, v240
    v_add_f32 v240, 0x3727c5ac, v240
    v_rsq_f32 v240, v240
    s_nop 0
    v_mul_f32 v241, v242, v240
    s_mov_b32 s56, 0xc0135761
    s_mov_b32 s57, 0xbdd2d3e8
    v_lshlrev_b32 v18, 4, v12
    v_add_u32 v18, 135168, v18
    ds_read_b128 v[128:131], v18 offset:0
    ds_read_b128 v[144:147], v18 offset:512
    ds_read_b128 v[132:135], v18 offset:32
    ds_read_b128 v[148:151], v18 offset:544
    ds_read_b128 v[136:139], v18 offset:64
    ds_read_b128 v[152:155], v18 offset:576
    ds_read_b128 v[140:143], v18 offset:96
    ds_read_b128 v[156:159], v18 offset:608
    s_waitcnt lgkmcnt(0)
    ds_read_b128 v[208:211], v18 offset:128
    ds_read_b128 v[224:227], v18 offset:640
    ds_read_b128 v[212:215], v18 offset:160
    ds_read_b128 v[228:231], v18 offset:672
    ds_read_b128 v[216:219], v18 offset:192
    ds_read_b128 v[232:235], v18 offset:704
    ds_read_b128 v[220:223], v18 offset:224
    ds_read_b128 v[236:239], v18 offset:736
    v_pk_fma_f32 v[144:145], v[128:129], v[240:241], v[144:145] op_sel:[0,1,0] op_sel_hi:[1,1,1] neg_lo:[1,0,0] neg_hi:[1,0,0]
    v_pk_fma_f32 v[146:147], v[130:131], v[240:241], v[146:147] op_sel:[0,1,0] op_sel_hi:[1,1,1] neg_lo:[1,0,0] neg_hi:[1,0,0]
    v_pk_fma_f32 v[148:149], v[132:133], v[240:241], v[148:149] op_sel:[0,1,0] op_sel_hi:[1,1,1] neg_lo:[1,0,0] neg_hi:[1,0,0]
    v_pk_fma_f32 v[150:151], v[134:135], v[240:241], v[150:151] op_sel:[0,1,0] op_sel_hi:[1,1,1] neg_lo:[1,0,0] neg_hi:[1,0,0]
    v_pk_fma_f32 v[152:153], v[136:137], v[240:241], v[152:153] op_sel:[0,1,0] op_sel_hi:[1,1,1] neg_lo:[1,0,0] neg_hi:[1,0,0]
    v_pk_fma_f32 v[154:155], v[138:139], v[240:241], v[154:155] op_sel:[0,1,0] op_sel_hi:[1,1,1] neg_lo:[1,0,0] neg_hi:[1,0,0]
    v_pk_fma_f32 v[156:157], v[140:141], v[240:241], v[156:157] op_sel:[0,1,0] op_sel_hi:[1,1,1] neg_lo:[1,0,0] neg_hi:[1,0,0]
    v_pk_fma_f32 v[158:159], v[142:143], v[240:241], v[158:159] op_sel:[0,1,0] op_sel_hi:[1,1,1] neg_lo:[1,0,0] neg_hi:[1,0,0]
    v_pk_fma_f32 v[64:65], v[64:65], v[240:241], v[144:145] op_sel_hi:[1,0,1]
    v_pk_fma_f32 v[66:67], v[66:67], v[240:241], v[146:147] op_sel_hi:[1,0,1]
    v_pk_fma_f32 v[68:69], v[68:69], v[240:241], v[148:149] op_sel_hi:[1,0,1]
    v_pk_fma_f32 v[70:71], v[70:71], v[240:241], v[150:151] op_sel_hi:[1,0,1]
    v_pk_fma_f32 v[72:73], v[72:73], v[240:241], v[152:153] op_sel_hi:[1,0,1]
    v_pk_fma_f32 v[74:75], v[74:75], v[240:241], v[154:155] op_sel_hi:[1,0,1]
    v_pk_fma_f32 v[76:77], v[76:77], v[240:241], v[156:157] op_sel_hi:[1,0,1]
    v_pk_fma_f32 v[78:79], v[78:79], v[240:241], v[158:159] op_sel_hi:[1,0,1]
    v_pk_mul_f32 v[160:161], v[64:65], v[64:65]
    v_pk_mul_f32 v[162:163], v[66:67], v[66:67]
    v_pk_mul_f32 v[164:165], v[68:69], v[68:69]
    v_pk_mul_f32 v[166:167], v[70:71], v[70:71]
    v_pk_mul_f32 v[168:169], v[72:73], v[72:73]
    v_pk_mul_f32 v[170:171], v[74:75], v[74:75]
    v_pk_mul_f32 v[172:173], v[76:77], v[76:77]
    v_pk_mul_f32 v[174:175], v[78:79], v[78:79]
    v_pk_fma_f32 v[160:161], v[160:161], s[56:57], s[56:57] op_sel:[0,1,0] op_sel_hi:[1,1,0]
    v_pk_fma_f32 v[162:163], v[162:163], s[56:57], s[56:57] op_sel:[0,1,0] op_sel_hi:[1,1,0]
    v_pk_fma_f32 v[164:165], v[164:165], s[56:57], s[56:57] op_sel:[0,1,0] op_sel_hi:[1,1,0]
    v_pk_fma_f32 v[166:167], v[166:167], s[56:57], s[56:57] op_sel:[0,1,0] op_sel_hi:[1,1,0]
    v_pk_fma_f32 v[168:169], v[168:169], s[56:57], s[56:57] op_sel:[0,1,0] op_sel_hi:[1,1,0]
    v_pk_fma_f32 v[170:171], v[170:171], s[56:57], s[56:57] op_sel:[0,1,0] op_sel_hi:[1,1,0]
    v_pk_fma_f32 v[172:173], v[172:173], s[56:57], s[56:57] op_sel:[0,1,0] op_sel_hi:[1,1,0]
    v_pk_fma_f32 v[174:175], v[174:175], s[56:57], s[56:57] op_sel:[0,1,0] op_sel_hi:[1,1,0]
    v_pk_mul_f32 v[160:161], v[160:161], v[64:65]
    v_pk_mul_f32 v[162:163], v[162:163], v[66:67]
    v_pk_mul_f32 v[164:165], v[164:165], v[68:69]
    v_pk_mul_f32 v[166:167], v[166:167], v[70:71]
    v_pk_mul_f32 v[168:169], v[168:169], v[72:73]
    v_pk_mul_f32 v[170:171], v[170:171], v[74:75]
    v_pk_mul_f32 v[172:173], v[172:173], v[76:77]
    v_pk_mul_f32 v[174:175], v[174:175], v[78:79]
    v_exp_f32 v176, v160
    v_exp_f32 v177, v161
    v_exp_f32 v178, v162
    v_exp_f32 v179, v163
    v_exp_f32 v180, v164
    v_exp_f32 v181, v165
    v_exp_f32 v182, v166
    v_exp_f32 v183, v167
    v_exp_f32 v184, v168
    v_exp_f32 v185, v169
    v_exp_f32 v186, v170
    v_exp_f32 v187, v171
    v_exp_f32 v188, v172
    v_exp_f32 v189, v173
    v_exp_f32 v190, v174
    v_exp_f32 v191, v175
    v_pk_add_f32 v[176:177], v[176:177], 1.0 op_sel_hi:[1,0]
    v_pk_add_f32 v[178:179], v[178:179], 1.0 op_sel_hi:[1,0]
    v_pk_add_f32 v[180:181], v[180:181], 1.0 op_sel_hi:[1,0]
    v_pk_add_f32 v[182:183], v[182:183], 1.0 op_sel_hi:[1,0]
    v_pk_add_f32 v[184:185], v[184:185], 1.0 op_sel_hi:[1,0]
    v_pk_add_f32 v[186:187], v[186:187], 1.0 op_sel_hi:[1,0]
    v_pk_add_f32 v[188:189], v[188:189], 1.0 op_sel_hi:[1,0]
    v_pk_add_f32 v[190:191], v[190:191], 1.0 op_sel_hi:[1,0]
    v_rcp_f32 v176, v176
    v_rcp_f32 v177, v177
    v_rcp_f32 v178, v178
    v_rcp_f32 v179, v179
    v_rcp_f32 v180, v180
    v_rcp_f32 v181, v181
    v_rcp_f32 v182, v182
    v_rcp_f32 v183, v183
    v_rcp_f32 v184, v184
    v_rcp_f32 v185, v185
    v_rcp_f32 v186, v186
    v_rcp_f32 v187, v187
    v_rcp_f32 v188, v188
    v_rcp_f32 v189, v189
    v_rcp_f32 v190, v190
    v_rcp_f32 v191, v191
    v_pk_mul_f32 v[64:65], v[64:65], v[176:177]
    v_pk_mul_f32 v[66:67], v[66:67], v[178:179]
    v_pk_mul_f32 v[68:69], v[68:69], v[180:181]
    v_pk_mul_f32 v[70:71], v[70:71], v[182:183]
    v_pk_mul_f32 v[72:73], v[72:73], v[184:185]
    v_pk_mul_f32 v[74:75], v[74:75], v[186:187]
    v_pk_mul_f32 v[76:77], v[76:77], v[188:189]
    v_pk_mul_f32 v[78:79], v[78:79], v[190:191]
    v_cvt_pk_bf16_f32 v192, v64, v65
    v_cvt_pk_bf16_f32 v193, v66, v67
    v_cvt_pk_bf16_f32 v194, v68, v69
    v_cvt_pk_bf16_f32 v195, v70, v71
    v_cvt_pk_bf16_f32 v196, v72, v73
    v_cvt_pk_bf16_f32 v197, v74, v75
    v_cvt_pk_bf16_f32 v198, v76, v77
    v_cvt_pk_bf16_f32 v199, v78, v79
    s_mul_i32 s29, s51, 112
    s_lshl_b32 s30, s91, 3
    s_add_u32 s29, s29, s30
    s_add_u32 s29, s29, 0
    s_lshl_b32 s55, s29, 10
    buffer_store_dwordx4 v[192:195], v24, s[12:15], s55 offen sc1
    buffer_store_dwordx4 v[196:199], v24, s[12:15], s55 offen offset:1024 sc1
    s_waitcnt lgkmcnt(0)
    ds_read_b128 v[128:131], v18 offset:256
    ds_read_b128 v[144:147], v18 offset:768
    ds_read_b128 v[132:135], v18 offset:288
    ds_read_b128 v[148:151], v18 offset:800
    ds_read_b128 v[136:139], v18 offset:320
    ds_read_b128 v[152:155], v18 offset:832
    ds_read_b128 v[140:143], v18 offset:352
    ds_read_b128 v[156:159], v18 offset:864
    v_pk_fma_f32 v[224:225], v[208:209], v[240:241], v[224:225] op_sel:[0,1,0] op_sel_hi:[1,1,1] neg_lo:[1,0,0] neg_hi:[1,0,0]
    v_pk_fma_f32 v[226:227], v[210:211], v[240:241], v[226:227] op_sel:[0,1,0] op_sel_hi:[1,1,1] neg_lo:[1,0,0] neg_hi:[1,0,0]
    v_pk_fma_f32 v[228:229], v[212:213], v[240:241], v[228:229] op_sel:[0,1,0] op_sel_hi:[1,1,1] neg_lo:[1,0,0] neg_hi:[1,0,0]
    v_pk_fma_f32 v[230:231], v[214:215], v[240:241], v[230:231] op_sel:[0,1,0] op_sel_hi:[1,1,1] neg_lo:[1,0,0] neg_hi:[1,0,0]
    v_pk_fma_f32 v[232:233], v[216:217], v[240:241], v[232:233] op_sel:[0,1,0] op_sel_hi:[1,1,1] neg_lo:[1,0,0] neg_hi:[1,0,0]
    v_pk_fma_f32 v[234:235], v[218:219], v[240:241], v[234:235] op_sel:[0,1,0] op_sel_hi:[1,1,1] neg_lo:[1,0,0] neg_hi:[1,0,0]
    v_pk_fma_f32 v[236:237], v[220:221], v[240:241], v[236:237] op_sel:[0,1,0] op_sel_hi:[1,1,1] neg_lo:[1,0,0] neg_hi:[1,0,0]
    v_pk_fma_f32 v[238:239], v[222:223], v[240:241], v[238:239] op_sel:[0,1,0] op_sel_hi:[1,1,1] neg_lo:[1,0,0] neg_hi:[1,0,0]
    v_pk_fma_f32 v[80:81], v[80:81], v[240:241], v[224:225] op_sel_hi:[1,0,1]
    v_pk_fma_f32 v[82:83], v[82:83], v[240:241], v[226:227] op_sel_hi:[1,0,1]
    v_pk_fma_f32 v[84:85], v[84:85], v[240:241], v[228:229] op_sel_hi:[1,0,1]
    v_pk_fma_f32 v[86:87], v[86:87], v[240:241], v[230:231] op_sel_hi:[1,0,1]
    v_pk_fma_f32 v[88:89], v[88:89], v[240:241], v[232:233] op_sel_hi:[1,0,1]
    v_pk_fma_f32 v[90:91], v[90:91], v[240:241], v[234:235] op_sel_hi:[1,0,1]
    v_pk_fma_f32 v[92:93], v[92:93], v[240:241], v[236:237] op_sel_hi:[1,0,1]
    v_pk_fma_f32 v[94:95], v[94:95], v[240:241], v[238:239] op_sel_hi:[1,0,1]
    v_pk_mul_f32 v[160:161], v[80:81], v[80:81]
    v_pk_mul_f32 v[162:163], v[82:83], v[82:83]
    v_pk_mul_f32 v[164:165], v[84:85], v[84:85]
    v_pk_mul_f32 v[166:167], v[86:87], v[86:87]
    v_pk_mul_f32 v[168:169], v[88:89], v[88:89]
    v_pk_mul_f32 v[170:171], v[90:91], v[90:91]
    v_pk_mul_f32 v[172:173], v[92:93], v[92:93]
    v_pk_mul_f32 v[174:175], v[94:95], v[94:95]
    v_pk_fma_f32 v[160:161], v[160:161], s[56:57], s[56:57] op_sel:[0,1,0] op_sel_hi:[1,1,0]
    v_pk_fma_f32 v[162:163], v[162:163], s[56:57], s[56:57] op_sel:[0,1,0] op_sel_hi:[1,1,0]
    v_pk_fma_f32 v[164:165], v[164:165], s[56:57], s[56:57] op_sel:[0,1,0] op_sel_hi:[1,1,0]
    v_pk_fma_f32 v[166:167], v[166:167], s[56:57], s[56:57] op_sel:[0,1,0] op_sel_hi:[1,1,0]
    v_pk_fma_f32 v[168:169], v[168:169], s[56:57], s[56:57] op_sel:[0,1,0] op_sel_hi:[1,1,0]
    v_pk_fma_f32 v[170:171], v[170:171], s[56:57], s[56:57] op_sel:[0,1,0] op_sel_hi:[1,1,0]
    v_pk_fma_f32 v[172:173], v[172:173], s[56:57], s[56:57] op_sel:[0,1,0] op_sel_hi:[1,1,0]
    v_pk_fma_f32 v[174:175], v[174:175], s[56:57], s[56:57] op_sel:[0,1,0] op_sel_hi:[1,1,0]
    v_pk_mul_f32 v[160:161], v[160:161], v[80:81]
    v_pk_mul_f32 v[162:163], v[162:163], v[82:83]
    v_pk_mul_f32 v[164:165], v[164:165], v[84:85]
    v_pk_mul_f32 v[166:167], v[166:167], v[86:87]
    v_pk_mul_f32 v[168:169], v[168:169], v[88:89]
    v_pk_mul_f32 v[170:171], v[170:171], v[90:91]
    v_pk_mul_f32 v[172:173], v[172:173], v[92:93]
    v_pk_mul_f32 v[174:175], v[174:175], v[94:95]
    v_exp_f32 v176, v160
    v_exp_f32 v177, v161
    v_exp_f32 v178, v162
    v_exp_f32 v179, v163
    v_exp_f32 v180, v164
    v_exp_f32 v181, v165
    v_exp_f32 v182, v166
    v_exp_f32 v183, v167
    v_exp_f32 v184, v168
    v_exp_f32 v185, v169
    v_exp_f32 v186, v170
    v_exp_f32 v187, v171
    v_exp_f32 v188, v172
    v_exp_f32 v189, v173
    v_exp_f32 v190, v174
    v_exp_f32 v191, v175
    v_pk_add_f32 v[176:177], v[176:177], 1.0 op_sel_hi:[1,0]
    v_pk_add_f32 v[178:179], v[178:179], 1.0 op_sel_hi:[1,0]
    v_pk_add_f32 v[180:181], v[180:181], 1.0 op_sel_hi:[1,0]
    v_pk_add_f32 v[182:183], v[182:183], 1.0 op_sel_hi:[1,0]
    v_pk_add_f32 v[184:185], v[184:185], 1.0 op_sel_hi:[1,0]
    v_pk_add_f32 v[186:187], v[186:187], 1.0 op_sel_hi:[1,0]
    v_pk_add_f32 v[188:189], v[188:189], 1.0 op_sel_hi:[1,0]
    v_pk_add_f32 v[190:191], v[190:191], 1.0 op_sel_hi:[1,0]
    v_rcp_f32 v176, v176
    v_rcp_f32 v177, v177
    v_rcp_f32 v178, v178
    v_rcp_f32 v179, v179
    v_rcp_f32 v180, v180
    v_rcp_f32 v181, v181
    v_rcp_f32 v182, v182
    v_rcp_f32 v183, v183
    v_rcp_f32 v184, v184
    v_rcp_f32 v185, v185
    v_rcp_f32 v186, v186
    v_rcp_f32 v187, v187
    v_rcp_f32 v188, v188
    v_rcp_f32 v189, v189
    v_rcp_f32 v190, v190
    v_rcp_f32 v191, v191
    v_pk_mul_f32 v[80:81], v[80:81], v[176:177]
    v_pk_mul_f32 v[82:83], v[82:83], v[178:179]
    v_pk_mul_f32 v[84:85], v[84:85], v[180:181]
    v_pk_mul_f32 v[86:87], v[86:87], v[182:183]
    v_pk_mul_f32 v[88:89], v[88:89], v[184:185]
    v_pk_mul_f32 v[90:91], v[90:91], v[186:187]
    v_pk_mul_f32 v[92:93], v[92:93], v[188:189]
    v_pk_mul_f32 v[94:95], v[94:95], v[190:191]
    v_cvt_pk_bf16_f32 v200, v80, v81
    v_cvt_pk_bf16_f32 v201, v82, v83
    v_cvt_pk_bf16_f32 v202, v84, v85
    v_cvt_pk_bf16_f32 v203, v86, v87
    v_cvt_pk_bf16_f32 v204, v88, v89
    v_cvt_pk_bf16_f32 v205, v90, v91
    v_cvt_pk_bf16_f32 v206, v92, v93
    v_cvt_pk_bf16_f32 v207, v94, v95
    s_mul_i32 s29, s51, 112
    s_lshl_b32 s30, s91, 3
    s_add_u32 s29, s29, s30
    s_add_u32 s29, s29, 2
    s_lshl_b32 s55, s29, 10
    buffer_store_dwordx4 v[200:203], v24, s[12:15], s55 offen sc1
    buffer_store_dwordx4 v[204:207], v24, s[12:15], s55 offen offset:1024 sc1
    s_waitcnt lgkmcnt(0)
    ds_read_b128 v[208:211], v18 offset:384
    ds_read_b128 v[224:227], v18 offset:896
    ds_read_b128 v[212:215], v18 offset:416
    ds_read_b128 v[228:231], v18 offset:928
    ds_read_b128 v[216:219], v18 offset:448
    ds_read_b128 v[232:235], v18 offset:960
    ds_read_b128 v[220:223], v18 offset:480
    ds_read_b128 v[236:239], v18 offset:992
    v_pk_fma_f32 v[144:145], v[128:129], v[240:241], v[144:145] op_sel:[0,1,0] op_sel_hi:[1,1,1] neg_lo:[1,0,0] neg_hi:[1,0,0]
    v_pk_fma_f32 v[146:147], v[130:131], v[240:241], v[146:147] op_sel:[0,1,0] op_sel_hi:[1,1,1] neg_lo:[1,0,0] neg_hi:[1,0,0]
    v_pk_fma_f32 v[148:149], v[132:133], v[240:241], v[148:149] op_sel:[0,1,0] op_sel_hi:[1,1,1] neg_lo:[1,0,0] neg_hi:[1,0,0]
    v_pk_fma_f32 v[150:151], v[134:135], v[240:241], v[150:151] op_sel:[0,1,0] op_sel_hi:[1,1,1] neg_lo:[1,0,0] neg_hi:[1,0,0]
    v_pk_fma_f32 v[152:153], v[136:137], v[240:241], v[152:153] op_sel:[0,1,0] op_sel_hi:[1,1,1] neg_lo:[1,0,0] neg_hi:[1,0,0]
    v_pk_fma_f32 v[154:155], v[138:139], v[240:241], v[154:155] op_sel:[0,1,0] op_sel_hi:[1,1,1] neg_lo:[1,0,0] neg_hi:[1,0,0]
    v_pk_fma_f32 v[156:157], v[140:141], v[240:241], v[156:157] op_sel:[0,1,0] op_sel_hi:[1,1,1] neg_lo:[1,0,0] neg_hi:[1,0,0]
    v_pk_fma_f32 v[158:159], v[142:143], v[240:241], v[158:159] op_sel:[0,1,0] op_sel_hi:[1,1,1] neg_lo:[1,0,0] neg_hi:[1,0,0]
    v_pk_fma_f32 v[96:97], v[96:97], v[240:241], v[144:145] op_sel_hi:[1,0,1]
    v_pk_fma_f32 v[98:99], v[98:99], v[240:241], v[146:147] op_sel_hi:[1,0,1]
    v_pk_fma_f32 v[100:101], v[100:101], v[240:241], v[148:149] op_sel_hi:[1,0,1]
    v_pk_fma_f32 v[102:103], v[102:103], v[240:241], v[150:151] op_sel_hi:[1,0,1]
    v_pk_fma_f32 v[104:105], v[104:105], v[240:241], v[152:153] op_sel_hi:[1,0,1]
    v_pk_fma_f32 v[106:107], v[106:107], v[240:241], v[154:155] op_sel_hi:[1,0,1]
    v_pk_fma_f32 v[108:109], v[108:109], v[240:241], v[156:157] op_sel_hi:[1,0,1]
    v_pk_fma_f32 v[110:111], v[110:111], v[240:241], v[158:159] op_sel_hi:[1,0,1]
    v_pk_mul_f32 v[160:161], v[96:97], v[96:97]
    v_pk_mul_f32 v[162:163], v[98:99], v[98:99]
    v_pk_mul_f32 v[164:165], v[100:101], v[100:101]
    v_pk_mul_f32 v[166:167], v[102:103], v[102:103]
    v_pk_mul_f32 v[168:169], v[104:105], v[104:105]
    v_pk_mul_f32 v[170:171], v[106:107], v[106:107]
    v_pk_mul_f32 v[172:173], v[108:109], v[108:109]
    v_pk_mul_f32 v[174:175], v[110:111], v[110:111]
    v_pk_fma_f32 v[160:161], v[160:161], s[56:57], s[56:57] op_sel:[0,1,0] op_sel_hi:[1,1,0]
    v_pk_fma_f32 v[162:163], v[162:163], s[56:57], s[56:57] op_sel:[0,1,0] op_sel_hi:[1,1,0]
    v_pk_fma_f32 v[164:165], v[164:165], s[56:57], s[56:57] op_sel:[0,1,0] op_sel_hi:[1,1,0]
    v_pk_fma_f32 v[166:167], v[166:167], s[56:57], s[56:57] op_sel:[0,1,0] op_sel_hi:[1,1,0]
    v_pk_fma_f32 v[168:169], v[168:169], s[56:57], s[56:57] op_sel:[0,1,0] op_sel_hi:[1,1,0]
    v_pk_fma_f32 v[170:171], v[170:171], s[56:57], s[56:57] op_sel:[0,1,0] op_sel_hi:[1,1,0]
    v_pk_fma_f32 v[172:173], v[172:173], s[56:57], s[56:57] op_sel:[0,1,0] op_sel_hi:[1,1,0]
    v_pk_fma_f32 v[174:175], v[174:175], s[56:57], s[56:57] op_sel:[0,1,0] op_sel_hi:[1,1,0]
    v_pk_mul_f32 v[160:161], v[160:161], v[96:97]
    v_pk_mul_f32 v[162:163], v[162:163], v[98:99]
    v_pk_mul_f32 v[164:165], v[164:165], v[100:101]
    v_pk_mul_f32 v[166:167], v[166:167], v[102:103]
    v_pk_mul_f32 v[168:169], v[168:169], v[104:105]
    v_pk_mul_f32 v[170:171], v[170:171], v[106:107]
    v_pk_mul_f32 v[172:173], v[172:173], v[108:109]
    v_pk_mul_f32 v[174:175], v[174:175], v[110:111]
    v_exp_f32 v176, v160
    v_exp_f32 v177, v161
    v_exp_f32 v178, v162
    v_exp_f32 v179, v163
    v_exp_f32 v180, v164
    v_exp_f32 v181, v165
    v_exp_f32 v182, v166
    v_exp_f32 v183, v167
    v_exp_f32 v184, v168
    v_exp_f32 v185, v169
    v_exp_f32 v186, v170
    v_exp_f32 v187, v171
    v_exp_f32 v188, v172
    v_exp_f32 v189, v173
    v_exp_f32 v190, v174
    v_exp_f32 v191, v175
    v_pk_add_f32 v[176:177], v[176:177], 1.0 op_sel_hi:[1,0]
    v_pk_add_f32 v[178:179], v[178:179], 1.0 op_sel_hi:[1,0]
    v_pk_add_f32 v[180:181], v[180:181], 1.0 op_sel_hi:[1,0]
    v_pk_add_f32 v[182:183], v[182:183], 1.0 op_sel_hi:[1,0]
    v_pk_add_f32 v[184:185], v[184:185], 1.0 op_sel_hi:[1,0]
    v_pk_add_f32 v[186:187], v[186:187], 1.0 op_sel_hi:[1,0]
    v_pk_add_f32 v[188:189], v[188:189], 1.0 op_sel_hi:[1,0]
    v_pk_add_f32 v[190:191], v[190:191], 1.0 op_sel_hi:[1,0]
    v_rcp_f32 v176, v176
    v_rcp_f32 v177, v177
    v_rcp_f32 v178, v178
    v_rcp_f32 v179, v179
    v_rcp_f32 v180, v180
    v_rcp_f32 v181, v181
    v_rcp_f32 v182, v182
    v_rcp_f32 v183, v183
    v_rcp_f32 v184, v184
    v_rcp_f32 v185, v185
    v_rcp_f32 v186, v186
    v_rcp_f32 v187, v187
    v_rcp_f32 v188, v188
    v_rcp_f32 v189, v189
    v_rcp_f32 v190, v190
    v_rcp_f32 v191, v191
    v_pk_mul_f32 v[96:97], v[96:97], v[176:177]
    v_pk_mul_f32 v[98:99], v[98:99], v[178:179]
    v_pk_mul_f32 v[100:101], v[100:101], v[180:181]
    v_pk_mul_f32 v[102:103], v[102:103], v[182:183]
    v_pk_mul_f32 v[104:105], v[104:105], v[184:185]
    v_pk_mul_f32 v[106:107], v[106:107], v[186:187]
    v_pk_mul_f32 v[108:109], v[108:109], v[188:189]
    v_pk_mul_f32 v[110:111], v[110:111], v[190:191]
    v_cvt_pk_bf16_f32 v192, v96, v97
    v_cvt_pk_bf16_f32 v193, v98, v99
    v_cvt_pk_bf16_f32 v194, v100, v101
    v_cvt_pk_bf16_f32 v195, v102, v103
    v_cvt_pk_bf16_f32 v196, v104, v105
    v_cvt_pk_bf16_f32 v197, v106, v107
    v_cvt_pk_bf16_f32 v198, v108, v109
    v_cvt_pk_bf16_f32 v199, v110, v111
    s_mul_i32 s29, s51, 112
    s_lshl_b32 s30, s91, 3
    s_add_u32 s29, s29, s30
    s_add_u32 s29, s29, 4
    s_lshl_b32 s55, s29, 10
    buffer_store_dwordx4 v[192:195], v24, s[12:15], s55 offen sc1
    buffer_store_dwordx4 v[196:199], v24, s[12:15], s55 offen offset:1024 sc1
    s_waitcnt lgkmcnt(0)
    v_pk_fma_f32 v[224:225], v[208:209], v[240:241], v[224:225] op_sel:[0,1,0] op_sel_hi:[1,1,1] neg_lo:[1,0,0] neg_hi:[1,0,0]
    v_pk_fma_f32 v[226:227], v[210:211], v[240:241], v[226:227] op_sel:[0,1,0] op_sel_hi:[1,1,1] neg_lo:[1,0,0] neg_hi:[1,0,0]
    v_pk_fma_f32 v[228:229], v[212:213], v[240:241], v[228:229] op_sel:[0,1,0] op_sel_hi:[1,1,1] neg_lo:[1,0,0] neg_hi:[1,0,0]
    v_pk_fma_f32 v[230:231], v[214:215], v[240:241], v[230:231] op_sel:[0,1,0] op_sel_hi:[1,1,1] neg_lo:[1,0,0] neg_hi:[1,0,0]
    v_pk_fma_f32 v[232:233], v[216:217], v[240:241], v[232:233] op_sel:[0,1,0] op_sel_hi:[1,1,1] neg_lo:[1,0,0] neg_hi:[1,0,0]
    v_pk_fma_f32 v[234:235], v[218:219], v[240:241], v[234:235] op_sel:[0,1,0] op_sel_hi:[1,1,1] neg_lo:[1,0,0] neg_hi:[1,0,0]
    v_pk_fma_f32 v[236:237], v[220:221], v[240:241], v[236:237] op_sel:[0,1,0] op_sel_hi:[1,1,1] neg_lo:[1,0,0] neg_hi:[1,0,0]
    v_pk_fma_f32 v[238:239], v[222:223], v[240:241], v[238:239] op_sel:[0,1,0] op_sel_hi:[1,1,1] neg_lo:[1,0,0] neg_hi:[1,0,0]
    v_pk_fma_f32 v[112:113], v[112:113], v[240:241], v[224:225] op_sel_hi:[1,0,1]
    v_pk_fma_f32 v[114:115], v[114:115], v[240:241], v[226:227] op_sel_hi:[1,0,1]
    v_pk_fma_f32 v[116:117], v[116:117], v[240:241], v[228:229] op_sel_hi:[1,0,1]
    v_pk_fma_f32 v[118:119], v[118:119], v[240:241], v[230:231] op_sel_hi:[1,0,1]
    v_pk_fma_f32 v[120:121], v[120:121], v[240:241], v[232:233] op_sel_hi:[1,0,1]
    v_pk_fma_f32 v[122:123], v[122:123], v[240:241], v[234:235] op_sel_hi:[1,0,1]
    v_pk_fma_f32 v[124:125], v[124:125], v[240:241], v[236:237] op_sel_hi:[1,0,1]
    v_pk_fma_f32 v[126:127], v[126:127], v[240:241], v[238:239] op_sel_hi:[1,0,1]
    v_pk_mul_f32 v[160:161], v[112:113], v[112:113]
    v_pk_mul_f32 v[162:163], v[114:115], v[114:115]
    v_pk_mul_f32 v[164:165], v[116:117], v[116:117]
    v_pk_mul_f32 v[166:167], v[118:119], v[118:119]
    v_pk_mul_f32 v[168:169], v[120:121], v[120:121]
    v_pk_mul_f32 v[170:171], v[122:123], v[122:123]
    v_pk_mul_f32 v[172:173], v[124:125], v[124:125]
    v_pk_mul_f32 v[174:175], v[126:127], v[126:127]
    v_pk_fma_f32 v[160:161], v[160:161], s[56:57], s[56:57] op_sel:[0,1,0] op_sel_hi:[1,1,0]
    v_pk_fma_f32 v[162:163], v[162:163], s[56:57], s[56:57] op_sel:[0,1,0] op_sel_hi:[1,1,0]
    v_pk_fma_f32 v[164:165], v[164:165], s[56:57], s[56:57] op_sel:[0,1,0] op_sel_hi:[1,1,0]
    v_pk_fma_f32 v[166:167], v[166:167], s[56:57], s[56:57] op_sel:[0,1,0] op_sel_hi:[1,1,0]
    v_pk_fma_f32 v[168:169], v[168:169], s[56:57], s[56:57] op_sel:[0,1,0] op_sel_hi:[1,1,0]
    v_pk_fma_f32 v[170:171], v[170:171], s[56:57], s[56:57] op_sel:[0,1,0] op_sel_hi:[1,1,0]
    v_pk_fma_f32 v[172:173], v[172:173], s[56:57], s[56:57] op_sel:[0,1,0] op_sel_hi:[1,1,0]
    v_pk_fma_f32 v[174:175], v[174:175], s[56:57], s[56:57] op_sel:[0,1,0] op_sel_hi:[1,1,0]
    v_pk_mul_f32 v[160:161], v[160:161], v[112:113]
    v_pk_mul_f32 v[162:163], v[162:163], v[114:115]
    v_pk_mul_f32 v[164:165], v[164:165], v[116:117]
    v_pk_mul_f32 v[166:167], v[166:167], v[118:119]
    v_pk_mul_f32 v[168:169], v[168:169], v[120:121]
    v_pk_mul_f32 v[170:171], v[170:171], v[122:123]
    v_pk_mul_f32 v[172:173], v[172:173], v[124:125]
    v_pk_mul_f32 v[174:175], v[174:175], v[126:127]
    v_exp_f32 v176, v160
    v_exp_f32 v177, v161
    v_exp_f32 v178, v162
    v_exp_f32 v179, v163
    v_exp_f32 v180, v164
    v_exp_f32 v181, v165
    v_exp_f32 v182, v166
    v_exp_f32 v183, v167
    v_exp_f32 v184, v168
    v_exp_f32 v185, v169
    v_exp_f32 v186, v170
    v_exp_f32 v187, v171
    v_exp_f32 v188, v172
    v_exp_f32 v189, v173
    v_exp_f32 v190, v174
    v_exp_f32 v191, v175
    v_pk_add_f32 v[176:177], v[176:177], 1.0 op_sel_hi:[1,0]
    v_pk_add_f32 v[178:179], v[178:179], 1.0 op_sel_hi:[1,0]
    v_pk_add_f32 v[180:181], v[180:181], 1.0 op_sel_hi:[1,0]
    v_pk_add_f32 v[182:183], v[182:183], 1.0 op_sel_hi:[1,0]
    v_pk_add_f32 v[184:185], v[184:185], 1.0 op_sel_hi:[1,0]
    v_pk_add_f32 v[186:187], v[186:187], 1.0 op_sel_hi:[1,0]
    v_pk_add_f32 v[188:189], v[188:189], 1.0 op_sel_hi:[1,0]
    v_pk_add_f32 v[190:191], v[190:191], 1.0 op_sel_hi:[1,0]
    v_rcp_f32 v176, v176
    v_rcp_f32 v177, v177
    v_rcp_f32 v178, v178
    v_rcp_f32 v179, v179
    v_rcp_f32 v180, v180
    v_rcp_f32 v181, v181
    v_rcp_f32 v182, v182
    v_rcp_f32 v183, v183
    v_rcp_f32 v184, v184
    v_rcp_f32 v185, v185
    v_rcp_f32 v186, v186
    v_rcp_f32 v187, v187
    v_rcp_f32 v188, v188
    v_rcp_f32 v189, v189
    v_rcp_f32 v190, v190
    v_rcp_f32 v191, v191
    v_pk_mul_f32 v[112:113], v[112:113], v[176:177]
    v_pk_mul_f32 v[114:115], v[114:115], v[178:179]
    v_pk_mul_f32 v[116:117], v[116:117], v[180:181]
    v_pk_mul_f32 v[118:119], v[118:119], v[182:183]
    v_pk_mul_f32 v[120:121], v[120:121], v[184:185]
    v_pk_mul_f32 v[122:123], v[122:123], v[186:187]
    v_pk_mul_f32 v[124:125], v[124:125], v[188:189]
    v_pk_mul_f32 v[126:127], v[126:127], v[190:191]
    v_cvt_pk_bf16_f32 v200, v112, v113
    v_cvt_pk_bf16_f32 v201, v114, v115
    v_cvt_pk_bf16_f32 v202, v116, v117
    v_cvt_pk_bf16_f32 v203, v118, v119
    v_cvt_pk_bf16_f32 v204, v120, v121
    v_cvt_pk_bf16_f32 v205, v122, v123
    v_cvt_pk_bf16_f32 v206, v124, v125
    v_cvt_pk_bf16_f32 v207, v126, v127
    s_mul_i32 s29, s51, 112
    s_lshl_b32 s30, s91, 3
    s_add_u32 s29, s29, s30
    s_add_u32 s29, s29, 6
    s_lshl_b32 s55, s29, 10
    buffer_store_dwordx4 v[200:203], v24, s[12:15], s55 offen sc1
    buffer_store_dwordx4 v[204:207], v24, s[12:15], s55 offen offset:1024 sc1
    s_waitcnt vmcnt(0)
    s_barrier
    s_mov_b32 s31, 0
    s_cmp_lg_u32 s24, 0
    s_cbranch_scc1 attn_kernel_oB
    s_lshl_b32 s29, s90, 7
    s_add_u32 s29, s29, 19924992
    v_mov_b32 v2, s29
    v_mov_b32 v3, 1
    s_mov_b64 exec, 1
    global_atomic_add v2, v3, s[34:35]
attn_kernel_pB:
    global_load_dword v4, v2, s[34:35] sc1
    s_add_u32 s31, s31, 1
    s_waitcnt vmcnt(0)
    v_readfirstlane_b32 s30, v4
    s_nop 1
    s_cmp_ge_u32 s31, 0x100000
    s_cbranch_scc1 attn_kernel_qB
    s_cmp_ge_u32 s30, 14
    s_cbranch_scc1 attn_kernel_qB
    s_sleep 3
    s_branch attn_kernel_pB
attn_kernel_qB:
    s_mov_b64 exec, -1
attn_kernel_oB:
    s_barrier
attn_kernel_C:
    v_lshrrev_b32 v2, 3, v0
    v_and_b32 v3, 7, v0
    v_bfe_u32 v4, v0, 4, 1
    v_lshlrev_b32 v4, 2, v4
    v_xor_b32 v3, v3, v4
    v_mul_u32_u24 v2, 896, v2
    v_lshl_add_u32 v10, v3, 4, v2
    v_lshlrev_b32 v11, 4, v0
    s_mul_i32 s42, s24, 28672
    s_lshl_b32 s30, s26, 7
    s_add_u32 s42, s42, s30
    s_mul_i32 s43, s25, 229376
    s_lshl_b32 s30, s24, 11
    s_add_u32 s43, s43, s30
    s_lshl_b32 s44, s24, 14
    s_mov_b32 s4, s84
    s_mov_b32 s5, s85
    s_mov_b32 s6, 1605632
    s_mov_b32 s7, 0x00020000
    s_add_u32 s8, s34, 10485760
    s_addc_u32 s9, s35, 0
    s_mov_b32 s10, 7340032
    s_mov_b32 s11, 0x00020000
    s_add_u32 s30, s43, 0
    buffer_load_dwordx4 v[128:131], v11, s[8:11], s30 offen sc1
    s_add_u32 s30, s43, 114688
    buffer_load_dwordx4 v[132:135], v11, s[8:11], s30 offen sc1
    s_add_u32 s30, s43, 1024
    buffer_load_dwordx4 v[136:139], v11, s[8:11], s30 offen sc1
    s_add_u32 s30, s43, 115712
    buffer_load_dwordx4 v[140:143], v11, s[8:11], s30 offen sc1
    s_add_u32 s30, s43, 16384
    buffer_load_dwordx4 v[144:147], v11, s[8:11], s30 offen sc1
    s_add_u32 s30, s43, 131072
    buffer_load_dwordx4 v[148:151], v11, s[8:11], s30 offen sc1
    s_add_u32 s30, s43, 17408
    buffer_load_dwordx4 v[152:155], v11, s[8:11], s30 offen sc1
    s_add_u32 s30, s43, 132096
    buffer_load_dwordx4 v[156:159], v11, s[8:11], s30 offen sc1
    s_add_u32 s30, s43, 32768
    buffer_load_dwordx4 v[160:163], v11, s[8:11], s30 offen sc1
    s_add_u32 s30, s43, 147456
    buffer_load_dwordx4 v[164:167], v11, s[8:11], s30 offen sc1
    s_add_u32 s30, s43, 33792
    buffer_load_dwordx4 v[168:171], v11, s[8:11], s30 offen sc1
    s_add_u32 s30, s43, 148480
    buffer_load_dwordx4 v[172:175], v11, s[8:11], s30 offen sc1
    s_add_u32 s30, s43, 49152
    buffer_load_dwordx4 v[176:179], v11, s[8:11], s30 offen sc1
    s_add_u32 s30, s43, 163840
    buffer_load_dwordx4 v[180:183], v11, s[8:11], s30 offen sc1
    s_add_u32 s30, s43, 50176
    buffer_load_dwordx4 v[184:187], v11, s[8:11], s30 offen sc1
    s_add_u32 s30, s43, 164864
    buffer_load_dwordx4 v[188:191], v11, s[8:11], s30 offen sc1
    v_lshrrev_b32 v12, 5, v0
    v_and_b32 v15, 31, v0
    s_lshr_b32 s48, s24, 2
    s_bfe_u32 s50, s24, 0x10001
    s_and_b32 s53, s24, 1
    s_lshl_b32 s29, s25, 1
    s_add_u32 s51, s29, s50
    s_lshl_b32 s29, s26, 1
    s_add_u32 s49, s29, s48
    s_lshl_b32 s29, s51, 5
    v_add_u32 v16, s29, v15
    v_mul_u32_u24 v16, 896, v16
    v_lshl_add_u32 v16, v12, 3, v16
    s_lshl_b32 s52, s49, 6
    s_lshl_b32 s29, s53, 5
    s_add_u32 s52, s52, s29
    s_mul_i32 s29, s51, 28
    s_lshl_b32 s30, s49, 1
    s_add_u32 s29, s29, s30
    s_add_u32 s29, s29, s53
    s_lshl_b32 s55, s29, 10
    s_mov_b32 s12, s40
    s_mov_b32 s13, s41
    s_mov_b32 s14, 1835008
    s_mov_b32 s15, 0x00020000
    s_mov_b32 s16, s38
    s_mov_b32 s17, s39
    s_mov_b32 s18, 896
    s_mov_b32 s19, 0x00020000
    v_lshlrev_b32 v17, 3, v12
    buffer_load_dwordx2 v[212:213], v17, s[16:19], s52 offen offset:0
    buffer_load_dwordx2 v[214:215], v17, s[16:19], s52 offen offset:16
    v_bfe_u32 v13, v0, 2, 2
    v_and_b32 v14, 3, v0
    v_bfe_u32 v18, v0, 4, 1
    v_lshl_add_u32 v19, v12, 2, v13
    v_lshlrev_b32 v19, 7, v19
    v_add_u32 v19, s44, v19
    v_and_b32 v20, 1, v14
    v_lshl_add_u32 v19, v20, 3, v19
    v_lshrrev_b32 v20, 1, v14
    v_lshl_add_u32 v20, v18, 1, v20
    v_lshrrev_b32 v21, 1, v13
    v_lshlrev_b32 v21, 2, v21
    v_xor_b32 v22, v20, v21
    v_lshl_add_u32 v2, v22, 4, v19
    v_add_u32 v20, 4, v20
    v_xor_b32 v22, v20, v21
    v_lshl_add_u32 v4, v22, 4, v19
    s_waitcnt vmcnt(14)
    ds_read_b64_tr_b16 v[192:193], v2 offset:0
    ds_read_b64_tr_b16 v[194:195], v2 offset:1024
    ds_read_b64_tr_b16 v[196:197], v4 offset:0
    ds_read_b64_tr_b16 v[198:199], v4 offset:1024
    ds_read_b64_tr_b16 v[200:201], v2 offset:2048
    ds_read_b64_tr_b16 v[202:203], v2 offset:3072
    ds_read_b64_tr_b16 v[204:205], v4 offset:2048
    ds_read_b64_tr_b16 v[206:207], v4 offset:3072
    s_waitcnt lgkmcnt(4)
    v_mfma_f32_32x32x16_bf16 v[64:79], v[192:195], v[128:131], 0
    v_mfma_f32_32x32x16_bf16 v[80:95], v[192:195], v[132:135], 0
    v_mfma_f32_32x32x16_bf16 v[96:111], v[196:199], v[128:131], 0
    v_mfma_f32_32x32x16_bf16 v[112:127], v[196:199], v[132:135], 0
    s_waitcnt lgkmcnt(0)
    v_mfma_f32_32x32x16_bf16 v[64:79], v[200:203], v[136:139], v[64:79]
    v_mfma_f32_32x32x16_bf16 v[80:95], v[200:203], v[140:143], v[80:95]
    v_mfma_f32_32x32x16_bf16 v[96:111], v[204:207], v[136:139], v[96:111]
    v_mfma_f32_32x32x16_bf16 v[112:127], v[204:207], v[140:143], v[112:127]
    s_add_u32 m0, s44, 0
    s_add_u32 s30, s42, 917504
    buffer_load_dwordx4 v10, s[4:7], s30 offen lds
    s_add_u32 m0, s44, 1024
    s_add_u32 s30, s42, 924672
    buffer_load_dwordx4 v10, s[4:7], s30 offen lds
    s_add_u32 m0, s44, 2048
    s_add_u32 s30, s42, 931840
    buffer_load_dwordx4 v10, s[4:7], s30 offen lds
    s_add_u32 m0, s44, 3072
    s_add_u32 s30, s42, 939008
    buffer_load_dwordx4 v10, s[4:7], s30 offen lds
    s_add_u32 s30, s43, 65536
    buffer_load_dwordx4 v[128:131], v11, s[8:11], s30 offen sc1
    s_add_u32 s30, s43, 180224
    buffer_load_dwordx4 v[132:135], v11, s[8:11], s30 offen sc1
    s_add_u32 s30, s43, 66560
    buffer_load_dwordx4 v[136:139], v11, s[8:11], s30 offen sc1
    s_add_u32 s30, s43, 181248
    buffer_load_dwordx4 v[140:143], v11, s[8:11], s30 offen sc1
    s_waitcnt vmcnt(18)
    ds_read_b64_tr_b16 v[192:193], v2 offset:4096
    ds_read_b64_tr_b16 v[194:195], v2 offset:5120
    ds_read_b64_tr_b16 v[196:197], v4 offset:4096
    ds_read_b64_tr_b16 v[198:199], v4 offset:5120
    ds_read_b64_tr_b16 v[200:201], v2 offset:6144
    ds_read_b64_tr_b16 v[202:203], v2 offset:7168
    ds_read_b64_tr_b16 v[204:205], v4 offset:6144
    ds_read_b64_tr_b16 v[206:207], v4 offset:7168
    s_waitcnt lgkmcnt(4)
    v_mfma_f32_32x32x16_bf16 v[64:79], v[192:195], v[144:147], v[64:79]
    v_mfma_f32_32x32x16_bf16 v[80:95], v[192:195], v[148:151], v[80:95]
    v_mfma_f32_32x32x16_bf16 v[96:111], v[196:199], v[144:147], v[96:111]
    v_mfma_f32_32x32x16_bf16 v[112:127], v[196:199], v[148:151], v[112:127]
    s_waitcnt lgkmcnt(0)
    v_mfma_f32_32x32x16_bf16 v[64:79], v[200:203], v[152:155], v[64:79]
    v_mfma_f32_32x32x16_bf16 v[80:95], v[200:203], v[156:159], v[80:95]
    v_mfma_f32_32x32x16_bf16 v[96:111], v[204:207], v[152:155], v[96:111]
    v_mfma_f32_32x32x16_bf16 v[112:127], v[204:207], v[156:159], v[112:127]
    s_add_u32 m0, s44, 4096
    s_add_u32 s30, s42, 1146880
    buffer_load_dwordx4 v10, s[4:7], s30 offen lds
    s_add_u32 m0, s44, 5120
    s_add_u32 s30, s42, 1154048
    buffer_load_dwordx4 v10, s[4:7], s30 offen lds
    s_add_u32 m0, s44, 6144
    s_add_u32 s30, s42, 1161216
    buffer_load_dwordx4 v10, s[4:7], s30 offen lds
    s_add_u32 m0, s44, 7168
    s_add_u32 s30, s42, 1168384
    buffer_load_dwordx4 v10, s[4:7], s30 offen lds
    s_add_u32 s30, s43, 81920
    buffer_load_dwordx4 v[144:147], v11, s[8:11], s30 offen sc1
    s_add_u32 s30, s43, 196608
    buffer_load_dwordx4 v[148:151], v11, s[8:11], s30 offen sc1
    s_add_u32 s30, s43, 82944
    buffer_load_dwordx4 v[152:155], v11, s[8:11], s30 offen sc1
    s_add_u32 s30, s43, 197632
    buffer_load_dwordx4 v[156:159], v11, s[8:11], s30 offen sc1
    s_waitcnt vmcnt(22)
    ds_read_b64_tr_b16 v[192:193], v2 offset:8192
    ds_read_b64_tr_b16 v[194:195], v2 offset:9216
    ds_read_b64_tr_b16 v[196:197], v4 offset:8192
    ds_read_b64_tr_b16 v[198:199], v4 offset:9216
    ds_read_b64_tr_b16 v[200:201], v2 offset:10240
    ds_read_b64_tr_b16 v[202:203], v2 offset:11264
    ds_read_b64_tr_b16 v[204:205], v4 offset:10240
    ds_read_b64_tr_b16 v[206:207], v4 offset:11264
    s_waitcnt lgkmcnt(4)
    v_mfma_f32_32x32x16_bf16 v[64:79], v[192:195], v[160:163], v[64:79]
    v_mfma_f32_32x32x16_bf16 v[80:95], v[192:195], v[164:167], v[80:95]
    v_mfma_f32_32x32x16_bf16 v[96:111], v[196:199], v[160:163], v[96:111]
    v_mfma_f32_32x32x16_bf16 v[112:127], v[196:199], v[164:167], v[112:127]
    s_waitcnt lgkmcnt(0)
    v_mfma_f32_32x32x16_bf16 v[64:79], v[200:203], v[168:171], v[64:79]
    v_mfma_f32_32x32x16_bf16 v[80:95], v[200:203], v[172:175], v[80:95]
    v_mfma_f32_32x32x16_bf16 v[96:111], v[204:207], v[168:171], v[96:111]
    v_mfma_f32_32x32x16_bf16 v[112:127], v[204:207], v[172:175], v[112:127]
    s_add_u32 m0, s44, 8192
    s_add_u32 s30, s42, 1376256
    buffer_load_dwordx4 v10, s[4:7], s30 offen lds
    s_add_u32 m0, s44, 9216
    s_add_u32 s30, s42, 1383424
    buffer_load_dwordx4 v10, s[4:7], s30 offen lds
    s_add_u32 m0, s44, 10240
    s_add_u32 s30, s42, 1390592
    buffer_load_dwordx4 v10, s[4:7], s30 offen lds
    s_add_u32 m0, s44, 11264
    s_add_u32 s30, s42, 1397760
    buffer_load_dwordx4 v10, s[4:7], s30 offen lds
    s_add_u32 s30, s43, 98304
    buffer_load_dwordx4 v[160:163], v11, s[8:11], s30 offen sc1
    s_add_u32 s30, s43, 212992
    buffer_load_dwordx4 v[164:167], v11, s[8:11], s30 offen sc1
    s_add_u32 s30, s43, 99328
    buffer_load_dwordx4 v[168:171], v11, s[8:11], s30 offen sc1
    s_add_u32 s30, s43, 214016
    buffer_load_dwordx4 v[172:175], v11, s[8:11], s30 offen sc1
    s_waitcnt vmcnt(26)
    ds_read_b64_tr_b16 v[192:193], v2 offset:12288
    ds_read_b64_tr_b16 v[194:195], v2 offset:13312
    ds_read_b64_tr_b16 v[196:197], v4 offset:12288
    ds_read_b64_tr_b16 v[198:199], v4 offset:13312
    ds_read_b64_tr_b16 v[200:201], v2 offset:14336
    ds_read_b64_tr_b16 v[202:203], v2 offset:15360
    ds_read_b64_tr_b16 v[204:205], v4 offset:14336
    ds_read_b64_tr_b16 v[206:207], v4 offset:15360
    s_waitcnt lgkmcnt(4)
    v_mfma_f32_32x32x16_bf16 v[64:79], v[192:195], v[176:179], v[64:79]
    v_mfma_f32_32x32x16_bf16 v[80:95], v[192:195], v[180:183], v[80:95]
    v_mfma_f32_32x32x16_bf16 v[96:111], v[196:199], v[176:179], v[96:111]
    v_mfma_f32_32x32x16_bf16 v[112:127], v[196:199], v[180:183], v[112:127]
    s_waitcnt lgkmcnt(0)
    v_mfma_f32_32x32x16_bf16 v[64:79], v[200:203], v[184:187], v[64:79]
    v_mfma_f32_32x32x16_bf16 v[80:95], v[200:203], v[188:191], v[80:95]
    v_mfma_f32_32x32x16_bf16 v[96:111], v[204:207], v[184:187], v[96:111]
    v_mfma_f32_32x32x16_bf16 v[112:127], v[204:207], v[188:191], v[112:127]
    s_waitcnt vmcnt(16)
    ds_read_b64_tr_b16 v[192:193], v2 offset:0
    ds_read_b64_tr_b16 v[194:195], v2 offset:1024
    ds_read_b64_tr_b16 v[196:197], v4 offset:0
    ds_read_b64_tr_b16 v[198:199], v4 offset:1024
    ds_read_b64_tr_b16 v[200:201], v2 offset:2048
    ds_read_b64_tr_b16 v[202:203], v2 offset:3072
    ds_read_b64_tr_b16 v[204:205], v4 offset:2048
    ds_read_b64_tr_b16 v[206:207], v4 offset:3072
    s_waitcnt lgkmcnt(4)
    v_mfma_f32_32x32x16_bf16 v[64:79], v[192:195], v[128:131], v[64:79]
    v_mfma_f32_32x32x16_bf16 v[80:95], v[192:195], v[132:135], v[80:95]
    v_mfma_f32_32x32x16_bf16 v[96:111], v[196:199], v[128:131], v[96:111]
    v_mfma_f32_32x32x16_bf16 v[112:127], v[196:199], v[132:135], v[112:127]
    s_waitcnt lgkmcnt(0)
    v_mfma_f32_32x32x16_bf16 v[64:79], v[200:203], v[136:139], v[64:79]
    v_mfma_f32_32x32x16_bf16 v[80:95], v[200:203], v[140:143], v[80:95]
    v_mfma_f32_32x32x16_bf16 v[96:111], v[204:207], v[136:139], v[96:111]
    v_mfma_f32_32x32x16_bf16 v[112:127], v[204:207], v[140:143], v[112:127]
    s_waitcnt vmcnt(8)
    ds_read_b64_tr_b16 v[192:193], v2 offset:4096
    ds_read_b64_tr_b16 v[194:195], v2 offset:5120
    ds_read_b64_tr_b16 v[196:197], v4 offset:4096
    ds_read_b64_tr_b16 v[198:199], v4 offset:5120
    ds_read_b64_tr_b16 v[200:201], v2 offset:6144
    ds_read_b64_tr_b16 v[202:203], v2 offset:7168
    ds_read_b64_tr_b16 v[204:205], v4 offset:6144
    ds_read_b64_tr_b16 v[206:207], v4 offset:7168
    s_waitcnt lgkmcnt(4)
    v_mfma_f32_32x32x16_bf16 v[64:79], v[192:195], v[144:147], v[64:79]
    v_mfma_f32_32x32x16_bf16 v[80:95], v[192:195], v[148:151], v[80:95]
    v_mfma_f32_32x32x16_bf16 v[96:111], v[196:199], v[144:147], v[96:111]
    v_mfma_f32_32x32x16_bf16 v[112:127], v[196:199], v[148:151], v[112:127]
    s_waitcnt lgkmcnt(0)
    v_mfma_f32_32x32x16_bf16 v[64:79], v[200:203], v[152:155], v[64:79]
    v_mfma_f32_32x32x16_bf16 v[80:95], v[200:203], v[156:159], v[80:95]
    v_mfma_f32_32x32x16_bf16 v[96:111], v[204:207], v[152:155], v[96:111]
    v_mfma_f32_32x32x16_bf16 v[112:127], v[204:207], v[156:159], v[112:127]
    s_waitcnt vmcnt(0)
    ds_read_b64_tr_b16 v[192:193], v2 offset:8192
    ds_read_b64_tr_b16 v[194:195], v2 offset:9216
    ds_read_b64_tr_b16 v[196:197], v4 offset:8192
    ds_read_b64_tr_b16 v[198:199], v4 offset:9216
    ds_read_b64_tr_b16 v[200:201], v2 offset:10240
    ds_read_b64_tr_b16 v[202:203], v2 offset:11264
    ds_read_b64_tr_b16 v[204:205], v4 offset:10240
    ds_read_b64_tr_b16 v[206:207], v4 offset:11264
    s_waitcnt lgkmcnt(4)
    v_mfma_f32_32x32x16_bf16 v[64:79], v[192:195], v[160:163], v[64:79]
    v_mfma_f32_32x32x16_bf16 v[80:95], v[192:195], v[164:167], v[80:95]
    v_mfma_f32_32x32x16_bf16 v[96:111], v[196:199], v[160:163], v[96:111]
    v_mfma_f32_32x32x16_bf16 v[112:127], v[196:199], v[164:167], v[112:127]
    s_waitcnt lgkmcnt(0)
    v_mfma_f32_32x32x16_bf16 v[64:79], v[200:203], v[168:171], v[64:79]
    v_mfma_f32_32x32x16_bf16 v[80:95], v[200:203], v[172:175], v[80:95]
    v_mfma_f32_32x32x16_bf16 v[96:111], v[204:207], v[168:171], v[96:111]
    v_mfma_f32_32x32x16_bf16 v[112:127], v[204:207], v[172:175], v[112:127]
    v_add_u32 v17, s44, v11
    s_nop 7
    ds_write_b128 v17, v[64:67] offset:0
    ds_write_b128 v17, v[68:71] offset:1024
    ds_write_b128 v17, v[72:75] offset:2048
    ds_write_b128 v17, v[76:79] offset:3072
    ds_write_b128 v17, v[80:83] offset:4096
    ds_write_b128 v17, v[84:87] offset:5120
    ds_write_b128 v17, v[88:91] offset:6144
    ds_write_b128 v17, v[92:95] offset:7168
    ds_write_b128 v17, v[96:99] offset:8192
    ds_write_b128 v17, v[100:103] offset:9216
    ds_write_b128 v17, v[104:107] offset:10240
    ds_write_b128 v17, v[108:111] offset:11264
    ds_write_b128 v17, v[112:115] offset:12288
    ds_write_b128 v17, v[116:119] offset:13312
    ds_write_b128 v17, v[120:123] offset:14336
    ds_write_b128 v17, v[124:127] offset:15360
    s_waitcnt lgkmcnt(0)
    s_barrier
    s_lshl_b32 s29, s24, 11
    v_add_u32 v17, s29, v11
    v_add_u32 v18, 0x10000, v17
    ds_read_b128 v[64:67], v17 offset:0
    ds_read_b128 v[68:71], v17 offset:1024
    ds_read_b128 v[72:75], v17 offset:16384
    ds_read_b128 v[76:79], v17 offset:17408
    ds_read_b128 v[80:83], v17 offset:32768
    ds_read_b128 v[84:87], v17 offset:33792
    ds_read_b128 v[88:91], v17 offset:49152
    ds_read_b128 v[92:95], v17 offset:50176
    ds_read_b128 v[96:99], v18 offset:0
    ds_read_b128 v[100:103], v18 offset:1024
    ds_read_b128 v[104:107], v18 offset:16384
    ds_read_b128 v[108:111], v18 offset:17408
    ds_read_b128 v[112:115], v18 offset:32768
    ds_read_b128 v[116:119], v18 offset:33792
    ds_read_b128 v[120:123], v18 offset:49152
    ds_read_b128 v[124:127], v18 offset:50176
    s_waitcnt vmcnt(0)
    v_and_b32 v225, 0xffff0000, v26
    v_lshlrev_b32 v224, 16, v26
    v_and_b32 v227, 0xffff0000, v27
    v_lshlrev_b32 v226, 16, v27
    v_and_b32 v229, 0xffff0000, v28
    v_lshlrev_b32 v228, 16, v28
    v_and_b32 v231, 0xffff0000, v29
    v_lshlrev_b32 v230, 16, v29
    v_and_b32 v233, 0xffff0000, v212
    v_lshlrev_b32 v232, 16, v212
    v_and_b32 v235, 0xffff0000, v213
    v_lshlrev_b32 v234, 16, v213
    v_and_b32 v237, 0xffff0000, v214
    v_lshlrev_b32 v236, 16, v214
    v_and_b32 v239, 0xffff0000, v215
    v_lshlrev_b32 v238, 16, v215
    v_pk_add_f32 v[224:225], v[224:225], v[232:233]
    v_pk_add_f32 v[226:227], v[226:227], v[234:235]
    v_pk_add_f32 v[228:229], v[228:229], v[236:237]
    v_pk_add_f32 v[230:231], v[230:231], v[238:239]
    s_waitcnt lgkmcnt(0)
    v_pk_add_f32 v[64:65], v[64:65], v[96:97]
    v_pk_add_f32 v[66:67], v[66:67], v[98:99]
    v_pk_add_f32 v[68:69], v[68:69], v[100:101]
    v_pk_add_f32 v[70:71], v[70:71], v[102:103]
    v_pk_add_f32 v[72:73], v[72:73], v[104:105]
    v_pk_add_f32 v[74:75], v[74:75], v[106:107]
    v_pk_add_f32 v[76:77], v[76:77], v[108:109]
    v_pk_add_f32 v[78:79], v[78:79], v[110:111]
    v_pk_add_f32 v[80:81], v[80:81], v[112:113]
    v_pk_add_f32 v[82:83], v[82:83], v[114:115]
    v_pk_add_f32 v[84:85], v[84:85], v[116:117]
    v_pk_add_f32 v[86:87], v[86:87], v[118:119]
    v_pk_add_f32 v[88:89], v[88:89], v[120:121]
    v_pk_add_f32 v[90:91], v[90:91], v[122:123]
    v_pk_add_f32 v[92:93], v[92:93], v[124:125]
    v_pk_add_f32 v[94:95], v[94:95], v[126:127]
    v_pk_add_f32 v[64:65], v[64:65], v[80:81]
    v_pk_add_f32 v[66:67], v[66:67], v[82:83]
    v_pk_add_f32 v[68:69], v[68:69], v[84:85]
    v_pk_add_f32 v[70:71], v[70:71], v[86:87]
    v_pk_add_f32 v[72:73], v[72:73], v[88:89]
    v_pk_add_f32 v[74:75], v[74:75], v[90:91]
    v_pk_add_f32 v[76:77], v[76:77], v[92:93]
    v_pk_add_f32 v[78:79], v[78:79], v[94:95]
    v_pk_add_f32 v[64:65], v[64:65], v[72:73]
    v_pk_add_f32 v[66:67], v[66:67], v[74:75]
    v_pk_add_f32 v[68:69], v[68:69], v[76:77]
    v_pk_add_f32 v[70:71], v[70:71], v[78:79]
    v_pk_add_f32 v[64:65], v[64:65], v[224:225]
    v_pk_add_f32 v[66:67], v[66:67], v[226:227]
    v_pk_add_f32 v[68:69], v[68:69], v[228:229]
    v_pk_add_f32 v[70:71], v[70:71], v[230:231]
    v_cvt_pk_bf16_f32 v240, v64, v65
    v_cvt_pk_bf16_f32 v241, v66, v67
    v_cvt_pk_bf16_f32 v242, v68, v69
    v_cvt_pk_bf16_f32 v243, v70, v71
    s_lshl_b32 s29, s50, 5
    v_add_u32 v2, s29, v15
    v_mul_u32_u24 v2, 144, v2
    v_lshl_add_u32 v2, v12, 3, v2
    s_lshl_b32 s29, s48, 6
    s_lshl_b32 s30, s53, 5
    s_add_u32 s29, s29, s30
    s_add_u32 s29, s29, 131072
    v_add_u32 v2, s29, v2
    ds_write_b64 v2, v[240:241]
    ds_write_b64 v2, v[242:243] offset:16
    v_lshrrev_b32 v3, 3, v0
    v_and_b32 v4, 7, v0
    s_lshl_b32 s29, s24, 3
    v_add_u32 v3, s29, v3
    v_mul_u32_u24 v5, 144, v3
    v_lshl_add_u32 v5, v4, 4, v5
    v_add_u32 v5, 131072, v5
    s_lshl_b32 s29, s25, 6
    v_add_u32 v3, s29, v3
    v_mul_u32_u24 v3, 896, v3
    v_lshl_add_u32 v3, v4, 4, v3
    s_lshl_b32 s29, s26, 7
    s_waitcnt lgkmcnt(0)
    s_barrier
    ds_read_b128 v[8:11], v5
    s_waitcnt lgkmcnt(0)
    buffer_store_dwordx4 v[8:11], v3, s[12:15], s29 offen
attn_kernel_end:
    s_endpgm
.section .rodata,"a"
.p2align 6
.amdhsa_kernel sequential_preLN__mha_block__dense_activation_gelu__prompt_kernel
  .amdhsa_next_free_vgpr 256
  .amdhsa_next_free_sgpr 96
  .amdhsa_accum_offset 256
  .amdhsa_group_segment_fixed_size 0
  .amdhsa_kernarg_size 88
  .amdhsa_user_sgpr_count 2
  .amdhsa_user_sgpr_kernarg_segment_ptr 1
  .amdhsa_system_sgpr_workgroup_id_x 1
.end_amdhsa_kernel
.p2align 6
.amdhsa_kernel attn_kernel
  .amdhsa_next_free_vgpr 256
  .amdhsa_next_free_sgpr 96
  .amdhsa_accum_offset 256
  .amdhsa_group_segment_fixed_size 0
  .amdhsa_kernarg_size 88
  .amdhsa_user_sgpr_count 2
  .amdhsa_user_sgpr_kernarg_segment_ptr 1
  .amdhsa_system_sgpr_workgroup_id_x 1
.end_amdhsa_kernel
```
